```python
import torch

def _softmax(x, axis=-1):
    return torch.softmax(x, dim=axis)
def _gelu(x):
    return torch.nn.functional.gelu(x, approximate="tanh")
def _silu(x):
    return torch.nn.functional.silu(x)
def _sigmoid(x):
    return torch.sigmoid(x)
def _layernorm(x, axis=-1, eps=1e-5):
    m = x.mean(dim=axis, keepdim=True)
    v = x.var(dim=axis, keepdim=True, unbiased=False)
    return (x - m) / torch.sqrt(v + eps)
def _scatter_add(tgt, idx, src, axis=0):
    return tgt.clone().index_add_(axis, idx, src)
def _segment_sum(src, seg, n):
    out = torch.zeros((n,) + src.shape[1:], dtype=src.dtype)
    return out.index_add_(0, seg, src)
def _pad(x, pw):
    flat = tuple(v for pair in reversed(pw) for v in pair)
    return torch.nn.functional.pad(x, flat)

kernel_name = 'interleave_layers__sliding_local_dilated__linear_kernel_hedgehog__prompt'

def setup_inputs():

    _w = (lambda a: (lambda t: t.to(torch.bfloat16) if t.is_floating_point() else t)(torch.as_tensor(a)))
    def _A_setup():
        B, S, D = 1, 2048, 576
        return {
            "x": _w((lambda *s: torch.randn(*s, dtype=torch.bfloat16) * 0.05)(B, S, D)),
            "wqkv": _w((lambda *s: torch.randn(*s, dtype=torch.bfloat16) * 0.05)(D, 3 * D)),
            "wo": _w((lambda *s: torch.randn(*s, dtype=torch.bfloat16) * 0.05)(D, D)),
        }
    _A_in = _A_setup()

    def _B_setup():
        B, S, D, H = 1, 2048, 576, 32
        Dh = D // H
        return {
            "x": _w((lambda *s: torch.randn(*s, dtype=torch.bfloat16) * 0.05)(B, S, D)),
            "wqkv": _w((lambda *s: torch.randn(*s, dtype=torch.bfloat16) * 0.4)(D, 3 * D)),
            "w_phi": _w((lambda *s: torch.randn(*s, dtype=torch.bfloat16) * 0.4)(H, Dh, Dh) * (Dh ** -0.5)),
            "wo": _w((lambda *s: torch.randn(*s, dtype=torch.bfloat16) * 0.1)(D, D)),
        }
    _B_in = _B_setup()

    return {
        "A_x": _A_in["x"],
        "A_wqkv": _A_in["wqkv"],
        "A_wo": _A_in["wo"],
        "B_x": _B_in["x"],
        "B_wqkv": _B_in["wqkv"],
        "B_w_phi": _B_in["w_phi"],
        "B_wo": _B_in["wo"],
    }

def reference(A_x, A_wqkv, A_wo, B_x, B_wqkv, B_w_phi, B_wo):
    def _A_ref(x, wqkv, wo):
        B, S, D = x.shape
        H = 32; Dh = D // H
        W, dil = 8, 2
        qkv = (lambda x, *d: x.permute(*d))((x @ wqkv).reshape(B, S, 3, H, Dh), 2, 0, 3, 1, 4)
        q, k, v = qkv[0], qkv[1], qkv[2]
        scale = Dh ** -0.5
        pos = torch.arange(S)
        off = torch.arange(W) * dil
        idx = pos[:, None] - off[None, :]
        mask = idx >= 0
        idx_c = torch.where(mask, idx, 0).reshape(-1)
        kg = k[:, :, idx_c, :].reshape(B, H, S, W, Dh)
        vg = v[:, :, idx_c, :].reshape(B, H, S, W, Dh)
        logits = torch.einsum("bhsd,bhswd->bhsw", q, kg) * scale
        logits = torch.where(mask[None, None, :, :], logits, -1e9)
        attn = _softmax(logits, axis=-1)
        o = torch.einsum("bhsw,bhswd->bhsd", attn, vg)
        return (lambda x, *d: x.permute(*d))(o, 0, 2, 1, 3).reshape(B, S, D) @ wo

    def _B_ref(x, wqkv, w_phi, wo):
        B, S, D = x.shape
        H = 32; Dh = D // H
        qkv = (lambda x, *d: x.permute(*d))((x @ wqkv).reshape(B, S, 3, H, Dh), 2, 0, 3, 1, 4)
        q, k, v = qkv[0], qkv[1], qkv[2]
        pq = torch.einsum("bhsd,hdf->bhsf", q, w_phi)
        pk = torch.einsum("bhsd,hdf->bhsf", k, w_phi)
        phi_q = torch.concatenate([_softmax(pq, axis=-1), _softmax(-pq, axis=-1)], axis=-1)
        phi_k = torch.concatenate([_softmax(pk, axis=-1), _softmax(-pk, axis=-1)], axis=-1)
        kv = torch.einsum("bhsf,bhsd->bhfd", phi_k, v)
        z  = torch.einsum("bhsf->bhf", phi_k)
        num = torch.einsum("bhqf,bhfd->bhqd", phi_q, kv)
        den = torch.einsum("bhqf,bhf->bhq", phi_q, z)[..., None] + 1e-6
        o = num / den
        return (lambda x, *d: x.permute(*d))(o, 0, 2, 1, 3).reshape(B, S, D) @ wo

    x = A_x
    x = x + _A_ref(_layernorm(x, axis=-1), A_wqkv, A_wo)
    x = x + _B_ref(_layernorm(x, axis=-1), B_wqkv, B_w_phi, B_wo)
    x = x + _A_ref(_layernorm(x, axis=-1), A_wqkv, A_wo)
    x = x + _B_ref(_layernorm(x, axis=-1), B_wqkv, B_w_phi, B_wo)
    return x
```

```asm
; @launch kernel=prep_kernel grid=(992,1,1) block=(256,1,1) lds=12288
; @launch kernel=main_kernel grid=(256,1,1) block=(512,1,1) lds=163840
.amdgcn_target "amdgcn-amd-amdhsa--gfx950"
.text
.globl prep_kernel
.p2align 8
.type prep_kernel,@function
prep_kernel:
s_cmp_ge_u32 s2, 992
s_cbranch_scc1 P_END
s_load_dwordx16 s[64:79], s[0:1], 0
s_load_dwordx2 s[4:5], s[0:1], 72
v_and_b32 v1, 15, v0
v_bfe_u32 v2, v0, 4, 2
v_lshrrev_b32 v3, 6, v0
v_and_b32 v4, 63, v0
v_readfirstlane_b32 s20, v3
v_lshlrev_b32 v5, 4, v4
s_and_b32 s50, s2, 7
s_cmp_ge_u32 s2, 864
s_cbranch_scc1 P_XS
s_cmp_ge_u32 s2, 576
s_cbranch_scc1 P_WO
s_lshr_b32 s51, s2, 3
s_lshr_b32 s52, s51, 4
s_lshl_b32 s52, s52, 3
s_add_u32 s52, s52, s50
s_and_b32 s53, s51, 15
s_lshr_b32 s54, s50, 1
s_add_u32 s54, s54, 32
s_and_b32 s55, s50, 1
s_lshl_b32 s55, s55, 3
s_add_u32 s55, s55, s51
s_sub_u32 s55, s55, 64
s_cmp_lt_u32 s51, 64
s_cselect_b32 s52, s52, s54
s_cselect_b32 s23, s53, s55
s_sub_u32 s24, s52, 18
s_cmp_lt_u32 s52, 18
s_cselect_b32 s24, s52, s24
s_cselect_b32 s21, 1, 0
s_lshr_b32 s26, s24, 1
s_mul_i32 s26, s26, 9
s_and_b32 s27, s24, 1
s_lshl_b32 s27, s27, 2
s_add_u32 s26, s26, s27
s_sub_u32 s27, s24, 16
s_mul_i32 s27, s27, 36
s_add_u32 s27, s27, 8
s_cmp_lt_u32 s24, 16
s_cselect_b32 s26, s26, s27
s_cselect_b32 s27, 1, 9
v_lshrrev_b32 v6, 3, v0
v_and_b32 v7, 7, v0
v_lshrrev_b32 v8, 3, v6
v_mul_u32_u24 v8, s27, v8
v_add_u32 v8, s26, v8
v_and_b32 v9, 7, v6
v_lshl_add_u32 v8, v8, 3, v9
v_mul_u32_u24 v8, 3456, v8
s_mul_i32 s34, s23, 72
v_add_u32 v8, s34, v8
v_lshl_add_u32 v14, v7, 3, v8
v_add_u32 v11, 1080, v14
v_cmp_le_u32 vcc, 1, v7
s_nop 1
v_cndmask_b32 v15, v14, v11, vcc
v_cmp_le_u32 vcc, 2, v7
s_nop 1
v_cndmask_b32 v16, v14, v11, vcc
v_mov_b32 v12, 0x7ff00000
v_cmp_gt_u32 s[88:89], 3, v7
s_nop 1
v_cndmask_b32 v17, v12, v14, s[88:89]
s_waitcnt lgkmcnt(0)
s_cmp_eq_u32 s21, 0
s_cselect_b32 s12, s66, s72
s_cselect_b32 s13, s67, s73
s_and_b32 s13, s13, 0xffff
s_mov_b32 s14, 1990656
s_mov_b32 s15, 0x20000
buffer_load_dwordx2 v[22:23], v14, s[12:15], 0 offen offset:0
buffer_load_dwordx2 v[24:25], v15, s[12:15], 0 offen offset:64
buffer_load_dwordx2 v[26:27], v16, s[12:15], 0 offen offset:1208
buffer_load_dwordx2 v[28:29], v17, s[12:15], 0 offen offset:2352
s_mov_b32 s8, s4
s_and_b32 s9, s5, 0xffff
s_mov_b32 s10, 28098560
s_mov_b32 s11, 0x20000
s_cmp_eq_u32 s21, 0
s_cbranch_scc1 PW_NOPHI
s_mov_b32 s28, s74
s_and_b32 s29, s75, 0xffff
s_mov_b32 s30, 20736
s_mov_b32 s31, 0x20000
s_and_b32 s35, s20, 1
s_lshl_b32 s36, s23, 1
s_add_u32 s36, s36, s35
s_mul_i32 s36, s36, 648
v_mul_u32_u24 v30, 288, v2
v_lshl_add_u32 v30, v1, 1, v30
v_add_u32 v30, s36, v30
v_mov_b32 v11, 0x7ff00000
v_add_u32 v31, 0, v30
v_cmp_gt_u32 vcc, 3, v2
s_nop 1
v_cndmask_b32 v32, v11, v31, vcc
v_cmp_gt_u32 vcc, 2, v2
s_nop 1
v_cndmask_b32 v33, v11, v31, vcc
buffer_load_ushort v96, v32, s[28:31], 0 offen offset:0
buffer_load_ushort v97, v32, s[28:31], 0 offen offset:36
buffer_load_ushort v98, v33, s[28:31], 0 offen offset:72
buffer_load_ushort v99, v33, s[28:31], 0 offen offset:108
buffer_load_ushort v100, v33, s[28:31], 0 offen offset:144
buffer_load_ushort v101, v33, s[28:31], 0 offen offset:180
buffer_load_ushort v102, v33, s[28:31], 0 offen offset:216
buffer_load_ushort v103, v33, s[28:31], 0 offen offset:252
v_add_u32 v31, 32, v30
v_cmp_gt_u32 vcc, 2, v1
s_nop 1
v_cndmask_b32 v31, v11, v31, vcc
v_cmp_gt_u32 vcc, 3, v2
s_nop 1
v_cndmask_b32 v32, v11, v31, vcc
v_cmp_gt_u32 vcc, 2, v2
s_nop 1
v_cndmask_b32 v33, v11, v31, vcc
buffer_load_ushort v104, v32, s[28:31], 0 offen offset:0
buffer_load_ushort v105, v32, s[28:31], 0 offen offset:36
buffer_load_ushort v106, v33, s[28:31], 0 offen offset:72
buffer_load_ushort v107, v33, s[28:31], 0 offen offset:108
buffer_load_ushort v108, v33, s[28:31], 0 offen offset:144
buffer_load_ushort v109, v33, s[28:31], 0 offen offset:180
buffer_load_ushort v110, v33, s[28:31], 0 offen offset:216
buffer_load_ushort v111, v33, s[28:31], 0 offen offset:252
s_lshr_b32 s35, s20, 1
s_mul_i32 s35, s35, 72
s_and_b32 s36, s20, 1
s_mul_i32 s36, s36, 36
s_add_u32 s35, s35, s36
v_mul_u32_u24 v8, 368, v1
v_lshl_add_u32 v8, v2, 4, v8
v_add_u32 v8, s35, v8
v_add_u32 v20, 5888, v8
v_mul_u32_u24 v9, 368, v1
v_lshl_add_u32 v9, v2, 3, v9
v_add_u32 v9, s35, v9
v_add_u32 v9, 216, v9
v_add_u32 v19, 5888, v9
PW_NOPHI:
v_mul_u32_u24 v10, 368, v6
v_lshl_add_u32 v18, v7, 3, v10
s_add_u32 s48, s24, 2
s_sub_u32 s49, s24, 16
s_cmp_lt_u32 s24, 16
s_cselect_b32 s48, s48, s49
s_mul_i32 s40, s23, 129024
s_mul_i32 s41, s48, 5120
s_add_u32 s40, s40, s41
s_mul_i32 s49, s48, 3072
s_sub_u32 s49, 87040, s49
s_mul_i32 s41, s21, 2064384
s_add_u32 s40, s40, s41
s_add_u32 s40, s40, 0
s_mul_i32 s42, s23, 18
s_add_u32 s42, s42, s24
s_lshl_b32 s42, s42, 9
s_mul_i32 s41, s21, 147456
s_add_u32 s42, s42, s41
s_add_u32 s42, s42, 4128768
s_lshl_b32 s41, s20, 6
s_add_u32 s86, s42, s41
v_mul_u32_u24 v34, 2944, v2
v_lshrrev_b32 v35, 2, v1
v_and_b32 v36, 3, v1
s_add_u32 s43, s20, 0
s_cmp_eq_u32 s21, 0
s_cbranch_scc0 PG_1_B
s_mul_i32 s46, s43, 18
s_add_u32 s46, s46, 36
v_add_u32 v37, s46, v1
s_mov_b64 s[80:81], -1
s_branch PG_1_J
PG_1_B:
s_lshl_b32 s46, s43, 2
v_add_u32 v38, s46, v36
v_cmp_le_u32 vcc, 9, v38
s_nop 1
v_cndmask_b32 v39, 0, 1, vcc
v_cmp_le_u32 vcc, 18, v38
s_nop 1
v_addc_co_u32 v39, vcc, 0, v39, vcc
v_mul_u32_u24 v76, 9, v39
v_sub_u32 v38, v38, v76
v_mov_b32 v76, 144
v_mov_b32 v77, 72
v_cmp_eq_u32 vcc, 1, v39
s_nop 1
v_cndmask_b32 v76, v76, v77, vcc
v_mov_b32 v77, 108
v_cmp_eq_u32 vcc, 2, v39
s_nop 1
v_cndmask_b32 v76, v76, v77, vcc
v_mul_u32_u24 v77, 9, v35
v_add3_u32 v37, v76, v77, v38
v_cmp_gt_u32 s[80:81], 9, v38
PG_1_J:
s_nop 1
v_cndmask_b32 v37, 0, v37, s[80:81]
v_lshl_add_u32 v86, v37, 1, v34
s_lshl_b32 s46, s43, 10
s_add_u32 s84, s46, s40
s_add_u32 s43, s20, 4
s_cmp_eq_u32 s21, 0
s_cbranch_scc0 PG_2_B
s_cmp_eq_u32 s43, 4
s_cbranch_scc1 PG_2_A4
s_sub_u32 s47, s43, 5
s_mul_i32 s47, s47, 18
v_add_u32 v37, s47, v1
s_mov_b64 s[82:83], -1
s_branch PG_2_J
PG_2_A4:
v_mul_u32_u24 v37, 36, v35
v_add_u32 v37, 36, v37
v_cmp_eq_u32 vcc, 2, v35
s_nop 1
v_cndmask_b32 v37, v37, 0, vcc
v_lshrrev_b32 v38, 1, v36
v_mul_u32_u24 v38, 18, v38
v_and_b32 v39, 1, v36
v_add3_u32 v37, v37, v38, v39
v_add_u32 v37, 16, v37
v_cmp_gt_u32 s[82:83], 3, v35
s_branch PG_2_J
PG_2_B:
s_lshl_b32 s46, s43, 2
v_add_u32 v38, s46, v36
v_cmp_le_u32 vcc, 9, v38
s_nop 1
v_cndmask_b32 v39, 0, 1, vcc
v_cmp_le_u32 vcc, 18, v38
s_nop 1
v_addc_co_u32 v39, vcc, 0, v39, vcc
v_mul_u32_u24 v76, 9, v39
v_sub_u32 v38, v38, v76
v_mov_b32 v76, 144
v_mov_b32 v77, 72
v_cmp_eq_u32 vcc, 1, v39
s_nop 1
v_cndmask_b32 v76, v76, v77, vcc
v_mov_b32 v77, 108
v_cmp_eq_u32 vcc, 2, v39
s_nop 1
v_cndmask_b32 v76, v76, v77, vcc
v_mul_u32_u24 v77, 9, v35
v_add3_u32 v37, v76, v77, v38
v_cmp_gt_u32 s[82:83], 9, v38
PG_2_J:
s_nop 1
v_cndmask_b32 v37, 0, v37, s[82:83]
v_lshl_add_u32 v87, v37, 1, v34
s_lshl_b32 s46, s43, 10
s_add_u32 s85, s46, s40
s_cmp_ge_u32 s43, 5
s_cselect_b32 s47, s49, 0
s_add_u32 s85, s85, s47
v_lshlrev_b32 v95, 2, v1
v_cmp_eq_u32 s[90:91], 1, v2
v_mov_b32 v94, 256
s_nop 0
v_cndmask_b32 v94, 0, v94, s[90:91]
v_add_u32 v95, v95, v94
s_mov_b32 s87, 0x3f803f80
v_mov_b32 v92, 0
v_mov_b32 v93, 0
s_cmp_eq_u32 s21, 0
s_cbranch_scc1 PW_W0
s_waitcnt vmcnt(16)
s_branch PW_W1
PW_W0:
s_waitcnt vmcnt(0)
PW_W1:
ds_write_b64 v18, v[22:23] offset:0
ds_write_b64 v18, v[24:25] offset:64
ds_write_b64 v18, v[26:27] offset:128
s_mov_b64 exec, s[88:89]
ds_write_b64 v18, v[28:29] offset:192
s_mov_b64 exec, -1
s_waitcnt vmcnt(0) lgkmcnt(0)
s_barrier
s_cmp_eq_u32 s21, 0
s_cbranch_scc1 PW_GATHER
ds_read2_b32 v[48:49], v8 offset0:0 offset1:1
ds_read2_b32 v[50:51], v8 offset0:2 offset1:3
ds_read2_b32 v[52:53], v20 offset0:0 offset1:1
ds_read2_b32 v[54:55], v20 offset0:2 offset1:3
v_lshl_or_b32 v40, v97, 16, v96
v_lshl_or_b32 v41, v99, 16, v98
v_lshl_or_b32 v42, v101, 16, v100
v_lshl_or_b32 v43, v103, 16, v102
v_lshl_or_b32 v44, v105, 16, v104
v_lshl_or_b32 v45, v107, 16, v106
v_lshl_or_b32 v46, v109, 16, v108
v_lshl_or_b32 v47, v111, 16, v110
s_waitcnt lgkmcnt(0)
v_mfma_f32_16x16x32_bf16 v[56:59], v[40:43], v[48:51], 0
v_mfma_f32_16x16x32_bf16 v[60:63], v[44:47], v[48:51], 0
v_mfma_f32_16x16x32_bf16 v[64:67], v[40:43], v[52:55], 0
v_mfma_f32_16x16x32_bf16 v[68:71], v[44:47], v[52:55], 0
s_nop 7
s_nop 7
v_cvt_pk_bf16_f32 v72, v56, v57
v_cvt_pk_bf16_f32 v73, v58, v59
v_cvt_pk_bf16_f32 v74, v60, v61
v_cvt_pk_bf16_f32 v76, v64, v65
v_cvt_pk_bf16_f32 v77, v66, v67
v_cvt_pk_bf16_f32 v78, v68, v69
ds_write2_b32 v9, v72, v73 offset0:0 offset1:1
ds_write2_b32 v19, v76, v77 offset0:0 offset1:1
s_mov_b64 exec, 0xffff
ds_write_b32 v9, v74 offset:32
ds_write_b32 v19, v78 offset:32
s_mov_b64 exec, -1
s_waitcnt lgkmcnt(0)
s_barrier
PW_GATHER:
ds_read_u16 v96, v86 offset:0
ds_read_u16 v97, v86 offset:368
ds_read_u16 v98, v86 offset:736
ds_read_u16 v99, v86 offset:1104
ds_read_u16 v100, v86 offset:1472
ds_read_u16 v101, v86 offset:1840
ds_read_u16 v102, v86 offset:2208
ds_read_u16 v103, v86 offset:2576
ds_read_u16 v104, v87 offset:0
ds_read_u16 v105, v87 offset:368
ds_read_u16 v106, v87 offset:736
ds_read_u16 v107, v87 offset:1104
ds_read_u16 v108, v87 offset:1472
ds_read_u16 v109, v87 offset:1840
ds_read_u16 v110, v87 offset:2208
ds_read_u16 v111, v87 offset:2576
s_waitcnt lgkmcnt(8)
v_lshl_or_b32 v80, v97, 16, v96
v_lshl_or_b32 v81, v99, 16, v98
v_lshl_or_b32 v82, v101, 16, v100
v_lshl_or_b32 v83, v103, 16, v102
v_cndmask_b32 v80, 0, v80, s[80:81]
v_cndmask_b32 v81, 0, v81, s[80:81]
v_cndmask_b32 v82, 0, v82, s[80:81]
v_cndmask_b32 v83, 0, v83, s[80:81]
buffer_store_dwordx4 v[80:83], v5, s[8:11], s84 offen
v_dot2c_f32_bf16 v92, s87, v80
v_dot2c_f32_bf16 v92, s87, v81
v_dot2c_f32_bf16 v92, s87, v82
v_dot2c_f32_bf16 v92, s87, v83
s_waitcnt lgkmcnt(0)
v_lshl_or_b32 v88, v105, 16, v104
v_lshl_or_b32 v89, v107, 16, v106
v_lshl_or_b32 v90, v109, 16, v108
v_lshl_or_b32 v91, v111, 16, v110
v_cndmask_b32 v88, 0, v88, s[82:83]
v_cndmask_b32 v89, 0, v89, s[82:83]
v_cndmask_b32 v90, 0, v90, s[82:83]
v_cndmask_b32 v91, 0, v91, s[82:83]
s_cmp_ge_u32 s20, 3
s_cbranch_scc1 PW_S1
buffer_store_dwordx4 v[88:91], v5, s[8:11], s85 offen
PW_S1:
v_dot2c_f32_bf16 v93, s87, v88
v_dot2c_f32_bf16 v93, s87, v89
v_dot2c_f32_bf16 v93, s87, v90
v_dot2c_f32_bf16 v93, s87, v91
v_mov_b32 v44, v92
s_nop 1
v_mov_b32 v45, v93
s_nop 1
v_permlane16_swap_b32 v92, v44
v_permlane16_swap_b32 v93, v45
s_nop 1
v_add_f32 v92, v92, v44
v_add_f32 v93, v93, v45
v_mov_b32 v44, v92
v_mov_b32 v45, v93
s_nop 1
v_permlane32_swap_b32 v92, v44
v_permlane32_swap_b32 v93, v45
s_nop 1
v_add_f32 v92, v92, v44
v_add_f32 v93, v93, v45
v_cndmask_b32 v92, v92, v93, s[90:91]
s_cmp_ge_u32 s20, 3
s_cselect_b32 s46, 0xffff, -1
s_mov_b32 s47, 0
s_mov_b64 exec, s[46:47]
buffer_store_dword v92, v95, s[8:11], s86 offen
s_mov_b64 exec, -1
s_branch P_CLR
P_WO:
s_sub_u32 s51, s2, 576
s_lshr_b32 s51, s51, 3
s_lshr_b32 s52, s51, 3
s_lshl_b32 s52, s52, 3
s_add_u32 s52, s52, s50
s_and_b32 s53, s51, 7
s_lshr_b32 s54, s50, 1
s_add_u32 s54, s54, 32
s_and_b32 s55, s50, 1
s_lshl_b32 s55, s55, 2
s_add_u32 s55, s55, s51
s_sub_u32 s55, s55, 32
s_cmp_lt_u32 s51, 32
s_cselect_b32 s52, s52, s54
s_cselect_b32 s23, s53, s55
s_sub_u32 s24, s52, 18
s_cmp_ge_u32 s52, 18
s_cselect_b32 s24, s24, s52
s_cselect_b32 s21, 1, 0
v_lshrrev_b32 v6, 3, v0
v_and_b32 v7, 7, v0
v_lshrrev_b32 v8, 3, v6
v_and_b32 v9, 7, v6
s_cmp_lt_u32 s24, 16
s_cbranch_scc0 PO_HI
s_add_u32 s26, s21, 8
v_lshrrev_b32 v10, 1, v8
s_lshl_b32 s27, s24, 1
v_add_u32 v10, s27, v10
v_mul_u32_u24 v10, 18, v10
v_and_b32 v11, 1, v8
v_mul_u32_u24 v11, s26, v11
v_add3_u32 v10, v10, v11, v9
s_branch PO_J
PO_HI:
s_sub_u32 s27, s24, 16
s_lshl_b32 s27, s27, 2
v_add_u32 v10, s27, v8
v_lshlrev_b32 v10, 2, v10
v_lshrrev_b32 v11, 1, v9
v_add_u32 v10, v10, v11
v_mul_u32_u24 v10, 18, v10
s_cmp_eq_u32 s21, 0
s_cselect_b32 s26, 16, 8
s_cselect_b32 s27, 1, 9
v_and_b32 v11, 1, v9
v_mul_u32_u24 v11, s27, v11
v_add_u32 v10, v10, v11
v_add_u32 v10, s26, v10
PO_J:
v_mul_u32_u24 v10, 1152, v10
s_mul_i32 s34, s23, 144
v_add_u32 v10, s34, v10
v_lshl_add_u32 v10, v7, 3, v10
v_mov_b32 v12, 0x7ff00000
v_cmp_gt_u32 s[88:89], 2, v7
s_nop 1
v_cndmask_b32 v13, v12, v10, s[88:89]
s_waitcnt lgkmcnt(0)
s_cmp_eq_u32 s21, 0
s_cselect_b32 s12, s68, s76
s_cselect_b32 s13, s69, s77
s_and_b32 s13, s13, 0xffff
s_mov_b32 s14, 663552
s_mov_b32 s15, 0x20000
buffer_load_dwordx2 v[22:23], v10, s[12:15], 0 offen
buffer_load_dwordx2 v[24:25], v10, s[12:15], 0 offen offset:64
buffer_load_dwordx2 v[26:27], v13, s[12:15], 0 offen offset:128
s_mov_b32 s8, s4
s_and_b32 s9, s5, 0xffff
s_mov_b32 s10, 28098560
s_mov_b32 s11, 0x20000
v_mul_u32_u24 v11, 152, v6
v_lshl_add_u32 v11, v7, 3, v11
s_and_b32 s48, s24, 7
s_add_u32 s48, s48, 1
s_lshr_b32 s49, s24, 3
s_sub_u32 s50, s24, 16
s_cmp_lt_u32 s24, 16
s_cselect_b32 s48, s48, 0
s_cselect_b32 s49, s49, s50
s_mul_i32 s48, s48, 9216
s_mul_i32 s49, s49, 4608
s_add_u32 s48, s48, s49
s_mul_i32 s40, s23, 82944
s_add_u32 s40, s40, s48
s_mul_i32 s41, s21, 663552
s_add_u32 s40, s40, s41
s_add_u32 s40, s40, 4423680
v_mul_u32_u24 v34, 1216, v2
s_lshr_b32 s46, s20, 1
s_lshl_b32 s46, s46, 5
s_and_b32 s47, s20, 1
s_lshl_b32 s47, s47, 2
s_add_u32 s46, s46, s47
v_lshrrev_b32 v35, 2, v1
v_and_b32 v36, 3, v1
v_lshl_add_u32 v37, v35, 3, v36
v_add_u32 v37, s46, v37
v_lshl_add_u32 v38, v37, 1, v34
s_lshl_b32 s46, s20, 10
s_add_u32 s46, s46, s40
s_add_u32 s47, s40, 4096
v_and_b32 v37, 7, v1
v_add_u32 v40, 64, v37
v_lshl_add_u32 v40, v40, 1, v34
v_lshlrev_b32 v39, 7, v2
v_lshl_add_u32 v39, v37, 4, v39
v_cmp_gt_u32 s[90:91], 8, v1
s_waitcnt vmcnt(0)
ds_write_b64 v11, v[22:23]
ds_write_b64 v11, v[24:25] offset:64
s_mov_b64 exec, s[88:89]
ds_write_b64 v11, v[26:27] offset:128
s_mov_b64 exec, -1
s_waitcnt lgkmcnt(0)
s_barrier
ds_read_u16 v96, v38 offset:0
ds_read_u16 v97, v38 offset:152
ds_read_u16 v98, v38 offset:304
ds_read_u16 v99, v38 offset:456
ds_read_u16 v100, v38 offset:608
ds_read_u16 v101, v38 offset:760
ds_read_u16 v102, v38 offset:912
ds_read_u16 v103, v38 offset:1064
s_cmp_eq_u32 s20, 0
s_cbranch_scc0 PO_N4
ds_read_u16 v104, v40 offset:0
ds_read_u16 v105, v40 offset:152
ds_read_u16 v106, v40 offset:304
ds_read_u16 v107, v40 offset:456
ds_read_u16 v108, v40 offset:608
ds_read_u16 v109, v40 offset:760
ds_read_u16 v110, v40 offset:912
ds_read_u16 v111, v40 offset:1064
s_waitcnt lgkmcnt(0)
v_lshl_or_b32 v84, v105, 16, v104
v_lshl_or_b32 v85, v107, 16, v106
v_lshl_or_b32 v86, v109, 16, v108
v_lshl_or_b32 v87, v111, 16, v110
s_mov_b64 exec, s[90:91]
buffer_store_dwordx4 v[84:87], v39, s[8:11], s47 offen
s_mov_b64 exec, -1
PO_N4:
s_waitcnt lgkmcnt(0)
v_lshl_or_b32 v80, v97, 16, v96
v_lshl_or_b32 v81, v99, 16, v98
v_lshl_or_b32 v82, v101, 16, v100
v_lshl_or_b32 v83, v103, 16, v102
buffer_store_dwordx4 v[80:83], v5, s[8:11], s46 offen
s_branch P_CLR
P_XS:
s_sub_u32 s51, s2, 864
s_lshr_b32 s51, s51, 3
s_lshl_b32 s50, s50, 4
s_add_u32 s22, s50, s51
s_mul_i32 s23, s22, 18432
s_mul_i32 s24, s22, 20480
s_add_u32 s24, s24, 5750784
v_mul_u32_u24 v6, 1152, v1
v_lshl_add_u32 v14, v2, 4, v6
v_mul_u32_u24 v7, 144, v2
v_add3_u32 v15, v6, v7, 0
v_add_u32 v15, 128, v15
v_mov_b32 v40, 0
v_mov_b32 v41, 0
v_mov_b32 v42, 0
v_mov_b32 v43, 0
v_mov_b32 v44, 0x3f803f80
s_waitcnt lgkmcnt(0)
s_mov_b32 s12, s64
s_and_b32 s13, s65, 0xffff
s_mov_b32 s14, 2359296
s_mov_b32 s15, 0x20000
s_mov_b32 s8, s4
s_and_b32 s9, s5, 0xffff
s_mov_b32 s10, 28098560
s_mov_b32 s11, 0x20000
s_cmp_eq_u32 s20, 0
s_cbranch_scc0 PX_0
buffer_load_dwordx4 v[20:23], v14, s[12:15], s23 offen offset:0
buffer_load_dwordx4 v[24:27], v14, s[12:15], s23 offen offset:64
buffer_load_dwordx4 v[28:31], v14, s[12:15], s23 offen offset:144
buffer_load_dwordx4 v[32:35], v14, s[12:15], s23 offen offset:208
buffer_load_dwordx4 v[36:39], v15, s[12:15], s23 offen offset:0
s_waitcnt vmcnt(4)
s_add_u32 s25, s24, 0
buffer_store_dwordx4 v[20:23], v5, s[8:11], s25 offen
v_dot2c_f32_bf16 v40, v20, v44
v_dot2c_f32_bf16 v41, v20, v20
v_dot2c_f32_bf16 v40, v21, v44
v_dot2c_f32_bf16 v41, v21, v21
v_dot2c_f32_bf16 v40, v22, v44
v_dot2c_f32_bf16 v41, v22, v22
v_dot2c_f32_bf16 v40, v23, v44
v_dot2c_f32_bf16 v41, v23, v23
s_waitcnt vmcnt(4)
s_add_u32 s25, s24, 1024
buffer_store_dwordx4 v[24:27], v5, s[8:11], s25 offen
v_dot2c_f32_bf16 v40, v24, v44
v_dot2c_f32_bf16 v41, v24, v24
v_dot2c_f32_bf16 v40, v25, v44
v_dot2c_f32_bf16 v41, v25, v25
v_dot2c_f32_bf16 v40, v26, v44
v_dot2c_f32_bf16 v41, v26, v26
v_dot2c_f32_bf16 v40, v27, v44
v_dot2c_f32_bf16 v41, v27, v27
s_waitcnt vmcnt(4)
s_add_u32 s25, s24, 2048
buffer_store_dwordx4 v[28:31], v5, s[8:11], s25 offen
v_dot2c_f32_bf16 v40, v28, v44
v_dot2c_f32_bf16 v41, v28, v28
v_dot2c_f32_bf16 v40, v29, v44
v_dot2c_f32_bf16 v41, v29, v29
v_dot2c_f32_bf16 v40, v30, v44
v_dot2c_f32_bf16 v41, v30, v30
v_dot2c_f32_bf16 v40, v31, v44
v_dot2c_f32_bf16 v41, v31, v31
s_waitcnt vmcnt(4)
s_add_u32 s25, s24, 3072
buffer_store_dwordx4 v[32:35], v5, s[8:11], s25 offen
v_dot2c_f32_bf16 v40, v32, v44
v_dot2c_f32_bf16 v41, v32, v32
v_dot2c_f32_bf16 v40, v33, v44
v_dot2c_f32_bf16 v41, v33, v33
v_dot2c_f32_bf16 v40, v34, v44
v_dot2c_f32_bf16 v41, v34, v34
v_dot2c_f32_bf16 v40, v35, v44
v_dot2c_f32_bf16 v41, v35, v35
s_waitcnt vmcnt(4)
s_add_u32 s25, s24, 16384
buffer_store_dwordx4 v[36:39], v5, s[8:11], s25 offen
v_dot2c_f32_bf16 v40, v36, v44
v_dot2c_f32_bf16 v41, v36, v36
v_dot2c_f32_bf16 v40, v37, v44
v_dot2c_f32_bf16 v41, v37, v37
v_dot2c_f32_bf16 v40, v38, v44
v_dot2c_f32_bf16 v41, v38, v38
v_dot2c_f32_bf16 v40, v39, v44
v_dot2c_f32_bf16 v41, v39, v39
s_branch PX_J
PX_0:
s_cmp_eq_u32 s20, 1
s_cbranch_scc0 PX_1
buffer_load_dwordx4 v[20:23], v14, s[12:15], s23 offen offset:288
buffer_load_dwordx4 v[24:27], v14, s[12:15], s23 offen offset:352
buffer_load_dwordx4 v[28:31], v14, s[12:15], s23 offen offset:432
buffer_load_dwordx4 v[32:35], v14, s[12:15], s23 offen offset:496
buffer_load_dwordx4 v[36:39], v15, s[12:15], s23 offen offset:576
s_waitcnt vmcnt(4)
s_add_u32 s25, s24, 4096
buffer_store_dwordx4 v[20:23], v5, s[8:11], s25 offen
v_dot2c_f32_bf16 v40, v20, v44
v_dot2c_f32_bf16 v41, v20, v20
v_dot2c_f32_bf16 v40, v21, v44
v_dot2c_f32_bf16 v41, v21, v21
v_dot2c_f32_bf16 v40, v22, v44
v_dot2c_f32_bf16 v41, v22, v22
v_dot2c_f32_bf16 v40, v23, v44
v_dot2c_f32_bf16 v41, v23, v23
s_waitcnt vmcnt(4)
s_add_u32 s25, s24, 5120
buffer_store_dwordx4 v[24:27], v5, s[8:11], s25 offen
v_dot2c_f32_bf16 v40, v24, v44
v_dot2c_f32_bf16 v41, v24, v24
v_dot2c_f32_bf16 v40, v25, v44
v_dot2c_f32_bf16 v41, v25, v25
v_dot2c_f32_bf16 v40, v26, v44
v_dot2c_f32_bf16 v41, v26, v26
v_dot2c_f32_bf16 v40, v27, v44
v_dot2c_f32_bf16 v41, v27, v27
s_waitcnt vmcnt(4)
s_add_u32 s25, s24, 6144
buffer_store_dwordx4 v[28:31], v5, s[8:11], s25 offen
v_dot2c_f32_bf16 v40, v28, v44
v_dot2c_f32_bf16 v41, v28, v28
v_dot2c_f32_bf16 v40, v29, v44
v_dot2c_f32_bf16 v41, v29, v29
v_dot2c_f32_bf16 v40, v30, v44
v_dot2c_f32_bf16 v41, v30, v30
v_dot2c_f32_bf16 v40, v31, v44
v_dot2c_f32_bf16 v41, v31, v31
s_waitcnt vmcnt(4)
s_add_u32 s25, s24, 7168
buffer_store_dwordx4 v[32:35], v5, s[8:11], s25 offen
v_dot2c_f32_bf16 v40, v32, v44
v_dot2c_f32_bf16 v41, v32, v32
v_dot2c_f32_bf16 v40, v33, v44
v_dot2c_f32_bf16 v41, v33, v33
v_dot2c_f32_bf16 v40, v34, v44
v_dot2c_f32_bf16 v41, v34, v34
v_dot2c_f32_bf16 v40, v35, v44
v_dot2c_f32_bf16 v41, v35, v35
s_waitcnt vmcnt(4)
s_add_u32 s25, s24, 17408
buffer_store_dwordx4 v[36:39], v5, s[8:11], s25 offen
v_dot2c_f32_bf16 v40, v36, v44
v_dot2c_f32_bf16 v41, v36, v36
v_dot2c_f32_bf16 v40, v37, v44
v_dot2c_f32_bf16 v41, v37, v37
v_dot2c_f32_bf16 v40, v38, v44
v_dot2c_f32_bf16 v41, v38, v38
v_dot2c_f32_bf16 v40, v39, v44
v_dot2c_f32_bf16 v41, v39, v39
s_branch PX_J
PX_1:
s_cmp_eq_u32 s20, 2
s_cbranch_scc0 PX_2
buffer_load_dwordx4 v[20:23], v14, s[12:15], s23 offen offset:576
buffer_load_dwordx4 v[24:27], v14, s[12:15], s23 offen offset:640
buffer_load_dwordx4 v[28:31], v14, s[12:15], s23 offen offset:720
buffer_load_dwordx4 v[32:35], v14, s[12:15], s23 offen offset:784
s_waitcnt vmcnt(3)
s_add_u32 s25, s24, 8192
buffer_store_dwordx4 v[20:23], v5, s[8:11], s25 offen
v_dot2c_f32_bf16 v40, v20, v44
v_dot2c_f32_bf16 v41, v20, v20
v_dot2c_f32_bf16 v40, v21, v44
v_dot2c_f32_bf16 v41, v21, v21
v_dot2c_f32_bf16 v40, v22, v44
v_dot2c_f32_bf16 v41, v22, v22
v_dot2c_f32_bf16 v40, v23, v44
v_dot2c_f32_bf16 v41, v23, v23
s_waitcnt vmcnt(3)
s_add_u32 s25, s24, 9216
buffer_store_dwordx4 v[24:27], v5, s[8:11], s25 offen
v_dot2c_f32_bf16 v40, v24, v44
v_dot2c_f32_bf16 v41, v24, v24
v_dot2c_f32_bf16 v40, v25, v44
v_dot2c_f32_bf16 v41, v25, v25
v_dot2c_f32_bf16 v40, v26, v44
v_dot2c_f32_bf16 v41, v26, v26
v_dot2c_f32_bf16 v40, v27, v44
v_dot2c_f32_bf16 v41, v27, v27
s_waitcnt vmcnt(3)
s_add_u32 s25, s24, 10240
buffer_store_dwordx4 v[28:31], v5, s[8:11], s25 offen
v_dot2c_f32_bf16 v40, v28, v44
v_dot2c_f32_bf16 v41, v28, v28
v_dot2c_f32_bf16 v40, v29, v44
v_dot2c_f32_bf16 v41, v29, v29
v_dot2c_f32_bf16 v40, v30, v44
v_dot2c_f32_bf16 v41, v30, v30
v_dot2c_f32_bf16 v40, v31, v44
v_dot2c_f32_bf16 v41, v31, v31
s_waitcnt vmcnt(3)
s_add_u32 s25, s24, 11264
buffer_store_dwordx4 v[32:35], v5, s[8:11], s25 offen
v_dot2c_f32_bf16 v40, v32, v44
v_dot2c_f32_bf16 v41, v32, v32
v_dot2c_f32_bf16 v40, v33, v44
v_dot2c_f32_bf16 v41, v33, v33
v_dot2c_f32_bf16 v40, v34, v44
v_dot2c_f32_bf16 v41, v34, v34
v_dot2c_f32_bf16 v40, v35, v44
v_dot2c_f32_bf16 v41, v35, v35
s_branch PX_J
PX_2:
buffer_load_dwordx4 v[20:23], v14, s[12:15], s23 offen offset:864
buffer_load_dwordx4 v[24:27], v14, s[12:15], s23 offen offset:928
buffer_load_dwordx4 v[28:31], v14, s[12:15], s23 offen offset:1008
buffer_load_dwordx4 v[32:35], v14, s[12:15], s23 offen offset:1072
s_waitcnt vmcnt(3)
s_add_u32 s25, s24, 12288
buffer_store_dwordx4 v[20:23], v5, s[8:11], s25 offen
v_dot2c_f32_bf16 v40, v20, v44
v_dot2c_f32_bf16 v41, v20, v20
v_dot2c_f32_bf16 v40, v21, v44
v_dot2c_f32_bf16 v41, v21, v21
v_dot2c_f32_bf16 v40, v22, v44
v_dot2c_f32_bf16 v41, v22, v22
v_dot2c_f32_bf16 v40, v23, v44
v_dot2c_f32_bf16 v41, v23, v23
s_waitcnt vmcnt(3)
s_add_u32 s25, s24, 13312
buffer_store_dwordx4 v[24:27], v5, s[8:11], s25 offen
v_dot2c_f32_bf16 v40, v24, v44
v_dot2c_f32_bf16 v41, v24, v24
v_dot2c_f32_bf16 v40, v25, v44
v_dot2c_f32_bf16 v41, v25, v25
v_dot2c_f32_bf16 v40, v26, v44
v_dot2c_f32_bf16 v41, v26, v26
v_dot2c_f32_bf16 v40, v27, v44
v_dot2c_f32_bf16 v41, v27, v27
s_waitcnt vmcnt(3)
s_add_u32 s25, s24, 14336
buffer_store_dwordx4 v[28:31], v5, s[8:11], s25 offen
v_dot2c_f32_bf16 v40, v28, v44
v_dot2c_f32_bf16 v41, v28, v28
v_dot2c_f32_bf16 v40, v29, v44
v_dot2c_f32_bf16 v41, v29, v29
v_dot2c_f32_bf16 v40, v30, v44
v_dot2c_f32_bf16 v41, v30, v30
v_dot2c_f32_bf16 v40, v31, v44
v_dot2c_f32_bf16 v41, v31, v31
s_waitcnt vmcnt(3)
s_add_u32 s25, s24, 15360
buffer_store_dwordx4 v[32:35], v5, s[8:11], s25 offen
v_dot2c_f32_bf16 v40, v32, v44
v_dot2c_f32_bf16 v41, v32, v32
v_dot2c_f32_bf16 v40, v33, v44
v_dot2c_f32_bf16 v41, v33, v33
v_dot2c_f32_bf16 v40, v34, v44
v_dot2c_f32_bf16 v41, v34, v34
v_dot2c_f32_bf16 v40, v35, v44
v_dot2c_f32_bf16 v41, v35, v35
PX_J:
s_nop 1
v_mov_b32 v45, v40
s_nop 1
v_permlane16_swap_b32 v40, v45
s_nop 0
v_add_f32 v40, v40, v45
v_mov_b32 v45, v40
s_nop 1
v_permlane32_swap_b32 v40, v45
s_nop 0
v_add_f32 v40, v40, v45
v_mov_b32 v45, v41
s_nop 1
v_permlane16_swap_b32 v41, v45
s_nop 0
v_add_f32 v41, v41, v45
v_mov_b32 v45, v41
s_nop 1
v_permlane32_swap_b32 v41, v45
s_nop 0
v_add_f32 v41, v41, v45
s_lshl_b32 s25, s20, 8
s_add_u32 s25, s25, s24
s_add_u32 s25, s25, 18432
s_add_u32 s26, s25, 1024
v_mov_b32 v46, 0
v_mov_b32 v47, 0
v_mov_b32 v48, 0
v_mov_b32 v49, 0
s_mov_b64 exec, 0xffff
buffer_store_dwordx4 v[40:43], v5, s[8:11], s25 offen
buffer_store_dwordx4 v[46:49], v5, s[8:11], s26 offen
s_mov_b64 exec, -1
P_CLR:
v_lshlrev_b32 v6, 4, v0
v_mov_b32 v8, -1
v_mov_b32 v9, -1
v_mov_b32 v10, -1
v_mov_b32 v11, -1
s_lshl_b32 s21, s2, 1
s_add_u32 s21, s21, 0
s_lshl_b32 s22, s21, 12
s_mov_b32 s23, 8372224
s_cmp_ge_u32 s21, 640
s_cselect_b32 s23, 13615104, s23
s_cmp_ge_u32 s21, 1296
s_cselect_b32 s23, 20692992, s23
s_add_u32 s22, s22, s23
s_cmp_ge_u32 s21, 1808
s_cbranch_scc1 PC_0
buffer_store_dwordx4 v[8:11], v6, s[8:11], s22 offen
PC_0:
s_lshl_b32 s21, s2, 1
s_add_u32 s21, s21, 1
s_lshl_b32 s22, s21, 12
s_mov_b32 s23, 8372224
s_cmp_ge_u32 s21, 640
s_cselect_b32 s23, 13615104, s23
s_cmp_ge_u32 s21, 1296
s_cselect_b32 s23, 20692992, s23
s_add_u32 s22, s22, s23
s_cmp_ge_u32 s21, 1808
s_cbranch_scc1 PC_1
buffer_store_dwordx4 v[8:11], v6, s[8:11], s22 offen
PC_1:
s_endpgm
P_END:
s_endpgm
.section .rodata,"a"
.p2align 6
.amdhsa_kernel prep_kernel
  .amdhsa_next_free_vgpr 112
  .amdhsa_next_free_sgpr 96
  .amdhsa_accum_offset 112
  .amdhsa_group_segment_fixed_size 0
  .amdhsa_kernarg_size 80
  .amdhsa_user_sgpr_count 2
  .amdhsa_user_sgpr_kernarg_segment_ptr 1
  .amdhsa_system_sgpr_workgroup_id_x 1
  .amdhsa_float_denorm_mode_32 3
.end_amdhsa_kernel
.text
.globl main_kernel
.p2align 8
.type main_kernel,@function
main_kernel:
s_cmp_ge_u32 s2, 256
s_cbranch_scc1 M_END
s_load_dwordx2 s[4:5], s[0:1], 72
s_load_dwordx2 s[6:7], s[0:1], 56
s_load_dwordx2 s[32:33], s[0:1], 64
s_load_dwordx2 s[34:35], s[0:1], 0
v_and_b32 v4, 63, v0
v_lshlrev_b32 v1, 4, v4
v_and_b32 v2, 15, v0
v_bfe_u32 v3, v0, 4, 2
v_lshrrev_b32 v5, 6, v0
s_nop 0
v_readfirstlane_b32 s20, v5
s_and_b32 s36, s2, 7
s_lshr_b32 s37, s2, 3
s_lshr_b32 s38, s37, 4
s_lshl_b32 s21, s36, 1
s_add_u32 s21, s21, s38
s_and_b32 s22, s37, 15
s_lshl_b32 s25, s20, 10
s_mul_i32 s36, s22, 129024
s_add_u32 s36, s36, s25
s_add_u32 s64, s36, 0
s_add_u32 s65, s36, 2064384
s_lshl_b32 s36, s21, 3
s_add_u32 s36, s36, s20
s_mul_i32 s70, s36, 20480
s_add_u32 s45, s70, 5750784
s_mov_b32 s24, 0
s_mov_b32 s23, 1
s_waitcnt lgkmcnt(0)
s_mov_b32 s8, s4
s_and_b32 s9, s5, 0xffff
s_mov_b32 s10, 28098560
s_mov_b32 s11, 0x20000
s_mov_b32 s16, s32
s_and_b32 s17, s33, 0xffff
s_mov_b32 s18, 256
s_mov_b32 s19, 0x20000
s_getreg_b32 s26, hwreg(HW_REG_XCC_ID, 0, 4)
s_and_b32 s26, s26, 7
s_cmp_eq_u32 s20, 5
s_cbranch_scc0 SA_1
s_lshl_b32 s38, s26, 3
s_lshl_b64 s[36:37], 1, s38
v_mov_b32 v224, s36
v_mov_b32 v225, s37
s_lshl_b32 s36, s21, 3
v_mov_b32 v226, 0
s_mov_b64 exec, 1
buffer_atomic_add_x2 v[224:225], v226, s[16:19], s36 offen sc1
s_mov_b64 exec, -1
SA_1:
s_add_u32 s40, s45, 16384
buffer_load_dwordx4 v[16:19], v1, s[8:11], s40 offen offset:0
s_add_u32 m0, s25, 0
s_add_u32 s40, s64, 92160
buffer_load_dwordx4 v1, s[8:11], s40 offen lds
s_add_u32 m0, s25, 36864
s_add_u32 s40, s64, 0
buffer_load_dwordx4 v1, s[8:11], s40 offen lds
s_add_u32 m0, s25, 45056
s_add_u32 s40, s64, 8192
buffer_load_dwordx4 v1, s[8:11], s40 offen lds
s_add_u32 m0, s25, 53248
s_add_u32 s40, s64, 16384
buffer_load_dwordx4 v1, s[8:11], s40 offen lds
s_add_u32 s40, s45, 16384
buffer_load_dwordx4 v[20:23], v1, s[8:11], s40 offen offset:1024
buffer_load_dwordx4 v[24:27], v1, s[8:11], s45 offen offset:0
buffer_load_dwordx4 v[28:31], v1, s[8:11], s45 offen offset:1024
s_add_u32 m0, s25, 61440
s_add_u32 s40, s64, 24576
buffer_load_dwordx4 v1, s[8:11], s40 offen lds
s_add_u32 m0, s25, 69632
s_add_u32 s40, s64, 32768
buffer_load_dwordx4 v1, s[8:11], s40 offen lds
s_add_u32 m0, s25, 8192
s_add_u32 s40, s64, 100352
buffer_load_dwordx4 v1, s[8:11], s40 offen lds
buffer_load_dwordx4 v[32:35], v1, s[8:11], s45 offen offset:2048
s_mov_b32 s60, s34
s_and_b32 s61, s35, 0xffff
s_mov_b32 s62, 2359296
s_mov_b32 s63, 0x20000
s_mov_b32 s12, s6
s_and_b32 s13, s7, 0xffff
s_mov_b32 s14, 2359296
s_mov_b32 s15, 0x20000
v_add_u32 v248, 0x10000, v1
v_add_u32 v249, 0x20000, v1
s_lshr_b32 s27, s22, 3
s_and_b32 s28, s22, 7
s_and_b32 s29, s20, 3
s_lshr_b32 s30, s20, 2
s_mul_i32 s36, s28, 82944
s_add_u32 s36, s36, s25
s_add_u32 s66, s36, 4423680
s_add_u32 s67, s36, 5087232
s_lshl_b32 s36, s21, 3
s_lshl_b32 s37, s27, 2
s_add_u32 s36, s36, s37
s_add_u32 s36, s36, s29
s_mul_i32 s93, s36, 20480
s_mul_i32 s71, s36, 18432
s_lshl_b32 s37, s28, 1
s_add_u32 s37, s37, s30
s_lshl_b32 s37, s37, 10
s_add_u32 s90, s93, s37
s_lshr_b32 s37, s28, 2
s_lshl_b32 s37, s37, 10
s_and_b32 s38, s28, 3
s_lshl_b32 s38, s38, 8
s_add_u32 s37, s37, s38
s_add_u32 s37, s37, s93
s_add_u32 s91, s37, 16384
s_lshl_b32 s38, s30, 3
s_add_u32 s37, s37, s38
s_add_u32 s92, s37, 18432
v_lshlrev_b32 v202, 4, v2
v_lshl_add_u32 v7, v3, 3, v202
s_mov_b32 s76, 0x22222222
s_mov_b32 s77, 0x22222222
s_mov_b32 s78, 0x44444444
s_mov_b32 s79, 0x44444444
s_mov_b32 s80, 0x88888888
s_mov_b32 s81, 0x88888888
s_mov_b32 s82, 0x00f0000f
s_mov_b32 s83, 0xf0000f00
s_lshl_b32 s37, s30, 4
s_lshl_b64 s[72:73], 0xffff, s37
s_xor_b32 s37, s37, 16
s_lshl_b64 s[74:75], 0xffff, s37
s_lshl_b32 s36, s21, 3
s_add_u32 s36, s36, s20
s_mul_i32 s36, s36, 18432
s_lshl_b32 s37, s22, 10
s_add_u32 s68, s36, s37
s_lshr_b32 s37, s22, 3
s_add_u32 s37, s37, 16
s_lshl_b32 s37, s37, 10
s_add_u32 s36, s36, s37
s_bfe_u32 s37, s22, 0x20001
s_lshl_b32 s37, s37, 8
s_add_u32 s36, s36, s37
s_and_b32 s37, s22, 1
s_lshl_b32 s37, s37, 3
s_add_u32 s69, s36, s37
v_lshrrev_b32 v5, 3, v4
v_lshlrev_b32 v5, 10, v5
v_bfe_u32 v6, v4, 1, 2
v_lshl_add_u32 v5, v6, 8, v5
v_and_b32 v6, 1, v4
v_lshl_add_u32 v5, v6, 3, v5
v_add_u32 v246, 18672, v5
v_lshrrev_b32 v5, 2, v4
v_lshlrev_b32 v5, 8, v5
v_and_b32 v6, 3, v4
v_lshl_add_u32 v5, v6, 2, v5
v_add_u32 v247, 240, v5
v_mov_b32 v236, 0x3f803f80
v_mov_b32 v237, 0x3f803f80
v_mov_b32 v238, 0x3f803f80
v_mov_b32 v239, 0x3f803f80
s_lshl_b32 s36, s20, 2
s_add_u32 s36, s36, 163008
v_mov_b32 v203, s36
v_and_b32 v5, 7, v4
v_lshlrev_b32 v5, 2, v5
v_add_u32 v240, 163008, v5
s_mov_b32 s97, 0
v_mov_b32 v5, 0
ds_write_b32 v203, v5
v_lshlrev_b32 v241, 4, v3
v_add_u32 v241, 161792, v241
s_waitcnt vmcnt(7)
s_waitcnt lgkmcnt(0)
s_barrier
ds_read_b128 v[116:119], v1 offset:36864
ds_read_b128 v[120:123], v1 offset:37888
ds_read_b128 v[124:127], v1 offset:38912
ds_read_b128 v[128:131], v1 offset:39936
ds_read_b128 v[132:135], v1 offset:40960
ds_read_b128 v[136:139], v1 offset:0
ds_read_b128 v[140:143], v1 offset:1024
ds_read_b128 v[144:147], v1 offset:41984
ds_read_b128 v[148:151], v1 offset:43008
ds_read_b128 v[152:155], v1 offset:44032
ds_read_b128 v[156:159], v1 offset:45056
ds_read_b128 v[160:163], v1 offset:46080
ds_read_b128 v[164:167], v1 offset:2048
ds_read_b128 v[168:171], v1 offset:3072
v_mov_b32 v172, 0
v_mov_b32 v173, 0
v_mov_b32 v174, 0
v_mov_b32 v175, 0
v_mov_b32 v176, 0
v_mov_b32 v177, 0
v_mov_b32 v178, 0
v_mov_b32 v179, 0
v_mov_b32 v180, 0
v_mov_b32 v181, 0
v_mov_b32 v182, 0
v_mov_b32 v183, 0
v_mov_b32 v184, 0
v_mov_b32 v185, 0
v_mov_b32 v186, 0
v_mov_b32 v187, 0
v_mov_b32 v188, 0
v_mov_b32 v189, 0
v_mov_b32 v190, 0
v_mov_b32 v191, 0
v_mov_b32 v192, 0
v_mov_b32 v193, 0
v_mov_b32 v194, 0
v_mov_b32 v195, 0
v_mov_b32 v196, 0
v_mov_b32 v197, 0
v_mov_b32 v198, 0
v_mov_b32 v199, 0
s_waitcnt vmcnt(11)
s_waitcnt lgkmcnt(13)
v_mfma_f32_16x16x32_bf16 v[172:175], v[116:119], v[16:19], v[172:175]
ds_read_b128 v[116:119], v1 offset:47104
v_min_u32 v224, 399, v0
v_cmp_le_u32 vcc, 200, v224
buffer_load_dwordx4 v[36:39], v1, s[8:11], s45 offen offset:3072
s_waitcnt lgkmcnt(13)
v_mfma_f32_16x16x32_bf16 v[176:179], v[120:123], v[16:19], v[176:179]
ds_read_b128 v[120:123], v1 offset:48128
v_cndmask_b32 v225, 0, 1, vcc
v_mul_u32_u24 v226, 200, v225
s_waitcnt lgkmcnt(13)
v_mfma_f32_16x16x32_bf16 v[180:183], v[124:127], v[16:19], v[180:183]
ds_read_b128 v[124:127], v1 offset:49152
v_sub_u32 v226, v224, v226
v_mul_u32_u24 v227, 3277, v226
s_waitcnt lgkmcnt(13)
v_mfma_f32_16x16x32_bf16 v[184:187], v[128:131], v[16:19], v[184:187]
ds_read_b128 v[128:131], v1 offset:50176
v_lshrrev_b32 v227, 16, v227
v_mul_u32_u24 v228, 20, v227
s_waitcnt lgkmcnt(13)
v_mfma_f32_16x16x32_bf16 v[188:191], v[132:135], v[16:19], v[188:191]
ds_read_b128 v[132:135], v1 offset:51200
v_sub_u32 v228, v226, v228
v_cmp_le_u32 vcc, 5, v227
s_waitcnt lgkmcnt(13)
v_mfma_f32_16x16x32_bf16 v[192:195], v[136:139], v[16:19], v[192:195]
ds_read_b128 v[136:139], v1 offset:4096
v_cndmask_b32 v229, 0, 1, vcc
v_mul_u32_u24 v230, 5, v229
s_waitcnt vmcnt(7)
s_waitcnt lgkmcnt(13)
v_mfma_f32_16x16x32_bf16 v[196:199], v[140:143], v[16:19], v[196:199]
ds_read_b128 v[140:143], v1 offset:5120
v_sub_u32 v230, v227, v230
v_cmp_le_u32 vcc, 10, v228
s_add_u32 m0, s25, 16384
s_add_u32 s40, s64, 108544
buffer_load_dwordx4 v1, s[8:11], s40 offen lds
s_waitcnt lgkmcnt(13)
v_mfma_f32_16x16x32_bf16 v[172:175], v[144:147], v[20:23], v[172:175]
ds_read_b128 v[144:147], v1 offset:52224
v_cndmask_b32 v231, 0, 1, vcc
v_mul_u32_u24 v232, 10, v231
s_add_u32 s40, s45, 4096
buffer_load_dwordx4 v[40:43], v1, s[8:11], s40 offen offset:0
s_waitcnt lgkmcnt(13)
v_mfma_f32_16x16x32_bf16 v[176:179], v[148:151], v[20:23], v[176:179]
ds_read_b128 v[148:151], v1 offset:53248
v_sub_u32 v232, v228, v232
v_lshrrev_b32 v233, 2, v232
s_waitcnt lgkmcnt(13)
v_mfma_f32_16x16x32_bf16 v[180:183], v[152:155], v[20:23], v[180:183]
ds_read_b128 v[152:155], v1 offset:54272
v_mul_u32_u24 v233, 3, v233
v_lshrrev_b32 v234, 1, v230
s_waitcnt lgkmcnt(13)
v_mfma_f32_16x16x32_bf16 v[184:187], v[156:159], v[20:23], v[184:187]
ds_read_b128 v[156:159], v1 offset:55296
v_add_u32 v233, v233, v234
v_lshl_add_u32 v234, v225, 1, v229
s_waitcnt lgkmcnt(13)
v_mfma_f32_16x16x32_bf16 v[188:191], v[160:163], v[20:23], v[188:191]
ds_read_b128 v[160:163], v1 offset:56320
v_lshl_add_u32 v235, v225, 1, v231
v_and_b32 v232, 3, v232
s_waitcnt lgkmcnt(13)
v_mfma_f32_16x16x32_bf16 v[192:195], v[164:167], v[20:23], v[192:195]
ds_read_b128 v[164:167], v1 offset:6144
v_lshl_add_u32 v235, v235, 2, v232
v_lshl_add_u32 v235, v234, 4, v235
s_waitcnt vmcnt(8)
s_waitcnt lgkmcnt(13)
v_mfma_f32_16x16x32_bf16 v[196:199], v[168:171], v[20:23], v[196:199]
ds_read_b128 v[168:171], v1 offset:7168
v_lshlrev_b32 v233, 10, v233
v_lshl_add_u32 v233, v235, 4, v233
s_add_u32 m0, s25, 77824
s_add_u32 s40, s64, 40960
buffer_load_dwordx4 v1, s[8:11], s40 offen lds
s_waitcnt vmcnt(5)
s_barrier
s_waitcnt lgkmcnt(13)
v_mfma_f32_16x16x32_bf16 v[172:175], v[116:119], v[24:27], v[172:175]
ds_read_b128 v[116:119], v1 offset:57344
v_and_b32 v230, 1, v230
v_lshl_add_u32 v233, v230, 3, v233
s_add_u32 s40, s45, 4096
buffer_load_dwordx4 v[44:47], v1, s[8:11], s40 offen offset:1024
s_waitcnt lgkmcnt(13)
v_mfma_f32_16x16x32_bf16 v[176:179], v[120:123], v[24:27], v[176:179]
ds_read_b128 v[120:123], v1 offset:58368
v_add_u32 v255, 152576, v233
v_lshlrev_b32 v254, 3, v224
s_waitcnt lgkmcnt(13)
v_mfma_f32_16x16x32_bf16 v[180:183], v[124:127], v[24:27], v[180:183]
ds_read_b128 v[124:127], v1 offset:59392
v_lshlrev_b32 v235, 4, v0
v_mov_b32 v224, 0
s_waitcnt lgkmcnt(13)
v_mfma_f32_16x16x32_bf16 v[184:187], v[128:131], v[24:27], v[184:187]
ds_read_b128 v[128:131], v1 offset:60416
v_mov_b32 v225, 0
v_mov_b32 v226, 0
s_waitcnt lgkmcnt(13)
v_mfma_f32_16x16x32_bf16 v[188:191], v[132:135], v[24:27], v[188:191]
ds_read_b128 v[132:135], v1 offset:61440
v_mov_b32 v227, 0
v_add_u32 v235, 152576, v235
s_waitcnt lgkmcnt(13)
v_mfma_f32_16x16x32_bf16 v[192:195], v[136:139], v[24:27], v[192:195]
ds_read_b128 v[136:139], v1 offset:8192
ds_write_b128 v235, v[224:227]
v_add_u32 v235, 160768, v1
s_waitcnt vmcnt(9)
s_waitcnt lgkmcnt(13)
v_mfma_f32_16x16x32_bf16 v[196:199], v[140:143], v[24:27], v[196:199]
ds_read_b128 v[140:143], v1 offset:9216
ds_write_b128 v235, v[224:227]
v_lshrrev_b32 v224, 5, v4
s_add_u32 m0, s25, 86016
s_add_u32 s40, s64, 49152
buffer_load_dwordx4 v1, s[8:11], s40 offen lds
s_waitcnt lgkmcnt(13)
v_mfma_f32_16x16x32_bf16 v[172:175], v[144:147], v[28:31], v[172:175]
ds_read_b128 v[144:147], v1 offset:62464
v_bfe_u32 v225, v4, 3, 2
v_bfe_u32 v226, v4, 2, 1
s_add_u32 s40, s45, 4096
buffer_load_dwordx4 v[48:51], v1, s[8:11], s40 offen offset:2048
s_waitcnt lgkmcnt(13)
v_mfma_f32_16x16x32_bf16 v[176:179], v[148:151], v[28:31], v[176:179]
ds_read_b128 v[148:151], v1 offset:63488
v_and_b32 v227, 3, v4
s_and_b32 s52, s20, 3
s_waitcnt lgkmcnt(13)
v_mfma_f32_16x16x32_bf16 v[180:183], v[152:155], v[28:31], v[180:183]
ds_read_b128 v[152:155], v1 offset:64512
s_lshl_b32 s52, s52, 5
v_lshl_add_u32 v228, v225, 3, v226
s_waitcnt lgkmcnt(13)
v_mfma_f32_16x16x32_bf16 v[184:187], v[156:159], v[28:31], v[184:187]
ds_read_b128 v[156:159], v248 offset:0
v_add_u32 v228, s52, v228
v_lshl_add_u32 v229, v227, 1, v228
s_waitcnt lgkmcnt(13)
v_mfma_f32_16x16x32_bf16 v[188:191], v[160:163], v[28:31], v[188:191]
ds_read_b128 v[160:163], v248 offset:1024
v_mul_u32_u24 v229, 40, v229
v_mul_u32_u24 v230, 5760, v224
s_waitcnt lgkmcnt(13)
v_mfma_f32_16x16x32_bf16 v[192:195], v[164:167], v[28:31], v[192:195]
ds_read_b128 v[164:167], v1 offset:10240
v_add_u32 v216, v229, v230
v_add_u32 v216, 92160, v216
s_waitcnt vmcnt(7)
s_waitcnt lgkmcnt(13)
v_mfma_f32_16x16x32_bf16 v[196:199], v[168:171], v[28:31], v[196:199]
ds_read_b128 v[168:171], v1 offset:11264
v_bfe_u32 v232, v4, 2, 2
v_and_b32 v233, 3, v4
s_add_u32 m0, s25, 94208
s_add_u32 s40, s64, 57344
buffer_load_dwordx4 v1, s[8:11], s40 offen lds
s_bfe_u32 s50, s20, 0x10001
s_mul_i32 s51, s50, 147456
s_mul_i32 s36, s22, 9216
s_add_u32 s51, s51, s36
s_add_u32 s51, s51, 4128768
s_mul_i32 s36, s30, 4608
s_add_u32 s51, s51, s36
s_and_b32 s36, s20, 1
s_lshl_b32 s36, s36, 8
v_lshlrev_b32 v5, 2, v4
v_add_u32 v5, s36, v5
buffer_load_dword v96, v5, s[8:11], s51 offen offset:0
buffer_load_dword v97, v5, s[8:11], s51 offen offset:512
buffer_load_dword v98, v5, s[8:11], s51 offen offset:1024
buffer_load_dword v99, v5, s[8:11], s51 offen offset:1536
buffer_load_dword v100, v5, s[8:11], s51 offen offset:2048
buffer_load_dword v101, v5, s[8:11], s51 offen offset:2560
buffer_load_dword v102, v5, s[8:11], s51 offen offset:3072
buffer_load_dword v103, v5, s[8:11], s51 offen offset:3584
s_add_u32 s51, s51, 4096
buffer_load_dword v104, v5, s[8:11], s51 offen offset:0
s_waitcnt lgkmcnt(13)
v_mfma_f32_16x16x32_bf16 v[172:175], v[116:119], v[32:35], v[172:175]
ds_read_b128 v[116:119], v248 offset:2048
v_bfe_u32 v234, v4, 4, 1
v_lshrrev_b32 v229, 1, v233
s_add_u32 s40, s45, 4096
buffer_load_dwordx4 v[52:55], v1, s[8:11], s40 offen offset:3072
s_waitcnt lgkmcnt(13)
v_mfma_f32_16x16x32_bf16 v[176:179], v[120:123], v[32:35], v[176:179]
ds_read_b128 v[120:123], v248 offset:3072
v_lshl_add_u32 v229, v234, 1, v229
v_and_b32 v233, 1, v233
s_waitcnt lgkmcnt(13)
v_mfma_f32_16x16x32_bf16 v[180:183], v[124:127], v[32:35], v[180:183]
ds_read_b128 v[124:127], v248 offset:4096
v_lshl_add_u32 v229, v229, 3, v233
v_lshl_add_u32 v229, v232, 1, v229
s_waitcnt lgkmcnt(13)
v_mfma_f32_16x16x32_bf16 v[184:187], v[128:131], v[32:35], v[184:187]
ds_read_b128 v[128:131], v248 offset:5120
v_add_u32 v229, s52, v229
v_mul_u32_u24 v229, 40, v229
s_waitcnt lgkmcnt(13)
v_mfma_f32_16x16x32_bf16 v[188:191], v[132:135], v[32:35], v[188:191]
ds_read_b128 v[132:135], v248 offset:6144
v_add_u32 v229, v229, v230
v_add_u32 v217, 103680, v229
s_waitcnt lgkmcnt(13)
v_mfma_f32_16x16x32_bf16 v[192:195], v[136:139], v[32:35], v[192:195]
ds_read_b128 v[136:139], v1 offset:12288
s_lshl_b32 s53, s21, 7
v_add_u32 v231, s53, v228
s_waitcnt vmcnt(17)
s_waitcnt lgkmcnt(13)
v_mfma_f32_16x16x32_bf16 v[196:199], v[140:143], v[32:35], v[196:199]
ds_read_b128 v[140:143], v1 offset:13312
v_mov_b32 v229, 0xf149f2ca
v_mov_b32 v204, v229
s_add_u32 m0, s25, 24576
s_add_u32 s40, s64, 116736
buffer_load_dwordx4 v1, s[8:11], s40 offen lds
s_waitcnt lgkmcnt(13)
v_mfma_f32_16x16x32_bf16 v[172:175], v[144:147], v[36:39], v[172:175]
ds_read_b128 v[144:147], v248 offset:7168
v_cmp_ge_i32 vcc, 0, v227
v_cmp_le_i32 s[54:55], 14, v231
s_add_u32 s40, s45, 8192
buffer_load_dwordx4 v[56:59], v1, s[8:11], s40 offen offset:0
s_waitcnt lgkmcnt(13)
v_mfma_f32_16x16x32_bf16 v[176:179], v[148:151], v[36:39], v[176:179]
ds_read_b128 v[148:151], v248 offset:8192
s_and_b64 vcc, vcc, s[54:55]
v_cndmask_b32 v205, v229, 0, vcc
s_waitcnt lgkmcnt(13)
v_mfma_f32_16x16x32_bf16 v[180:183], v[152:155], v[36:39], v[180:183]
ds_read_b128 v[152:155], v248 offset:9216
v_cmp_ge_i32 vcc, 1, v227
v_cmp_le_i32 s[54:55], 12, v231
s_waitcnt lgkmcnt(13)
v_mfma_f32_16x16x32_bf16 v[184:187], v[156:159], v[36:39], v[184:187]
ds_read_b128 v[156:159], v248 offset:10240
s_and_b64 vcc, vcc, s[54:55]
v_cndmask_b32 v206, v229, 0, vcc
s_waitcnt lgkmcnt(13)
v_mfma_f32_16x16x32_bf16 v[188:191], v[160:163], v[36:39], v[188:191]
ds_read_b128 v[160:163], v248 offset:11264
v_cmp_ge_i32 vcc, 2, v227
v_cmp_le_i32 s[54:55], 10, v231
s_waitcnt lgkmcnt(13)
v_mfma_f32_16x16x32_bf16 v[192:195], v[164:167], v[36:39], v[192:195]
ds_read_b128 v[164:167], v1 offset:14336
s_and_b64 vcc, vcc, s[54:55]
v_cndmask_b32 v207, v229, 0, vcc
s_waitcnt vmcnt(17)
s_waitcnt lgkmcnt(13)
v_mfma_f32_16x16x32_bf16 v[196:199], v[168:171], v[36:39], v[196:199]
ds_read_b128 v[168:171], v1 offset:15360
v_cmp_ge_i32 vcc, 3, v227
v_cmp_le_i32 s[54:55], 8, v231
s_cmp_eq_u32 s20, 2
s_cbranch_scc0 MI_2
s_lshl_b32 s36, s21, 3
v_mov_b32 v5, 0
buffer_load_dwordx2 v[232:233], v5, s[16:19], s36 offen sc1
MI_2:
s_add_u32 m0, s25, 102400
s_add_u32 s40, s64, 65536
buffer_load_dwordx4 v1, s[8:11], s40 offen lds
s_waitcnt vmcnt(13)
s_barrier
s_waitcnt lgkmcnt(13)
v_mfma_f32_16x16x32_bf16 v[172:175], v[116:119], v[40:43], v[172:175]
ds_read_b128 v[116:119], v248 offset:12288
s_and_b64 vcc, vcc, s[54:55]
v_cndmask_b32 v208, v229, 0, vcc
s_add_u32 s40, s45, 8192
buffer_load_dwordx4 v[60:63], v1, s[8:11], s40 offen offset:1024
s_waitcnt lgkmcnt(13)
v_mfma_f32_16x16x32_bf16 v[176:179], v[120:123], v[40:43], v[176:179]
ds_read_b128 v[120:123], v248 offset:13312
v_cmp_ge_i32 vcc, 4, v227
v_cmp_le_i32 s[54:55], 6, v231
s_waitcnt lgkmcnt(13)
v_mfma_f32_16x16x32_bf16 v[180:183], v[124:127], v[40:43], v[180:183]
ds_read_b128 v[124:127], v248 offset:14336
s_and_b64 vcc, vcc, s[54:55]
v_cndmask_b32 v209, v229, 0, vcc
s_waitcnt lgkmcnt(13)
v_mfma_f32_16x16x32_bf16 v[184:187], v[128:131], v[40:43], v[184:187]
ds_read_b128 v[128:131], v248 offset:15360
v_cmp_ge_i32 vcc, 5, v227
v_cmp_le_i32 s[54:55], 4, v231
s_waitcnt lgkmcnt(13)
v_mfma_f32_16x16x32_bf16 v[188:191], v[132:135], v[40:43], v[188:191]
ds_read_b128 v[132:135], v248 offset:16384
s_and_b64 vcc, vcc, s[54:55]
v_cndmask_b32 v210, v229, 0, vcc
s_waitcnt lgkmcnt(13)
v_mfma_f32_16x16x32_bf16 v[192:195], v[136:139], v[40:43], v[192:195]
ds_read_b128 v[136:139], v1 offset:16384
v_cmp_ge_i32 vcc, 6, v227
v_cmp_le_i32 s[54:55], 2, v231
s_waitcnt vmcnt(17)
s_waitcnt lgkmcnt(13)
v_mfma_f32_16x16x32_bf16 v[196:199], v[140:143], v[40:43], v[196:199]
ds_read_b128 v[140:143], v1 offset:17408
s_and_b64 vcc, vcc, s[54:55]
v_cndmask_b32 v211, v229, 0, vcc
s_add_u32 m0, s25, 110592
s_add_u32 s40, s64, 73728
buffer_load_dwordx4 v1, s[8:11], s40 offen lds
s_waitcnt lgkmcnt(13)
v_mfma_f32_16x16x32_bf16 v[172:175], v[144:147], v[44:47], v[172:175]
ds_read_b128 v[144:147], v248 offset:17408
v_cmp_ge_i32 vcc, 7, v227
s_nop 1
v_cndmask_b32 v212, v229, 0, vcc
s_add_u32 s40, s45, 8192
buffer_load_dwordx4 v[64:67], v1, s[8:11], s40 offen offset:2048
s_waitcnt lgkmcnt(13)
v_mfma_f32_16x16x32_bf16 v[176:179], v[148:151], v[44:47], v[176:179]
ds_read_b128 v[148:151], v248 offset:18432
v_cmp_ge_i32 vcc, 8, v227
v_cmp_le_i32 s[54:55], 1, v227
s_waitcnt lgkmcnt(13)
v_mfma_f32_16x16x32_bf16 v[180:183], v[152:155], v[44:47], v[180:183]
ds_read_b128 v[152:155], v248 offset:19456
s_and_b64 vcc, vcc, s[54:55]
v_cndmask_b32 v213, v229, 0, vcc
s_waitcnt lgkmcnt(13)
v_mfma_f32_16x16x32_bf16 v[184:187], v[156:159], v[44:47], v[184:187]
ds_read_b128 v[156:159], v248 offset:20480
v_cmp_ge_i32 vcc, 9, v227
v_cmp_le_i32 s[54:55], 2, v227
s_waitcnt lgkmcnt(13)
v_mfma_f32_16x16x32_bf16 v[188:191], v[160:163], v[44:47], v[188:191]
ds_read_b128 v[160:163], v248 offset:21504
s_and_b64 vcc, vcc, s[54:55]
v_cndmask_b32 v214, v229, 0, vcc
s_waitcnt lgkmcnt(13)
v_mfma_f32_16x16x32_bf16 v[192:195], v[164:167], v[44:47], v[192:195]
ds_read_b128 v[164:167], v1 offset:18432
v_cmp_ge_i32 vcc, 10, v227
v_cmp_le_i32 s[54:55], 3, v227
s_waitcnt vmcnt(17)
s_waitcnt lgkmcnt(13)
v_mfma_f32_16x16x32_bf16 v[196:199], v[168:171], v[44:47], v[196:199]
ds_read_b128 v[168:171], v1 offset:19456
s_and_b64 vcc, vcc, s[54:55]
v_cndmask_b32 v215, v229, 0, vcc
s_cmp_lt_u32 s20, 4
s_cbranch_scc0 DS_3
s_add_u32 m0, s25, 32768
s_add_u32 s40, s64, 124928
buffer_load_dwordx4 v1, s[8:11], s40 offen lds
DS_3:
s_waitcnt lgkmcnt(13)
v_mfma_f32_16x16x32_bf16 v[172:175], v[116:119], v[48:51], v[172:175]
ds_read_b128 v[116:119], v248 offset:22528
v_lshrrev_b32 v229, 1, v225
s_and_b32 s52, s20, 3
s_add_u32 s40, s45, 8192
buffer_load_dwordx4 v[68:71], v1, s[8:11], s40 offen offset:3072
s_waitcnt lgkmcnt(13)
v_mfma_f32_16x16x32_bf16 v[176:179], v[120:123], v[48:51], v[176:179]
ds_read_b128 v[120:123], v248 offset:23552
s_lshl_b32 s52, s52, 1
v_add_u32 v229, s52, v229
s_waitcnt lgkmcnt(13)
v_mfma_f32_16x16x32_bf16 v[180:183], v[124:127], v[48:51], v[180:183]
ds_read_b128 v[124:127], v248 offset:24576
s_movk_i32 s53, 18432
v_mul_lo_u32 v229, v229, s53
s_waitcnt lgkmcnt(13)
v_mfma_f32_16x16x32_bf16 v[184:187], v[128:131], v[48:51], v[184:187]
ds_read_b128 v[128:131], v248 offset:25600
v_and_b32 v230, 1, v225
v_lshlrev_b32 v230, 3, v230
s_waitcnt lgkmcnt(13)
v_mfma_f32_16x16x32_bf16 v[188:191], v[132:135], v[48:51], v[188:191]
ds_read_b128 v[132:135], v248 offset:26624
v_lshl_add_u32 v230, v227, 1, v230
v_add_u32 v230, v230, v226
s_waitcnt lgkmcnt(13)
v_mfma_f32_16x16x32_bf16 v[192:195], v[136:139], v[48:51], v[192:195]
ds_read_b128 v[136:139], v1 offset:20480
v_lshl_add_u32 v230, v230, 4, v229
v_lshl_add_u32 v218, v224, 9, v230
s_waitcnt vmcnt(7)
s_waitcnt lgkmcnt(13)
v_mfma_f32_16x16x32_bf16 v[196:199], v[140:143], v[48:51], v[196:199]
ds_read_b128 v[140:143], v1 offset:21504
v_lshl_add_u32 v219, v224, 2, v230
s_add_u32 m0, s25, 118784
s_add_u32 s40, s64, 81920
buffer_load_dwordx4 v1, s[8:11], s40 offen lds
s_waitcnt vmcnt(9)
v_add_f32 v96, v96, v97
v_add_f32 v98, v98, v99
v_add_f32 v100, v100, v101
v_add_f32 v102, v102, v103
v_add_f32 v96, v96, v98
v_add_f32 v100, v100, v102
v_add_f32 v96, v96, v104
v_add_f32 v96, v96, v100
s_bfe_u32 s34, s20, 0x10001
s_lshl_b32 s34, s34, 9
s_and_b32 s36, s20, 1
s_lshl_b32 s36, s36, 8
s_add_u32 s34, s34, s36
s_add_u32 s34, s34, 161792
v_lshlrev_b32 v97, 2, v4
v_add_u32 v97, s34, v97
s_cmp_lt_u32 s20, 4
s_cbranch_scc1 SS_4
ds_write_b32 v97, v96
SS_4:
s_waitcnt lgkmcnt(13)
v_mfma_f32_16x16x32_bf16 v[172:175], v[144:147], v[52:55], v[172:175]
ds_read_b128 v[144:147], v248 offset:27648
s_add_u32 s40, s45, 12288
buffer_load_dwordx4 v[72:75], v1, s[8:11], s40 offen offset:0
s_waitcnt lgkmcnt(13)
v_mfma_f32_16x16x32_bf16 v[176:179], v[148:151], v[52:55], v[176:179]
ds_read_b128 v[148:151], v248 offset:28672
s_waitcnt lgkmcnt(13)
v_mfma_f32_16x16x32_bf16 v[180:183], v[152:155], v[52:55], v[180:183]
ds_read_b128 v[152:155], v248 offset:29696
s_waitcnt lgkmcnt(13)
v_mfma_f32_16x16x32_bf16 v[184:187], v[156:159], v[52:55], v[184:187]
ds_read_b128 v[156:159], v248 offset:30720
s_waitcnt lgkmcnt(13)
v_mfma_f32_16x16x32_bf16 v[188:191], v[160:163], v[52:55], v[188:191]
ds_read_b128 v[160:163], v248 offset:31744
s_waitcnt lgkmcnt(13)
v_mfma_f32_16x16x32_bf16 v[192:195], v[164:167], v[52:55], v[192:195]
ds_read_b128 v[164:167], v1 offset:22528
s_waitcnt vmcnt(7)
s_waitcnt lgkmcnt(13)
v_mfma_f32_16x16x32_bf16 v[196:199], v[168:171], v[52:55], v[196:199]
ds_read_b128 v[168:171], v1 offset:23552
s_cmp_lt_u32 s20, 2
s_cbranch_scc0 DS_5
s_add_u32 m0, s25, 126976
s_add_u32 s40, s64, 90112
buffer_load_dwordx4 v1, s[8:11], s40 offen lds
DS_5:
s_cmp_eq_u32 s20, 2
s_cbranch_scc0 MD_6
s_waitcnt vmcnt(7)
s_mov_b32 s39, 20000
s_lshl_b32 s36, s21, 3
MP_7:
v_sad_u8 v234, v232, 0, 0
v_sad_u8 v234, v233, 0, v234
v_cmp_ne_u32 vcc, 16, v234
s_cbranch_vccz MX_8
s_sub_u32 s39, s39, 1
s_cbranch_scc1 MX_8
v_mov_b32 v5, 0
buffer_load_dwordx2 v[232:233], v5, s[16:19], s36 offen sc1
s_waitcnt vmcnt(0)
s_branch MP_7
MX_8:
v_readfirstlane_b32 s34, v232
v_readfirstlane_b32 s35, v233
s_lshl_b32 s36, s26, 3
s_lshr_b64 s[34:35], s[34:35], s36
s_and_b32 s34, s34, 0xff
s_cmp_eq_u32 s34, 16
s_cselect_b32 s34, 0, 1
v_mov_b32 v232, s34
v_mov_b32 v5, 162944
ds_write_b32 v5, v232
s_waitcnt lgkmcnt(0)
MD_6:
s_waitcnt vmcnt(4)
s_barrier
s_waitcnt lgkmcnt(13)
v_mfma_f32_16x16x32_bf16 v[172:175], v[116:119], v[56:59], v[172:175]
ds_read_b128 v[116:119], v248 offset:32768
s_add_u32 s40, s45, 12288
buffer_load_dwordx4 v[76:79], v1, s[8:11], s40 offen offset:1024
s_waitcnt lgkmcnt(13)
v_mfma_f32_16x16x32_bf16 v[176:179], v[120:123], v[56:59], v[176:179]
ds_read_b128 v[120:123], v248 offset:33792
s_waitcnt lgkmcnt(13)
v_mfma_f32_16x16x32_bf16 v[180:183], v[124:127], v[56:59], v[180:183]
ds_read_b128 v[124:127], v248 offset:34816
s_waitcnt lgkmcnt(13)
v_mfma_f32_16x16x32_bf16 v[184:187], v[128:131], v[56:59], v[184:187]
ds_read_b128 v[128:131], v248 offset:35840
s_waitcnt lgkmcnt(13)
v_mfma_f32_16x16x32_bf16 v[188:191], v[132:135], v[56:59], v[188:191]
ds_read_b128 v[132:135], v248 offset:36864
s_waitcnt lgkmcnt(13)
v_mfma_f32_16x16x32_bf16 v[192:195], v[136:139], v[56:59], v[192:195]
ds_read_b128 v[136:139], v1 offset:24576
s_waitcnt vmcnt(6)
s_waitcnt lgkmcnt(13)
v_mfma_f32_16x16x32_bf16 v[196:199], v[140:143], v[56:59], v[196:199]
ds_read_b128 v[140:143], v1 offset:25600
ds_read_b32 v98, v97
s_waitcnt lgkmcnt(13)
v_mfma_f32_16x16x32_bf16 v[172:175], v[144:147], v[60:63], v[172:175]
ds_read_b128 v[144:147], v248 offset:37888
s_add_u32 s40, s45, 12288
buffer_load_dwordx4 v[80:83], v1, s[8:11], s40 offen offset:2048
s_waitcnt lgkmcnt(13)
v_mfma_f32_16x16x32_bf16 v[176:179], v[148:151], v[60:63], v[176:179]
ds_read_b128 v[148:151], v248 offset:38912
s_waitcnt lgkmcnt(13)
v_mfma_f32_16x16x32_bf16 v[180:183], v[152:155], v[60:63], v[180:183]
ds_read_b128 v[152:155], v248 offset:39936
s_waitcnt lgkmcnt(13)
v_mfma_f32_16x16x32_bf16 v[184:187], v[156:159], v[60:63], v[184:187]
ds_read_b128 v[156:159], v248 offset:40960
s_waitcnt lgkmcnt(13)
v_mfma_f32_16x16x32_bf16 v[188:191], v[160:163], v[60:63], v[188:191]
ds_read_b128 v[160:163], v248 offset:41984
s_waitcnt lgkmcnt(13)
v_mfma_f32_16x16x32_bf16 v[192:195], v[164:167], v[60:63], v[192:195]
ds_read_b128 v[164:167], v1 offset:26624
s_waitcnt vmcnt(5)
s_waitcnt lgkmcnt(13)
v_mfma_f32_16x16x32_bf16 v[196:199], v[168:171], v[60:63], v[196:199]
ds_read_b128 v[168:171], v1 offset:27648
s_cmp_lt_u32 s20, 4
s_cbranch_scc0 SS_9
v_add_f32 v96, v96, v98
ds_write_b32 v97, v96
SS_9:
v_mov_b32 v5, 162944
ds_read_b32 v232, v5
s_waitcnt lgkmcnt(13)
v_mfma_f32_16x16x32_bf16 v[172:175], v[116:119], v[64:67], v[172:175]
ds_read_b128 v[116:119], v248 offset:43008
s_add_u32 s40, s45, 12288
buffer_load_dwordx4 v[84:87], v1, s[8:11], s40 offen offset:3072
s_waitcnt lgkmcnt(13)
v_mfma_f32_16x16x32_bf16 v[176:179], v[120:123], v[64:67], v[176:179]
ds_read_b128 v[120:123], v248 offset:44032
s_waitcnt lgkmcnt(13)
v_mfma_f32_16x16x32_bf16 v[180:183], v[124:127], v[64:67], v[180:183]
ds_read_b128 v[124:127], v248 offset:45056
s_waitcnt lgkmcnt(13)
v_mfma_f32_16x16x32_bf16 v[184:187], v[128:131], v[64:67], v[184:187]
ds_read_b128 v[128:131], v248 offset:46080
s_waitcnt lgkmcnt(13)
v_mfma_f32_16x16x32_bf16 v[188:191], v[132:135], v[64:67], v[188:191]
ds_read_b128 v[132:135], v248 offset:47104
s_waitcnt lgkmcnt(13)
v_mfma_f32_16x16x32_bf16 v[192:195], v[136:139], v[64:67], v[192:195]
ds_read_b128 v[136:139], v1 offset:28672
s_waitcnt vmcnt(5)
s_waitcnt lgkmcnt(13)
v_mfma_f32_16x16x32_bf16 v[196:199], v[140:143], v[64:67], v[196:199]
ds_read_b128 v[140:143], v1 offset:29696
s_add_u32 s40, s45, 16384
buffer_load_dwordx4 v[88:91], v1, s[8:11], s40 offen offset:2048
s_add_u32 s40, s45, 16384
buffer_load_dwordx4 v[92:95], v1, s[8:11], s40 offen offset:3072
s_waitcnt lgkmcnt(13)
v_mfma_f32_16x16x32_bf16 v[172:175], v[144:147], v[68:71], v[172:175]
ds_read_b128 v[144:147], v248 offset:48128
s_waitcnt lgkmcnt(13)
v_mfma_f32_16x16x32_bf16 v[176:179], v[148:151], v[68:71], v[176:179]
ds_read_b128 v[148:151], v248 offset:49152
s_waitcnt lgkmcnt(13)
v_mfma_f32_16x16x32_bf16 v[180:183], v[152:155], v[68:71], v[180:183]
ds_read_b128 v[152:155], v248 offset:50176
s_waitcnt lgkmcnt(13)
v_mfma_f32_16x16x32_bf16 v[184:187], v[156:159], v[68:71], v[184:187]
ds_read_b128 v[156:159], v248 offset:51200
s_waitcnt lgkmcnt(13)
v_mfma_f32_16x16x32_bf16 v[188:191], v[160:163], v[68:71], v[188:191]
ds_read_b128 v[160:163], v248 offset:52224
s_waitcnt lgkmcnt(13)
v_mfma_f32_16x16x32_bf16 v[192:195], v[164:167], v[68:71], v[192:195]
ds_read_b128 v[164:167], v1 offset:30720
s_waitcnt vmcnt(5)
s_waitcnt lgkmcnt(13)
v_mfma_f32_16x16x32_bf16 v[196:199], v[168:171], v[68:71], v[196:199]
ds_read_b128 v[168:171], v1 offset:31744
v_readfirstlane_b32 s23, v232
s_cmp_lt_u32 s20, 4
s_cbranch_scc0 HL_10
s_lshl_b32 s47, s21, 3
s_sub_u32 s47, s47, 1
s_max_i32 s47, s47, 0
s_mul_i32 s47, s47, 20480
s_add_u32 s47, s47, 5750784
s_mul_i32 s48, s20, 5
s_cmp_eq_u32 s20, 3
s_cselect_b32 s49, 1, 0
s_sub_u32 s48, s48, s49
s_lshl_b32 s48, s48, 10
s_add_u32 s48, s48, s47
s_cmp_lt_u32 s20, 2
s_cselect_b32 s49, 4, 3
s_lshl_b32 s49, s49, 10
s_add_u32 s49, s49, s48
buffer_load_dwordx4 v[96:99], v1, s[8:11], s48 offen offset:0 sc1
buffer_load_dwordx4 v[100:103], v1, s[8:11], s48 offen offset:1024 sc1
buffer_load_dwordx4 v[104:107], v1, s[8:11], s48 offen offset:2048 sc1
buffer_load_dwordx4 v[108:111], v1, s[8:11], s48 offen offset:3072 sc1
buffer_load_dwordx4 v[112:115], v1, s[8:11], s49 offen offset:0 sc1
HL_10:
s_cmp_eq_u32 s20, 7
s_cbranch_scc0 HL_11
s_lshl_b32 s47, s21, 3
s_sub_u32 s47, s47, 1
s_max_i32 s47, s47, 0
s_mul_i32 s47, s47, 20480
s_add_u32 s47, s47, 5750784
s_add_u32 s41, s47, 16384
buffer_load_dwordx4 v[96:99], v1, s[8:11], s41 offen offset:2048 sc1
s_add_u32 s41, s47, 16384
buffer_load_dwordx4 v[100:103], v1, s[8:11], s41 offen offset:3072 sc1
HL_11:
s_waitcnt vmcnt(5)
s_barrier
s_waitcnt lgkmcnt(13)
v_mfma_f32_16x16x32_bf16 v[172:175], v[116:119], v[72:75], v[172:175]
ds_read_b128 v[116:119], v248 offset:53248
s_waitcnt lgkmcnt(13)
v_mfma_f32_16x16x32_bf16 v[176:179], v[120:123], v[72:75], v[176:179]
ds_read_b128 v[120:123], v248 offset:54272
s_waitcnt lgkmcnt(13)
v_mfma_f32_16x16x32_bf16 v[180:183], v[124:127], v[72:75], v[180:183]
ds_read_b128 v[124:127], v248 offset:55296
s_waitcnt lgkmcnt(13)
v_mfma_f32_16x16x32_bf16 v[184:187], v[128:131], v[72:75], v[184:187]
ds_read_b128 v[128:131], v248 offset:56320
s_waitcnt lgkmcnt(13)
v_mfma_f32_16x16x32_bf16 v[188:191], v[132:135], v[72:75], v[188:191]
ds_read_b128 v[132:135], v248 offset:57344
s_waitcnt lgkmcnt(13)
v_mfma_f32_16x16x32_bf16 v[192:195], v[136:139], v[72:75], v[192:195]
ds_read_b128 v[136:139], v1 offset:32768
s_waitcnt vmcnt(4)
s_waitcnt lgkmcnt(13)
v_mfma_f32_16x16x32_bf16 v[196:199], v[140:143], v[72:75], v[196:199]
ds_read_b128 v[140:143], v1 offset:33792
s_lshl_b32 s36, s21, 3
s_lshl_b32 s37, s27, 2
s_add_u32 s36, s36, s37
s_add_u32 s36, s36, s29
s_mul_i32 s37, s36, 18432
s_mul_i32 s38, s28, 144
s_add_u32 s37, s37, s38
s_lshl_b32 s38, s30, 6
s_add_u32 s38, s38, s37
s_add_u32 s37, s37, 128
v_mul_u32_u24 v5, 1152, v2
v_lshl_add_u32 v6, v3, 3, v5
v_lshl_add_u32 v5, v3, 4, v5
buffer_load_dwordx4 v[8:11], v5, s[60:63], s38 offen
buffer_load_dwordx2 v[12:13], v6, s[60:63], s37 offen
s_mul_i32 s43, s24, 4718592
s_add_u32 s43, s43, 18923520
s_add_u32 s41, s43, s68
s_add_u32 s42, s43, s69
v_mov_b32 v220, -1
v_mov_b32 v221, -1
v_mov_b32 v222, -1
v_mov_b32 v223, -1
s_cmp_eq_u32 s23, 0
s_cbranch_scc0 HS_12
buffer_store_dwordx4 v[220:223], v1, s[8:11], s41 offen
s_mov_b64 exec, 0xffff
buffer_store_dwordx2 v[220:221], v202, s[8:11], s42 offen
s_mov_b64 exec, -1
HJ_13:
s_waitcnt lgkmcnt(13)
v_mfma_f32_16x16x32_bf16 v[172:175], v[144:147], v[76:79], v[172:175]
ds_read_b128 v[144:147], v248 offset:58368
s_waitcnt vmcnt(4)
v_add_f32 v250, v88, v90
v_add_f32 v251, v89, v91
s_waitcnt lgkmcnt(13)
v_mfma_f32_16x16x32_bf16 v[176:179], v[148:151], v[76:79], v[176:179]
ds_read_b128 v[148:151], v248 offset:59392
v_add_f32 v244, v92, v94
v_add_f32 v245, v93, v95
s_waitcnt lgkmcnt(13)
v_mfma_f32_16x16x32_bf16 v[180:183], v[152:155], v[76:79], v[180:183]
ds_read_b128 v[152:155], v248 offset:60416
v_add_f32 v250, v250, v244
v_add_f32 v251, v251, v245
s_waitcnt lgkmcnt(13)
v_mfma_f32_16x16x32_bf16 v[184:187], v[156:159], v[76:79], v[184:187]
ds_read_b128 v[156:159], v248 offset:61440
v_mov_b32 v244, v250
s_waitcnt lgkmcnt(13)
v_mfma_f32_16x16x32_bf16 v[188:191], v[160:163], v[76:79], v[188:191]
ds_read_b128 v[160:163], v248 offset:62464
v_mov_b32 v245, v251
s_waitcnt lgkmcnt(13)
v_mfma_f32_16x16x32_bf16 v[192:195], v[164:167], v[76:79], v[192:195]
ds_read_b128 v[164:167], v1 offset:34816
v_permlane16_swap_b32 v250, v244
s_waitcnt vmcnt(7)
s_waitcnt lgkmcnt(13)
v_mfma_f32_16x16x32_bf16 v[196:199], v[168:171], v[76:79], v[196:199]
ds_read_b128 v[168:171], v1 offset:35840
v_permlane16_swap_b32 v251, v245
s_add_u32 m0, s25, 0
s_add_u32 s40, s66, 0
buffer_load_dwordx4 v1, s[8:11], s40 offen lds
s_waitcnt lgkmcnt(13)
v_mfma_f32_16x16x32_bf16 v[172:175], v[116:119], v[80:83], v[172:175]
ds_read_b128 v[116:119], v241 offset:0
v_add_f32 v250, v250, v244
s_waitcnt lgkmcnt(13)
v_mfma_f32_16x16x32_bf16 v[176:179], v[120:123], v[80:83], v[176:179]
ds_read_b128 v[120:123], v241 offset:64
v_add_f32 v251, v251, v245
s_waitcnt lgkmcnt(13)
v_mfma_f32_16x16x32_bf16 v[180:183], v[124:127], v[80:83], v[180:183]
ds_read_b128 v[124:127], v241 offset:128
v_mov_b32 v244, v250
s_waitcnt lgkmcnt(13)
v_mfma_f32_16x16x32_bf16 v[184:187], v[128:131], v[80:83], v[184:187]
ds_read_b128 v[128:131], v241 offset:192
v_mov_b32 v245, v251
s_waitcnt lgkmcnt(13)
v_mfma_f32_16x16x32_bf16 v[188:191], v[132:135], v[80:83], v[188:191]
ds_read_b128 v[132:135], v241 offset:256
v_permlane32_swap_b32 v250, v244
s_waitcnt lgkmcnt(13)
v_mfma_f32_16x16x32_bf16 v[192:195], v[136:139], v[80:83], v[192:195]
ds_read_b128 v[136:139], v241 offset:320
v_permlane32_swap_b32 v251, v245
s_waitcnt vmcnt(7)
s_waitcnt lgkmcnt(13)
v_mfma_f32_16x16x32_bf16 v[196:199], v[140:143], v[80:83], v[196:199]
ds_read_b128 v[140:143], v241 offset:384
v_add_f32 v250, v250, v244
s_add_u32 m0, s25, 8192
s_add_u32 s40, s66, 8192
buffer_load_dwordx4 v1, s[8:11], s40 offen lds
s_waitcnt lgkmcnt(13)
v_mfma_f32_16x16x32_bf16 v[172:175], v[144:147], v[84:87], v[172:175]
v_add_f32 v251, v251, v245
s_waitcnt lgkmcnt(12)
v_mfma_f32_16x16x32_bf16 v[176:179], v[148:151], v[84:87], v[176:179]
v_mul_f32 v250, 0x3ae38e39, v250
s_waitcnt lgkmcnt(11)
v_mfma_f32_16x16x32_bf16 v[180:183], v[152:155], v[84:87], v[180:183]
v_mul_f32 v251, 0x3ae38e39, v251
s_waitcnt lgkmcnt(10)
v_mfma_f32_16x16x32_bf16 v[184:187], v[156:159], v[84:87], v[184:187]
v_fma_f32 v251, -v250, v250, v251
s_waitcnt lgkmcnt(9)
v_mfma_f32_16x16x32_bf16 v[188:191], v[160:163], v[84:87], v[188:191]
v_max_f32 v251, 0, v251
s_waitcnt lgkmcnt(8)
v_mfma_f32_16x16x32_bf16 v[192:195], v[164:167], v[84:87], v[192:195]
v_add_f32 v251, 0x3727c5ac, v251
s_waitcnt lgkmcnt(7)
v_mfma_f32_16x16x32_bf16 v[196:199], v[168:171], v[84:87], v[196:199]
v_rsq_f32 v251, v251
s_cmp_lt_u32 s20, 2
s_cbranch_scc0 DS_14
s_add_u32 m0, s25, 16384
s_add_u32 s40, s66, 16384
buffer_load_dwordx4 v1, s[8:11], s40 offen lds
DS_14:
s_branch M_QAC
M_LOOP:
s_add_u32 s46, s70, 10993664
s_mov_b32 s39, 20000
s_mov_b64 exec, 0xffff
LP_15:
buffer_load_dword v6, v246, s[8:11], s46 offen sc1
s_waitcnt vmcnt(0)
v_cmp_eq_u32 vcc, -1, v6
s_sub_u32 s39, s39, 1
s_cbranch_scc1 LX_16
s_cbranch_vccnz LP_15
LX_16:
s_mov_b64 exec, -1
s_add_u32 s40, s46, 16384
buffer_load_dwordx4 v[16:19], v1, s[8:11], s40 offen offset:0 sc1
s_add_u32 s40, s46, 16384
buffer_load_dwordx4 v[20:23], v1, s[8:11], s40 offen offset:1024 sc1
buffer_load_dwordx4 v[24:27], v1, s[8:11], s46 offen offset:0 sc1
buffer_load_dwordx4 v[28:31], v1, s[8:11], s46 offen offset:1024 sc1
buffer_load_dwordx4 v[32:35], v1, s[8:11], s46 offen offset:2048 sc1
s_barrier
ds_read_b128 v[116:119], v1 offset:36864
ds_read_b128 v[120:123], v1 offset:37888
ds_read_b128 v[124:127], v1 offset:38912
ds_read_b128 v[128:131], v1 offset:39936
ds_read_b128 v[132:135], v1 offset:40960
ds_read_b128 v[136:139], v1 offset:0
ds_read_b128 v[140:143], v1 offset:1024
ds_read_b128 v[144:147], v1 offset:41984
ds_read_b128 v[148:151], v1 offset:43008
ds_read_b128 v[152:155], v1 offset:44032
ds_read_b128 v[156:159], v1 offset:45056
ds_read_b128 v[160:163], v1 offset:46080
ds_read_b128 v[164:167], v1 offset:2048
ds_read_b128 v[168:171], v1 offset:3072
v_mov_b32 v172, 0
v_mov_b32 v173, 0
v_mov_b32 v174, 0
v_mov_b32 v175, 0
v_mov_b32 v176, 0
v_mov_b32 v177, 0
v_mov_b32 v178, 0
v_mov_b32 v179, 0
v_mov_b32 v180, 0
v_mov_b32 v181, 0
v_mov_b32 v182, 0
v_mov_b32 v183, 0
v_mov_b32 v184, 0
v_mov_b32 v185, 0
v_mov_b32 v186, 0
v_mov_b32 v187, 0
v_mov_b32 v188, 0
v_mov_b32 v189, 0
v_mov_b32 v190, 0
v_mov_b32 v191, 0
v_mov_b32 v192, 0
v_mov_b32 v193, 0
v_mov_b32 v194, 0
v_mov_b32 v195, 0
v_mov_b32 v196, 0
v_mov_b32 v197, 0
v_mov_b32 v198, 0
v_mov_b32 v199, 0
s_waitcnt vmcnt(4)
v_max_u32 v6, v16, v18
v_cmp_eq_u32 vcc, -1, v6
s_cbranch_vccnz RT_17
RB_18:
s_waitcnt lgkmcnt(13)
v_mfma_f32_16x16x32_bf16 v[172:175], v[116:119], v[16:19], v[172:175]
ds_read_b128 v[116:119], v1 offset:47104
buffer_load_dwordx4 v[36:39], v1, s[8:11], s46 offen offset:3072 sc1
s_waitcnt lgkmcnt(13)
v_mfma_f32_16x16x32_bf16 v[176:179], v[120:123], v[16:19], v[176:179]
ds_read_b128 v[120:123], v1 offset:48128
s_waitcnt lgkmcnt(13)
v_mfma_f32_16x16x32_bf16 v[180:183], v[124:127], v[16:19], v[180:183]
ds_read_b128 v[124:127], v1 offset:49152
s_waitcnt lgkmcnt(13)
v_mfma_f32_16x16x32_bf16 v[184:187], v[128:131], v[16:19], v[184:187]
ds_read_b128 v[128:131], v1 offset:50176
s_waitcnt lgkmcnt(13)
v_mfma_f32_16x16x32_bf16 v[188:191], v[132:135], v[16:19], v[188:191]
ds_read_b128 v[132:135], v1 offset:51200
s_waitcnt lgkmcnt(13)
v_mfma_f32_16x16x32_bf16 v[192:195], v[136:139], v[16:19], v[192:195]
ds_read_b128 v[136:139], v1 offset:4096
s_waitcnt vmcnt(4)
v_max_u32 v6, v20, v22
v_cmp_eq_u32 vcc, -1, v6
s_waitcnt lgkmcnt(13)
v_mfma_f32_16x16x32_bf16 v[196:199], v[140:143], v[16:19], v[196:199]
ds_read_b128 v[140:143], v1 offset:5120
s_cbranch_vccnz RT_20
RB_21:
s_waitcnt lgkmcnt(13)
v_mfma_f32_16x16x32_bf16 v[172:175], v[144:147], v[20:23], v[172:175]
ds_read_b128 v[144:147], v1 offset:52224
s_add_u32 s40, s46, 4096
buffer_load_dwordx4 v[40:43], v1, s[8:11], s40 offen offset:0 sc1
s_waitcnt lgkmcnt(13)
v_mfma_f32_16x16x32_bf16 v[176:179], v[148:151], v[20:23], v[176:179]
ds_read_b128 v[148:151], v1 offset:53248
s_waitcnt lgkmcnt(13)
v_mfma_f32_16x16x32_bf16 v[180:183], v[152:155], v[20:23], v[180:183]
ds_read_b128 v[152:155], v1 offset:54272
s_waitcnt lgkmcnt(13)
v_mfma_f32_16x16x32_bf16 v[184:187], v[156:159], v[20:23], v[184:187]
ds_read_b128 v[156:159], v1 offset:55296
s_waitcnt lgkmcnt(13)
v_mfma_f32_16x16x32_bf16 v[188:191], v[160:163], v[20:23], v[188:191]
ds_read_b128 v[160:163], v1 offset:56320
s_waitcnt lgkmcnt(13)
v_mfma_f32_16x16x32_bf16 v[192:195], v[164:167], v[20:23], v[192:195]
ds_read_b128 v[164:167], v1 offset:6144
s_waitcnt vmcnt(4)
v_cmp_eq_u32 vcc, -1, v24
s_waitcnt lgkmcnt(13)
v_mfma_f32_16x16x32_bf16 v[196:199], v[168:171], v[20:23], v[196:199]
ds_read_b128 v[168:171], v1 offset:7168
s_cbranch_vccnz RT_23
RB_24:
s_waitcnt lgkmcnt(13)
v_mfma_f32_16x16x32_bf16 v[172:175], v[116:119], v[24:27], v[172:175]
ds_read_b128 v[116:119], v1 offset:57344
s_add_u32 s40, s46, 4096
buffer_load_dwordx4 v[44:47], v1, s[8:11], s40 offen offset:1024 sc1
s_waitcnt lgkmcnt(13)
v_mfma_f32_16x16x32_bf16 v[176:179], v[120:123], v[24:27], v[176:179]
ds_read_b128 v[120:123], v1 offset:58368
s_waitcnt lgkmcnt(13)
v_mfma_f32_16x16x32_bf16 v[180:183], v[124:127], v[24:27], v[180:183]
ds_read_b128 v[124:127], v1 offset:59392
s_waitcnt lgkmcnt(13)
v_mfma_f32_16x16x32_bf16 v[184:187], v[128:131], v[24:27], v[184:187]
ds_read_b128 v[128:131], v1 offset:60416
s_waitcnt lgkmcnt(13)
v_mfma_f32_16x16x32_bf16 v[188:191], v[132:135], v[24:27], v[188:191]
ds_read_b128 v[132:135], v1 offset:61440
s_waitcnt lgkmcnt(13)
v_mfma_f32_16x16x32_bf16 v[192:195], v[136:139], v[24:27], v[192:195]
ds_read_b128 v[136:139], v1 offset:8192
s_waitcnt vmcnt(4)
v_cmp_eq_u32 vcc, -1, v28
s_waitcnt lgkmcnt(13)
v_mfma_f32_16x16x32_bf16 v[196:199], v[140:143], v[24:27], v[196:199]
ds_read_b128 v[140:143], v1 offset:9216
s_cbranch_vccnz RT_26
RB_27:
s_waitcnt lgkmcnt(13)
v_mfma_f32_16x16x32_bf16 v[172:175], v[144:147], v[28:31], v[172:175]
ds_read_b128 v[144:147], v1 offset:62464
s_add_u32 s40, s46, 4096
buffer_load_dwordx4 v[48:51], v1, s[8:11], s40 offen offset:2048 sc1
s_waitcnt lgkmcnt(13)
v_mfma_f32_16x16x32_bf16 v[176:179], v[148:151], v[28:31], v[176:179]
ds_read_b128 v[148:151], v1 offset:63488
s_waitcnt lgkmcnt(13)
v_mfma_f32_16x16x32_bf16 v[180:183], v[152:155], v[28:31], v[180:183]
ds_read_b128 v[152:155], v1 offset:64512
s_waitcnt lgkmcnt(13)
v_mfma_f32_16x16x32_bf16 v[184:187], v[156:159], v[28:31], v[184:187]
ds_read_b128 v[156:159], v248 offset:0
s_waitcnt lgkmcnt(13)
v_mfma_f32_16x16x32_bf16 v[188:191], v[160:163], v[28:31], v[188:191]
ds_read_b128 v[160:163], v248 offset:1024
s_waitcnt lgkmcnt(13)
v_mfma_f32_16x16x32_bf16 v[192:195], v[164:167], v[28:31], v[192:195]
ds_read_b128 v[164:167], v1 offset:10240
s_waitcnt vmcnt(4)
v_cmp_eq_u32 vcc, -1, v32
s_waitcnt lgkmcnt(13)
v_mfma_f32_16x16x32_bf16 v[196:199], v[168:171], v[28:31], v[196:199]
ds_read_b128 v[168:171], v1 offset:11264
s_cbranch_vccnz RT_29
RB_30:
s_waitcnt lgkmcnt(13)
v_mfma_f32_16x16x32_bf16 v[172:175], v[116:119], v[32:35], v[172:175]
ds_read_b128 v[116:119], v248 offset:2048
s_add_u32 s40, s46, 4096
buffer_load_dwordx4 v[52:55], v1, s[8:11], s40 offen offset:3072 sc1
s_waitcnt lgkmcnt(13)
v_mfma_f32_16x16x32_bf16 v[176:179], v[120:123], v[32:35], v[176:179]
ds_read_b128 v[120:123], v248 offset:3072
s_waitcnt lgkmcnt(13)
v_mfma_f32_16x16x32_bf16 v[180:183], v[124:127], v[32:35], v[180:183]
ds_read_b128 v[124:127], v248 offset:4096
s_waitcnt lgkmcnt(13)
v_mfma_f32_16x16x32_bf16 v[184:187], v[128:131], v[32:35], v[184:187]
ds_read_b128 v[128:131], v248 offset:5120
s_waitcnt lgkmcnt(13)
v_mfma_f32_16x16x32_bf16 v[188:191], v[132:135], v[32:35], v[188:191]
ds_read_b128 v[132:135], v248 offset:6144
s_waitcnt lgkmcnt(13)
v_mfma_f32_16x16x32_bf16 v[192:195], v[136:139], v[32:35], v[192:195]
ds_read_b128 v[136:139], v1 offset:12288
s_waitcnt vmcnt(4)
v_cmp_eq_u32 vcc, -1, v36
s_waitcnt lgkmcnt(13)
v_mfma_f32_16x16x32_bf16 v[196:199], v[140:143], v[32:35], v[196:199]
ds_read_b128 v[140:143], v1 offset:13312
s_cbranch_vccnz RT_32
RB_33:
s_waitcnt lgkmcnt(13)
v_mfma_f32_16x16x32_bf16 v[172:175], v[144:147], v[36:39], v[172:175]
ds_read_b128 v[144:147], v248 offset:7168
s_add_u32 s40, s46, 8192
buffer_load_dwordx4 v[56:59], v1, s[8:11], s40 offen offset:0 sc1
s_waitcnt lgkmcnt(13)
v_mfma_f32_16x16x32_bf16 v[176:179], v[148:151], v[36:39], v[176:179]
ds_read_b128 v[148:151], v248 offset:8192
s_waitcnt lgkmcnt(13)
v_mfma_f32_16x16x32_bf16 v[180:183], v[152:155], v[36:39], v[180:183]
ds_read_b128 v[152:155], v248 offset:9216
s_waitcnt lgkmcnt(13)
v_mfma_f32_16x16x32_bf16 v[184:187], v[156:159], v[36:39], v[184:187]
ds_read_b128 v[156:159], v248 offset:10240
s_waitcnt lgkmcnt(13)
v_mfma_f32_16x16x32_bf16 v[188:191], v[160:163], v[36:39], v[188:191]
ds_read_b128 v[160:163], v248 offset:11264
s_waitcnt lgkmcnt(13)
v_mfma_f32_16x16x32_bf16 v[192:195], v[164:167], v[36:39], v[192:195]
ds_read_b128 v[164:167], v1 offset:14336
s_waitcnt vmcnt(4)
v_cmp_eq_u32 vcc, -1, v40
s_waitcnt lgkmcnt(13)
v_mfma_f32_16x16x32_bf16 v[196:199], v[168:171], v[36:39], v[196:199]
ds_read_b128 v[168:171], v1 offset:15360
s_cbranch_vccnz RT_35
RB_36:
s_waitcnt lgkmcnt(13)
v_mfma_f32_16x16x32_bf16 v[172:175], v[116:119], v[40:43], v[172:175]
ds_read_b128 v[116:119], v248 offset:12288
s_add_u32 s40, s46, 8192
buffer_load_dwordx4 v[60:63], v1, s[8:11], s40 offen offset:1024 sc1
s_waitcnt lgkmcnt(13)
v_mfma_f32_16x16x32_bf16 v[176:179], v[120:123], v[40:43], v[176:179]
ds_read_b128 v[120:123], v248 offset:13312
s_waitcnt lgkmcnt(13)
v_mfma_f32_16x16x32_bf16 v[180:183], v[124:127], v[40:43], v[180:183]
ds_read_b128 v[124:127], v248 offset:14336
s_waitcnt lgkmcnt(13)
v_mfma_f32_16x16x32_bf16 v[184:187], v[128:131], v[40:43], v[184:187]
ds_read_b128 v[128:131], v248 offset:15360
s_waitcnt lgkmcnt(13)
v_mfma_f32_16x16x32_bf16 v[188:191], v[132:135], v[40:43], v[188:191]
ds_read_b128 v[132:135], v248 offset:16384
s_waitcnt lgkmcnt(13)
v_mfma_f32_16x16x32_bf16 v[192:195], v[136:139], v[40:43], v[192:195]
ds_read_b128 v[136:139], v1 offset:16384
s_waitcnt vmcnt(4)
v_cmp_eq_u32 vcc, -1, v44
s_waitcnt lgkmcnt(13)
v_mfma_f32_16x16x32_bf16 v[196:199], v[140:143], v[40:43], v[196:199]
ds_read_b128 v[140:143], v1 offset:17408
s_cbranch_vccnz RT_38
RB_39:
s_waitcnt lgkmcnt(13)
v_mfma_f32_16x16x32_bf16 v[172:175], v[144:147], v[44:47], v[172:175]
ds_read_b128 v[144:147], v248 offset:17408
s_add_u32 s40, s46, 8192
buffer_load_dwordx4 v[64:67], v1, s[8:11], s40 offen offset:2048 sc1
s_waitcnt lgkmcnt(13)
v_mfma_f32_16x16x32_bf16 v[176:179], v[148:151], v[44:47], v[176:179]
ds_read_b128 v[148:151], v248 offset:18432
s_waitcnt lgkmcnt(13)
v_mfma_f32_16x16x32_bf16 v[180:183], v[152:155], v[44:47], v[180:183]
ds_read_b128 v[152:155], v248 offset:19456
s_waitcnt lgkmcnt(13)
v_mfma_f32_16x16x32_bf16 v[184:187], v[156:159], v[44:47], v[184:187]
ds_read_b128 v[156:159], v248 offset:20480
s_waitcnt lgkmcnt(13)
v_mfma_f32_16x16x32_bf16 v[188:191], v[160:163], v[44:47], v[188:191]
ds_read_b128 v[160:163], v248 offset:21504
s_waitcnt lgkmcnt(13)
v_mfma_f32_16x16x32_bf16 v[192:195], v[164:167], v[44:47], v[192:195]
ds_read_b128 v[164:167], v1 offset:18432
s_waitcnt vmcnt(4)
v_cmp_eq_u32 vcc, -1, v48
s_waitcnt lgkmcnt(13)
v_mfma_f32_16x16x32_bf16 v[196:199], v[168:171], v[44:47], v[196:199]
ds_read_b128 v[168:171], v1 offset:19456
s_cbranch_vccnz RT_41
RB_42:
s_waitcnt lgkmcnt(13)
v_mfma_f32_16x16x32_bf16 v[172:175], v[116:119], v[48:51], v[172:175]
ds_read_b128 v[116:119], v248 offset:22528
s_add_u32 s40, s46, 8192
buffer_load_dwordx4 v[68:71], v1, s[8:11], s40 offen offset:3072 sc1
s_waitcnt lgkmcnt(13)
v_mfma_f32_16x16x32_bf16 v[176:179], v[120:123], v[48:51], v[176:179]
ds_read_b128 v[120:123], v248 offset:23552
s_waitcnt lgkmcnt(13)
v_mfma_f32_16x16x32_bf16 v[180:183], v[124:127], v[48:51], v[180:183]
ds_read_b128 v[124:127], v248 offset:24576
s_waitcnt lgkmcnt(13)
v_mfma_f32_16x16x32_bf16 v[184:187], v[128:131], v[48:51], v[184:187]
ds_read_b128 v[128:131], v248 offset:25600
s_waitcnt lgkmcnt(13)
v_mfma_f32_16x16x32_bf16 v[188:191], v[132:135], v[48:51], v[188:191]
ds_read_b128 v[132:135], v248 offset:26624
s_waitcnt lgkmcnt(13)
v_mfma_f32_16x16x32_bf16 v[192:195], v[136:139], v[48:51], v[192:195]
ds_read_b128 v[136:139], v1 offset:20480
s_waitcnt vmcnt(4)
v_cmp_eq_u32 vcc, -1, v52
s_waitcnt lgkmcnt(13)
v_mfma_f32_16x16x32_bf16 v[196:199], v[140:143], v[48:51], v[196:199]
ds_read_b128 v[140:143], v1 offset:21504
s_barrier
s_cbranch_vccnz RT_44
RB_45:
s_waitcnt lgkmcnt(13)
v_mfma_f32_16x16x32_bf16 v[172:175], v[144:147], v[52:55], v[172:175]
ds_read_b128 v[144:147], v248 offset:27648
s_add_u32 s40, s46, 12288
buffer_load_dwordx4 v[72:75], v1, s[8:11], s40 offen offset:0 sc1
s_waitcnt lgkmcnt(13)
v_mfma_f32_16x16x32_bf16 v[176:179], v[148:151], v[52:55], v[176:179]
ds_read_b128 v[148:151], v248 offset:28672
s_waitcnt lgkmcnt(13)
v_mfma_f32_16x16x32_bf16 v[180:183], v[152:155], v[52:55], v[180:183]
ds_read_b128 v[152:155], v248 offset:29696
s_waitcnt lgkmcnt(13)
v_mfma_f32_16x16x32_bf16 v[184:187], v[156:159], v[52:55], v[184:187]
ds_read_b128 v[156:159], v248 offset:30720
s_waitcnt lgkmcnt(13)
v_mfma_f32_16x16x32_bf16 v[188:191], v[160:163], v[52:55], v[188:191]
ds_read_b128 v[160:163], v248 offset:31744
s_waitcnt lgkmcnt(13)
v_mfma_f32_16x16x32_bf16 v[192:195], v[164:167], v[52:55], v[192:195]
ds_read_b128 v[164:167], v1 offset:22528
s_waitcnt vmcnt(4)
v_cmp_eq_u32 vcc, -1, v56
s_waitcnt lgkmcnt(13)
v_mfma_f32_16x16x32_bf16 v[196:199], v[168:171], v[52:55], v[196:199]
ds_read_b128 v[168:171], v1 offset:23552
s_cbranch_vccnz RT_47
RB_48:
s_waitcnt lgkmcnt(13)
v_mfma_f32_16x16x32_bf16 v[172:175], v[116:119], v[56:59], v[172:175]
ds_read_b128 v[116:119], v248 offset:32768
s_add_u32 s40, s46, 12288
buffer_load_dwordx4 v[76:79], v1, s[8:11], s40 offen offset:1024 sc1
s_waitcnt lgkmcnt(13)
v_mfma_f32_16x16x32_bf16 v[176:179], v[120:123], v[56:59], v[176:179]
ds_read_b128 v[120:123], v248 offset:33792
s_waitcnt lgkmcnt(13)
v_mfma_f32_16x16x32_bf16 v[180:183], v[124:127], v[56:59], v[180:183]
ds_read_b128 v[124:127], v248 offset:34816
s_waitcnt lgkmcnt(13)
v_mfma_f32_16x16x32_bf16 v[184:187], v[128:131], v[56:59], v[184:187]
ds_read_b128 v[128:131], v248 offset:35840
s_waitcnt lgkmcnt(13)
v_mfma_f32_16x16x32_bf16 v[188:191], v[132:135], v[56:59], v[188:191]
ds_read_b128 v[132:135], v248 offset:36864
s_waitcnt lgkmcnt(13)
v_mfma_f32_16x16x32_bf16 v[192:195], v[136:139], v[56:59], v[192:195]
ds_read_b128 v[136:139], v1 offset:24576
s_waitcnt vmcnt(4)
v_cmp_eq_u32 vcc, -1, v60
s_waitcnt lgkmcnt(13)
v_mfma_f32_16x16x32_bf16 v[196:199], v[140:143], v[56:59], v[196:199]
ds_read_b128 v[140:143], v1 offset:25600
s_cbranch_vccnz RT_50
RB_51:
s_waitcnt lgkmcnt(13)
v_mfma_f32_16x16x32_bf16 v[172:175], v[144:147], v[60:63], v[172:175]
ds_read_b128 v[144:147], v248 offset:37888
s_add_u32 s40, s46, 12288
buffer_load_dwordx4 v[80:83], v1, s[8:11], s40 offen offset:2048 sc1
s_waitcnt lgkmcnt(13)
v_mfma_f32_16x16x32_bf16 v[176:179], v[148:151], v[60:63], v[176:179]
ds_read_b128 v[148:151], v248 offset:38912
s_waitcnt lgkmcnt(13)
v_mfma_f32_16x16x32_bf16 v[180:183], v[152:155], v[60:63], v[180:183]
ds_read_b128 v[152:155], v248 offset:39936
s_waitcnt lgkmcnt(13)
v_mfma_f32_16x16x32_bf16 v[184:187], v[156:159], v[60:63], v[184:187]
ds_read_b128 v[156:159], v248 offset:40960
s_waitcnt lgkmcnt(13)
v_mfma_f32_16x16x32_bf16 v[188:191], v[160:163], v[60:63], v[188:191]
ds_read_b128 v[160:163], v248 offset:41984
s_waitcnt lgkmcnt(13)
v_mfma_f32_16x16x32_bf16 v[192:195], v[164:167], v[60:63], v[192:195]
ds_read_b128 v[164:167], v1 offset:26624
s_waitcnt vmcnt(4)
v_cmp_eq_u32 vcc, -1, v64
s_waitcnt lgkmcnt(13)
v_mfma_f32_16x16x32_bf16 v[196:199], v[168:171], v[60:63], v[196:199]
ds_read_b128 v[168:171], v1 offset:27648
s_cbranch_vccnz RT_53
RB_54:
s_waitcnt lgkmcnt(13)
v_mfma_f32_16x16x32_bf16 v[172:175], v[116:119], v[64:67], v[172:175]
ds_read_b128 v[116:119], v248 offset:43008
s_add_u32 s40, s46, 12288
buffer_load_dwordx4 v[84:87], v1, s[8:11], s40 offen offset:3072 sc1
s_waitcnt lgkmcnt(13)
v_mfma_f32_16x16x32_bf16 v[176:179], v[120:123], v[64:67], v[176:179]
ds_read_b128 v[120:123], v248 offset:44032
s_waitcnt lgkmcnt(13)
v_mfma_f32_16x16x32_bf16 v[180:183], v[124:127], v[64:67], v[180:183]
ds_read_b128 v[124:127], v248 offset:45056
s_waitcnt lgkmcnt(13)
v_mfma_f32_16x16x32_bf16 v[184:187], v[128:131], v[64:67], v[184:187]
ds_read_b128 v[128:131], v248 offset:46080
s_waitcnt lgkmcnt(13)
v_mfma_f32_16x16x32_bf16 v[188:191], v[132:135], v[64:67], v[188:191]
ds_read_b128 v[132:135], v248 offset:47104
s_waitcnt lgkmcnt(13)
v_mfma_f32_16x16x32_bf16 v[192:195], v[136:139], v[64:67], v[192:195]
ds_read_b128 v[136:139], v1 offset:28672
s_waitcnt vmcnt(4)
v_cmp_eq_u32 vcc, -1, v68
s_waitcnt lgkmcnt(13)
v_mfma_f32_16x16x32_bf16 v[196:199], v[140:143], v[64:67], v[196:199]
ds_read_b128 v[140:143], v1 offset:29696
s_add_u32 s40, s46, 16384
buffer_load_dwordx4 v[88:91], v1, s[8:11], s40 offen offset:2048 sc1
s_add_u32 s40, s46, 16384
buffer_load_dwordx4 v[92:95], v1, s[8:11], s40 offen offset:3072 sc1
s_cbranch_vccnz RT_56
RB_57:
s_waitcnt lgkmcnt(13)
v_mfma_f32_16x16x32_bf16 v[172:175], v[144:147], v[68:71], v[172:175]
ds_read_b128 v[144:147], v248 offset:48128
s_waitcnt lgkmcnt(13)
v_mfma_f32_16x16x32_bf16 v[176:179], v[148:151], v[68:71], v[176:179]
ds_read_b128 v[148:151], v248 offset:49152
s_waitcnt lgkmcnt(13)
v_mfma_f32_16x16x32_bf16 v[180:183], v[152:155], v[68:71], v[180:183]
ds_read_b128 v[152:155], v248 offset:50176
s_waitcnt lgkmcnt(13)
v_mfma_f32_16x16x32_bf16 v[184:187], v[156:159], v[68:71], v[184:187]
ds_read_b128 v[156:159], v248 offset:51200
s_waitcnt lgkmcnt(13)
v_mfma_f32_16x16x32_bf16 v[188:191], v[160:163], v[68:71], v[188:191]
ds_read_b128 v[160:163], v248 offset:52224
s_waitcnt lgkmcnt(13)
v_mfma_f32_16x16x32_bf16 v[192:195], v[164:167], v[68:71], v[192:195]
ds_read_b128 v[164:167], v1 offset:30720
s_waitcnt vmcnt(5)
v_cmp_eq_u32 vcc, -1, v72
s_waitcnt lgkmcnt(13)
v_mfma_f32_16x16x32_bf16 v[196:199], v[168:171], v[68:71], v[196:199]
ds_read_b128 v[168:171], v1 offset:31744
s_cmp_lt_u32 s20, 4
s_cbranch_scc0 HL_59
s_sub_u32 s47, s21, 1
s_max_i32 s47, s47, 0
s_mul_i32 s47, s47, 20480
s_add_u32 s47, s47, 16236544
s_mul_i32 s48, s20, 5
s_cmp_eq_u32 s20, 3
s_cselect_b32 s49, 1, 0
s_sub_u32 s48, s48, s49
s_lshl_b32 s48, s48, 10
s_add_u32 s48, s48, s47
s_cmp_lt_u32 s20, 2
s_cselect_b32 s49, 4, 3
s_lshl_b32 s49, s49, 10
s_add_u32 s49, s49, s48
buffer_load_dwordx4 v[96:99], v1, s[8:11], s48 offen offset:0 sc1
buffer_load_dwordx4 v[100:103], v1, s[8:11], s48 offen offset:1024 sc1
buffer_load_dwordx4 v[104:107], v1, s[8:11], s48 offen offset:2048 sc1
buffer_load_dwordx4 v[108:111], v1, s[8:11], s48 offen offset:3072 sc1
buffer_load_dwordx4 v[112:115], v1, s[8:11], s49 offen offset:0 sc1
HL_59:
s_cmp_eq_u32 s20, 7
s_cbranch_scc0 HL_60
s_sub_u32 s47, s21, 1
s_max_i32 s47, s47, 0
s_mul_i32 s47, s47, 20480
s_add_u32 s47, s47, 16236544
s_add_u32 s41, s47, 16384
buffer_load_dwordx4 v[96:99], v1, s[8:11], s41 offen offset:2048 sc1
s_add_u32 s41, s47, 16384
buffer_load_dwordx4 v[100:103], v1, s[8:11], s41 offen offset:3072 sc1
HL_60:
s_cbranch_vccnz RT_61
RB_62:
s_waitcnt lgkmcnt(13)
v_mfma_f32_16x16x32_bf16 v[172:175], v[116:119], v[72:75], v[172:175]
ds_read_b128 v[116:119], v248 offset:53248
s_waitcnt lgkmcnt(13)
v_mfma_f32_16x16x32_bf16 v[176:179], v[120:123], v[72:75], v[176:179]
ds_read_b128 v[120:123], v248 offset:54272
s_waitcnt lgkmcnt(13)
v_mfma_f32_16x16x32_bf16 v[180:183], v[124:127], v[72:75], v[180:183]
ds_read_b128 v[124:127], v248 offset:55296
s_waitcnt lgkmcnt(13)
v_mfma_f32_16x16x32_bf16 v[184:187], v[128:131], v[72:75], v[184:187]
ds_read_b128 v[128:131], v248 offset:56320
s_waitcnt lgkmcnt(13)
v_mfma_f32_16x16x32_bf16 v[188:191], v[132:135], v[72:75], v[188:191]
ds_read_b128 v[132:135], v248 offset:57344
s_waitcnt lgkmcnt(13)
v_mfma_f32_16x16x32_bf16 v[192:195], v[136:139], v[72:75], v[192:195]
ds_read_b128 v[136:139], v1 offset:32768
s_waitcnt vmcnt(4)
v_cmp_eq_u32 vcc, -1, v76
s_waitcnt lgkmcnt(13)
v_mfma_f32_16x16x32_bf16 v[196:199], v[140:143], v[72:75], v[196:199]
ds_read_b128 v[140:143], v1 offset:33792
s_mul_i32 s43, s24, 4718592
s_add_u32 s43, s43, 18923520
s_add_u32 s41, s43, s68
s_add_u32 s42, s43, s69
v_mov_b32 v220, -1
v_mov_b32 v221, -1
v_mov_b32 v222, -1
v_mov_b32 v223, -1
s_cmp_eq_u32 s23, 0
s_cbranch_scc0 HS_64
buffer_store_dwordx4 v[220:223], v1, s[8:11], s41 offen
s_mov_b64 exec, 0xffff
buffer_store_dwordx2 v[220:221], v202, s[8:11], s42 offen
s_mov_b64 exec, -1
HJ_65:
s_cbranch_vccnz RT_66
RB_67:
s_waitcnt lgkmcnt(13)
v_mfma_f32_16x16x32_bf16 v[172:175], v[144:147], v[76:79], v[172:175]
ds_read_b128 v[144:147], v248 offset:58368
s_waitcnt vmcnt(2)
v_max3_u32 v244, v88, v89, v90
v_max3_u32 v245, v91, v92, v93
s_waitcnt lgkmcnt(13)
v_mfma_f32_16x16x32_bf16 v[176:179], v[148:151], v[76:79], v[176:179]
ds_read_b128 v[148:151], v248 offset:59392
v_max3_u32 v244, v244, v94, v95
v_max_u32 v244, v244, v245
s_waitcnt lgkmcnt(13)
v_mfma_f32_16x16x32_bf16 v[180:183], v[152:155], v[76:79], v[180:183]
ds_read_b128 v[152:155], v248 offset:60416
v_cmp_eq_u32_e64 s[86:87], -1, v244
v_add_f32 v250, v88, v90
s_waitcnt lgkmcnt(13)
v_mfma_f32_16x16x32_bf16 v[184:187], v[156:159], v[76:79], v[184:187]
ds_read_b128 v[156:159], v248 offset:61440
v_add_f32 v251, v89, v91
v_add_f32 v244, v92, v94
s_waitcnt lgkmcnt(13)
v_mfma_f32_16x16x32_bf16 v[188:191], v[160:163], v[76:79], v[188:191]
ds_read_b128 v[160:163], v248 offset:62464
v_add_f32 v245, v93, v95
v_add_f32 v250, v250, v244
s_waitcnt lgkmcnt(13)
v_mfma_f32_16x16x32_bf16 v[192:195], v[164:167], v[76:79], v[192:195]
ds_read_b128 v[164:167], v1 offset:34816
v_add_f32 v251, v251, v245
v_mov_b32 v244, v250
s_waitcnt vmcnt(5)
v_cmp_eq_u32 vcc, -1, v80
s_waitcnt lgkmcnt(13)
v_mfma_f32_16x16x32_bf16 v[196:199], v[168:171], v[76:79], v[196:199]
ds_read_b128 v[168:171], v1 offset:35840
v_mov_b32 v245, v251
v_permlane16_swap_b32 v250, v244
s_add_u32 m0, s25, 0
s_add_u32 s40, s66, 0
buffer_load_dwordx4 v1, s[8:11], s40 offen lds
s_cbranch_vccnz RT_69
RB_70:
s_waitcnt lgkmcnt(13)
v_mfma_f32_16x16x32_bf16 v[172:175], v[116:119], v[80:83], v[172:175]
ds_read_b128 v[116:119], v241 offset:0
v_permlane16_swap_b32 v251, v245
v_add_f32 v250, v250, v244
s_waitcnt lgkmcnt(13)
v_mfma_f32_16x16x32_bf16 v[176:179], v[120:123], v[80:83], v[176:179]
ds_read_b128 v[120:123], v241 offset:64
v_add_f32 v251, v251, v245
s_waitcnt lgkmcnt(13)
v_mfma_f32_16x16x32_bf16 v[180:183], v[124:127], v[80:83], v[180:183]
ds_read_b128 v[124:127], v241 offset:128
v_mov_b32 v244, v250
s_waitcnt lgkmcnt(13)
v_mfma_f32_16x16x32_bf16 v[184:187], v[128:131], v[80:83], v[184:187]
ds_read_b128 v[128:131], v241 offset:192
v_mov_b32 v245, v251
s_waitcnt lgkmcnt(13)
v_mfma_f32_16x16x32_bf16 v[188:191], v[132:135], v[80:83], v[188:191]
ds_read_b128 v[132:135], v241 offset:256
v_permlane32_swap_b32 v250, v244
s_waitcnt lgkmcnt(13)
v_mfma_f32_16x16x32_bf16 v[192:195], v[136:139], v[80:83], v[192:195]
ds_read_b128 v[136:139], v241 offset:320
v_permlane32_swap_b32 v251, v245
s_waitcnt vmcnt(5)
v_cmp_eq_u32 vcc, -1, v84
s_waitcnt lgkmcnt(13)
v_mfma_f32_16x16x32_bf16 v[196:199], v[140:143], v[80:83], v[196:199]
ds_read_b128 v[140:143], v241 offset:384
v_add_f32 v250, v250, v244
s_add_u32 m0, s25, 8192
s_add_u32 s40, s66, 8192
buffer_load_dwordx4 v1, s[8:11], s40 offen lds
s_cbranch_vccnz RT_72
RB_73:
s_waitcnt lgkmcnt(13)
v_mfma_f32_16x16x32_bf16 v[172:175], v[144:147], v[84:87], v[172:175]
v_add_f32 v251, v251, v245
s_waitcnt lgkmcnt(12)
v_mfma_f32_16x16x32_bf16 v[176:179], v[148:151], v[84:87], v[176:179]
v_mul_f32 v250, 0x3ae38e39, v250
s_waitcnt lgkmcnt(11)
v_mfma_f32_16x16x32_bf16 v[180:183], v[152:155], v[84:87], v[180:183]
v_mul_f32 v251, 0x3ae38e39, v251
s_waitcnt lgkmcnt(10)
v_mfma_f32_16x16x32_bf16 v[184:187], v[156:159], v[84:87], v[184:187]
v_fma_f32 v251, -v250, v250, v251
s_waitcnt lgkmcnt(9)
v_mfma_f32_16x16x32_bf16 v[188:191], v[160:163], v[84:87], v[188:191]
v_max_f32 v251, 0, v251
s_waitcnt lgkmcnt(8)
v_mfma_f32_16x16x32_bf16 v[192:195], v[164:167], v[84:87], v[192:195]
v_add_f32 v251, 0x3727c5ac, v251
s_waitcnt lgkmcnt(7)
v_mfma_f32_16x16x32_bf16 v[196:199], v[168:171], v[84:87], v[196:199]
v_rsq_f32 v251, v251
s_cmp_lt_u32 s20, 2
s_cbranch_scc0 DS_75
s_add_u32 m0, s25, 16384
s_add_u32 s40, s66, 16384
buffer_load_dwordx4 v1, s[8:11], s40 offen lds
DS_75:
s_cmp_lg_u64 s[86:87], 0
s_cbranch_scc1 ST_76
SB_77:
M_QAC:
s_cmp_lt_u32 s20, 4
s_cbranch_scc0 HG_82
s_waitcnt vmcnt(4)
s_cmp_eq_u32 s24, 1
s_cbranch_scc0 HG_83
v_max3_u32 v6, v96, v97, v98
v_max3_u32 v6, v6, v99, v100
v_max3_u32 v6, v6, v101, v102
v_max3_u32 v6, v6, v103, v104
v_max3_u32 v6, v6, v105, v106
v_max3_u32 v6, v6, v107, v108
v_max3_u32 v6, v6, v109, v110
v_max3_u32 v6, v6, v111, v112
v_max3_u32 v6, v6, v113, v114
v_max_u32 v6, v6, v115
v_cmp_eq_u32 vcc, -1, v6
s_cbranch_vccnz RT_84
RB_85:
HG_83:
v_mov_b32 v16, 0
v_mov_b32 v17, 0
v_mov_b32 v18, 0
v_mov_b32 v19, 0
v_mov_b32 v20, 0
v_mov_b32 v21, 0
v_mov_b32 v22, 0
v_mov_b32 v23, 0
v_mov_b32 v24, 0
v_mov_b32 v25, 0
v_mov_b32 v26, 0
v_mov_b32 v27, 0
v_mov_b32 v28, 0
v_mov_b32 v29, 0
v_mov_b32 v30, 0
v_mov_b32 v31, 0
v_mov_b32 v32, 0
v_mov_b32 v33, 0
v_mov_b32 v34, 0
v_mov_b32 v35, 0
s_cmp_eq_u32 s20, 0
s_cbranch_scc0 HU_87
ds_read_b128 v[40:43], v1 offset:47104
ds_read_b128 v[44:47], v1 offset:48128
ds_read_b128 v[48:51], v1 offset:49152
ds_read_b128 v[52:55], v1 offset:50176
ds_read_b128 v[56:59], v1 offset:51200
ds_read_b128 v[144:147], v1 offset:52224
ds_read_b128 v[148:151], v1 offset:53248
ds_read_b128 v[152:155], v1 offset:54272
ds_read_b128 v[156:159], v1 offset:55296
ds_read_b128 v[160:163], v1 offset:56320
s_waitcnt lgkmcnt(9)
v_mfma_f32_16x16x32_bf16 v[16:19], v[40:43], v[96:99], v[16:19]
s_waitcnt lgkmcnt(8)
v_mfma_f32_16x16x32_bf16 v[20:23], v[44:47], v[96:99], v[20:23]
s_waitcnt lgkmcnt(7)
v_mfma_f32_16x16x32_bf16 v[24:27], v[48:51], v[96:99], v[24:27]
s_waitcnt lgkmcnt(6)
v_mfma_f32_16x16x32_bf16 v[28:31], v[52:55], v[96:99], v[28:31]
s_waitcnt lgkmcnt(5)
v_mfma_f32_16x16x32_bf16 v[32:35], v[56:59], v[96:99], v[32:35]
ds_read_b128 v[40:43], v1 offset:57344
ds_read_b128 v[44:47], v1 offset:58368
ds_read_b128 v[48:51], v1 offset:59392
ds_read_b128 v[52:55], v1 offset:60416
ds_read_b128 v[56:59], v1 offset:61440
s_waitcnt lgkmcnt(9)
v_mfma_f32_16x16x32_bf16 v[16:19], v[144:147], v[100:103], v[16:19]
s_waitcnt lgkmcnt(8)
v_mfma_f32_16x16x32_bf16 v[20:23], v[148:151], v[100:103], v[20:23]
s_waitcnt lgkmcnt(7)
v_mfma_f32_16x16x32_bf16 v[24:27], v[152:155], v[100:103], v[24:27]
s_waitcnt lgkmcnt(6)
v_mfma_f32_16x16x32_bf16 v[28:31], v[156:159], v[100:103], v[28:31]
s_waitcnt lgkmcnt(5)
v_mfma_f32_16x16x32_bf16 v[32:35], v[160:163], v[100:103], v[32:35]
ds_read_b128 v[144:147], v1 offset:62464
ds_read_b128 v[148:151], v1 offset:63488
ds_read_b128 v[152:155], v1 offset:64512
ds_read_b128 v[156:159], v248 offset:0
ds_read_b128 v[160:163], v248 offset:1024
s_waitcnt lgkmcnt(9)
v_mfma_f32_16x16x32_bf16 v[16:19], v[40:43], v[104:107], v[16:19]
s_waitcnt lgkmcnt(8)
v_mfma_f32_16x16x32_bf16 v[20:23], v[44:47], v[104:107], v[20:23]
s_waitcnt lgkmcnt(7)
v_mfma_f32_16x16x32_bf16 v[24:27], v[48:51], v[104:107], v[24:27]
s_waitcnt lgkmcnt(6)
v_mfma_f32_16x16x32_bf16 v[28:31], v[52:55], v[104:107], v[28:31]
s_waitcnt lgkmcnt(5)
v_mfma_f32_16x16x32_bf16 v[32:35], v[56:59], v[104:107], v[32:35]
ds_read_b128 v[40:43], v248 offset:2048
ds_read_b128 v[44:47], v248 offset:3072
ds_read_b128 v[48:51], v248 offset:4096
ds_read_b128 v[52:55], v248 offset:5120
ds_read_b128 v[56:59], v248 offset:6144
s_waitcnt lgkmcnt(9)
v_mfma_f32_16x16x32_bf16 v[16:19], v[144:147], v[108:111], v[16:19]
s_waitcnt lgkmcnt(8)
v_mfma_f32_16x16x32_bf16 v[20:23], v[148:151], v[108:111], v[20:23]
s_waitcnt lgkmcnt(7)
v_mfma_f32_16x16x32_bf16 v[24:27], v[152:155], v[108:111], v[24:27]
s_waitcnt lgkmcnt(6)
v_mfma_f32_16x16x32_bf16 v[28:31], v[156:159], v[108:111], v[28:31]
s_waitcnt lgkmcnt(5)
v_mfma_f32_16x16x32_bf16 v[32:35], v[160:163], v[108:111], v[32:35]
s_waitcnt lgkmcnt(4)
v_mfma_f32_16x16x32_bf16 v[16:19], v[40:43], v[112:115], v[16:19]
s_waitcnt lgkmcnt(3)
v_mfma_f32_16x16x32_bf16 v[20:23], v[44:47], v[112:115], v[20:23]
s_waitcnt lgkmcnt(2)
v_mfma_f32_16x16x32_bf16 v[24:27], v[48:51], v[112:115], v[24:27]
s_waitcnt lgkmcnt(1)
v_mfma_f32_16x16x32_bf16 v[28:31], v[52:55], v[112:115], v[28:31]
s_waitcnt lgkmcnt(0)
v_mfma_f32_16x16x32_bf16 v[32:35], v[56:59], v[112:115], v[32:35]
s_branch HU_91
HU_87:
s_cmp_eq_u32 s20, 1
s_cbranch_scc0 HU_88
ds_read_b128 v[40:43], v248 offset:7168
ds_read_b128 v[44:47], v248 offset:8192
ds_read_b128 v[48:51], v248 offset:9216
ds_read_b128 v[52:55], v248 offset:10240
ds_read_b128 v[56:59], v248 offset:11264
ds_read_b128 v[144:147], v248 offset:12288
ds_read_b128 v[148:151], v248 offset:13312
ds_read_b128 v[152:155], v248 offset:14336
ds_read_b128 v[156:159], v248 offset:15360
ds_read_b128 v[160:163], v248 offset:16384
s_waitcnt lgkmcnt(9)
v_mfma_f32_16x16x32_bf16 v[16:19], v[40:43], v[96:99], v[16:19]
s_waitcnt lgkmcnt(8)
v_mfma_f32_16x16x32_bf16 v[20:23], v[44:47], v[96:99], v[20:23]
s_waitcnt lgkmcnt(7)
v_mfma_f32_16x16x32_bf16 v[24:27], v[48:51], v[96:99], v[24:27]
s_waitcnt lgkmcnt(6)
v_mfma_f32_16x16x32_bf16 v[28:31], v[52:55], v[96:99], v[28:31]
s_waitcnt lgkmcnt(5)
v_mfma_f32_16x16x32_bf16 v[32:35], v[56:59], v[96:99], v[32:35]
ds_read_b128 v[40:43], v248 offset:17408
ds_read_b128 v[44:47], v248 offset:18432
ds_read_b128 v[48:51], v248 offset:19456
ds_read_b128 v[52:55], v248 offset:20480
ds_read_b128 v[56:59], v248 offset:21504
s_waitcnt lgkmcnt(9)
v_mfma_f32_16x16x32_bf16 v[16:19], v[144:147], v[100:103], v[16:19]
s_waitcnt lgkmcnt(8)
v_mfma_f32_16x16x32_bf16 v[20:23], v[148:151], v[100:103], v[20:23]
s_waitcnt lgkmcnt(7)
v_mfma_f32_16x16x32_bf16 v[24:27], v[152:155], v[100:103], v[24:27]
s_waitcnt lgkmcnt(6)
v_mfma_f32_16x16x32_bf16 v[28:31], v[156:159], v[100:103], v[28:31]
s_waitcnt lgkmcnt(5)
v_mfma_f32_16x16x32_bf16 v[32:35], v[160:163], v[100:103], v[32:35]
ds_read_b128 v[144:147], v248 offset:22528
ds_read_b128 v[148:151], v248 offset:23552
ds_read_b128 v[152:155], v248 offset:24576
ds_read_b128 v[156:159], v248 offset:25600
ds_read_b128 v[160:163], v248 offset:26624
s_waitcnt lgkmcnt(9)
v_mfma_f32_16x16x32_bf16 v[16:19], v[40:43], v[104:107], v[16:19]
s_waitcnt lgkmcnt(8)
v_mfma_f32_16x16x32_bf16 v[20:23], v[44:47], v[104:107], v[20:23]
s_waitcnt lgkmcnt(7)
v_mfma_f32_16x16x32_bf16 v[24:27], v[48:51], v[104:107], v[24:27]
s_waitcnt lgkmcnt(6)
v_mfma_f32_16x16x32_bf16 v[28:31], v[52:55], v[104:107], v[28:31]
s_waitcnt lgkmcnt(5)
v_mfma_f32_16x16x32_bf16 v[32:35], v[56:59], v[104:107], v[32:35]
ds_read_b128 v[40:43], v248 offset:27648
ds_read_b128 v[44:47], v248 offset:28672
ds_read_b128 v[48:51], v248 offset:29696
ds_read_b128 v[52:55], v248 offset:30720
ds_read_b128 v[56:59], v248 offset:31744
s_waitcnt lgkmcnt(9)
v_mfma_f32_16x16x32_bf16 v[16:19], v[144:147], v[108:111], v[16:19]
s_waitcnt lgkmcnt(8)
v_mfma_f32_16x16x32_bf16 v[20:23], v[148:151], v[108:111], v[20:23]
s_waitcnt lgkmcnt(7)
v_mfma_f32_16x16x32_bf16 v[24:27], v[152:155], v[108:111], v[24:27]
s_waitcnt lgkmcnt(6)
v_mfma_f32_16x16x32_bf16 v[28:31], v[156:159], v[108:111], v[28:31]
s_waitcnt lgkmcnt(5)
v_mfma_f32_16x16x32_bf16 v[32:35], v[160:163], v[108:111], v[32:35]
s_waitcnt lgkmcnt(4)
v_mfma_f32_16x16x32_bf16 v[16:19], v[40:43], v[112:115], v[16:19]
s_waitcnt lgkmcnt(3)
v_mfma_f32_16x16x32_bf16 v[20:23], v[44:47], v[112:115], v[20:23]
s_waitcnt lgkmcnt(2)
v_mfma_f32_16x16x32_bf16 v[24:27], v[48:51], v[112:115], v[24:27]
s_waitcnt lgkmcnt(1)
v_mfma_f32_16x16x32_bf16 v[28:31], v[52:55], v[112:115], v[28:31]
s_waitcnt lgkmcnt(0)
v_mfma_f32_16x16x32_bf16 v[32:35], v[56:59], v[112:115], v[32:35]
s_branch HU_91
HU_88:
s_cmp_eq_u32 s20, 2
s_cbranch_scc0 HU_89
ds_read_b128 v[40:43], v248 offset:32768
ds_read_b128 v[44:47], v248 offset:33792
ds_read_b128 v[48:51], v248 offset:34816
ds_read_b128 v[52:55], v248 offset:35840
ds_read_b128 v[56:59], v248 offset:36864
ds_read_b128 v[144:147], v248 offset:37888
ds_read_b128 v[148:151], v248 offset:38912
ds_read_b128 v[152:155], v248 offset:39936
ds_read_b128 v[156:159], v248 offset:40960
ds_read_b128 v[160:163], v248 offset:41984
s_waitcnt lgkmcnt(9)
v_mfma_f32_16x16x32_bf16 v[16:19], v[40:43], v[96:99], v[16:19]
s_waitcnt lgkmcnt(8)
v_mfma_f32_16x16x32_bf16 v[20:23], v[44:47], v[96:99], v[20:23]
s_waitcnt lgkmcnt(7)
v_mfma_f32_16x16x32_bf16 v[24:27], v[48:51], v[96:99], v[24:27]
s_waitcnt lgkmcnt(6)
v_mfma_f32_16x16x32_bf16 v[28:31], v[52:55], v[96:99], v[28:31]
s_waitcnt lgkmcnt(5)
v_mfma_f32_16x16x32_bf16 v[32:35], v[56:59], v[96:99], v[32:35]
ds_read_b128 v[40:43], v248 offset:43008
ds_read_b128 v[44:47], v248 offset:44032
ds_read_b128 v[48:51], v248 offset:45056
ds_read_b128 v[52:55], v248 offset:46080
ds_read_b128 v[56:59], v248 offset:47104
s_waitcnt lgkmcnt(9)
v_mfma_f32_16x16x32_bf16 v[16:19], v[144:147], v[100:103], v[16:19]
s_waitcnt lgkmcnt(8)
v_mfma_f32_16x16x32_bf16 v[20:23], v[148:151], v[100:103], v[20:23]
s_waitcnt lgkmcnt(7)
v_mfma_f32_16x16x32_bf16 v[24:27], v[152:155], v[100:103], v[24:27]
s_waitcnt lgkmcnt(6)
v_mfma_f32_16x16x32_bf16 v[28:31], v[156:159], v[100:103], v[28:31]
s_waitcnt lgkmcnt(5)
v_mfma_f32_16x16x32_bf16 v[32:35], v[160:163], v[100:103], v[32:35]
ds_read_b128 v[144:147], v248 offset:48128
ds_read_b128 v[148:151], v248 offset:49152
ds_read_b128 v[152:155], v248 offset:50176
ds_read_b128 v[156:159], v248 offset:51200
ds_read_b128 v[160:163], v248 offset:52224
s_waitcnt lgkmcnt(9)
v_mfma_f32_16x16x32_bf16 v[16:19], v[40:43], v[104:107], v[16:19]
s_waitcnt lgkmcnt(8)
v_mfma_f32_16x16x32_bf16 v[20:23], v[44:47], v[104:107], v[20:23]
s_waitcnt lgkmcnt(7)
v_mfma_f32_16x16x32_bf16 v[24:27], v[48:51], v[104:107], v[24:27]
s_waitcnt lgkmcnt(6)
v_mfma_f32_16x16x32_bf16 v[28:31], v[52:55], v[104:107], v[28:31]
s_waitcnt lgkmcnt(5)
v_mfma_f32_16x16x32_bf16 v[32:35], v[56:59], v[104:107], v[32:35]
s_waitcnt lgkmcnt(4)
v_mfma_f32_16x16x32_bf16 v[16:19], v[144:147], v[108:111], v[16:19]
s_waitcnt lgkmcnt(3)
v_mfma_f32_16x16x32_bf16 v[20:23], v[148:151], v[108:111], v[20:23]
s_waitcnt lgkmcnt(2)
v_mfma_f32_16x16x32_bf16 v[24:27], v[152:155], v[108:111], v[24:27]
s_waitcnt lgkmcnt(1)
v_mfma_f32_16x16x32_bf16 v[28:31], v[156:159], v[108:111], v[28:31]
s_waitcnt lgkmcnt(0)
v_mfma_f32_16x16x32_bf16 v[32:35], v[160:163], v[108:111], v[32:35]
s_branch HU_91
HU_89:
ds_read_b128 v[40:43], v248 offset:53248
ds_read_b128 v[44:47], v248 offset:54272
ds_read_b128 v[48:51], v248 offset:55296
ds_read_b128 v[52:55], v248 offset:56320
ds_read_b128 v[56:59], v248 offset:57344
ds_read_b128 v[144:147], v248 offset:58368
ds_read_b128 v[148:151], v248 offset:59392
ds_read_b128 v[152:155], v248 offset:60416
ds_read_b128 v[156:159], v248 offset:61440
ds_read_b128 v[160:163], v248 offset:62464
s_waitcnt lgkmcnt(9)
v_mfma_f32_16x16x32_bf16 v[16:19], v[40:43], v[96:99], v[16:19]
s_waitcnt lgkmcnt(8)
v_mfma_f32_16x16x32_bf16 v[20:23], v[44:47], v[96:99], v[20:23]
s_waitcnt lgkmcnt(7)
v_mfma_f32_16x16x32_bf16 v[24:27], v[48:51], v[96:99], v[24:27]
s_waitcnt lgkmcnt(6)
v_mfma_f32_16x16x32_bf16 v[28:31], v[52:55], v[96:99], v[28:31]
s_waitcnt lgkmcnt(5)
v_mfma_f32_16x16x32_bf16 v[32:35], v[56:59], v[96:99], v[32:35]
ds_read_b128 v[40:43], v1 offset:36864
ds_read_b128 v[44:47], v1 offset:37888
ds_read_b128 v[48:51], v1 offset:38912
ds_read_b128 v[52:55], v1 offset:39936
ds_read_b128 v[56:59], v1 offset:40960
s_waitcnt lgkmcnt(9)
v_mfma_f32_16x16x32_bf16 v[16:19], v[144:147], v[100:103], v[16:19]
s_waitcnt lgkmcnt(8)
v_mfma_f32_16x16x32_bf16 v[20:23], v[148:151], v[100:103], v[20:23]
s_waitcnt lgkmcnt(7)
v_mfma_f32_16x16x32_bf16 v[24:27], v[152:155], v[100:103], v[24:27]
s_waitcnt lgkmcnt(6)
v_mfma_f32_16x16x32_bf16 v[28:31], v[156:159], v[100:103], v[28:31]
s_waitcnt lgkmcnt(5)
v_mfma_f32_16x16x32_bf16 v[32:35], v[160:163], v[100:103], v[32:35]
ds_read_b128 v[144:147], v1 offset:41984
ds_read_b128 v[148:151], v1 offset:43008
ds_read_b128 v[152:155], v1 offset:44032
ds_read_b128 v[156:159], v1 offset:45056
ds_read_b128 v[160:163], v1 offset:46080
s_waitcnt lgkmcnt(9)
v_mfma_f32_16x16x32_bf16 v[16:19], v[40:43], v[104:107], v[16:19]
s_waitcnt lgkmcnt(8)
v_mfma_f32_16x16x32_bf16 v[20:23], v[44:47], v[104:107], v[20:23]
s_waitcnt lgkmcnt(7)
v_mfma_f32_16x16x32_bf16 v[24:27], v[48:51], v[104:107], v[24:27]
s_waitcnt lgkmcnt(6)
v_mfma_f32_16x16x32_bf16 v[28:31], v[52:55], v[104:107], v[28:31]
s_waitcnt lgkmcnt(5)
v_mfma_f32_16x16x32_bf16 v[32:35], v[56:59], v[104:107], v[32:35]
s_waitcnt lgkmcnt(4)
v_mfma_f32_16x16x32_bf16 v[16:19], v[144:147], v[108:111], v[16:19]
s_waitcnt lgkmcnt(3)
v_mfma_f32_16x16x32_bf16 v[20:23], v[148:151], v[108:111], v[20:23]
s_waitcnt lgkmcnt(2)
v_mfma_f32_16x16x32_bf16 v[24:27], v[152:155], v[108:111], v[24:27]
s_waitcnt lgkmcnt(1)
v_mfma_f32_16x16x32_bf16 v[28:31], v[156:159], v[108:111], v[28:31]
s_waitcnt lgkmcnt(0)
v_mfma_f32_16x16x32_bf16 v[32:35], v[160:163], v[108:111], v[32:35]
HU_91:
s_mul_i32 s52, s20, 5120
s_add_u32 s52, s52, 129024
v_add_u32 v5, s52, v1
ds_write_b128 v5, v[16:19] offset:0
ds_write_b128 v5, v[20:23] offset:1024
ds_write_b128 v5, v[24:27] offset:2048
ds_write_b128 v5, v[28:31] offset:3072
s_nop 0
ds_write_b128 v5, v[32:35] offset:4096
s_branch HG_81
HG_82:
s_cmp_eq_u32 s20, 7
s_cbranch_scc0 HG_81
s_waitcnt vmcnt(4)
s_cmp_eq_u32 s24, 1
s_cbranch_scc0 HG_92
v_max3_u32 v6, v96, v97, v98
v_max3_u32 v6, v6, v99, v100
v_max3_u32 v6, v6, v101, v102
v_max_u32 v6, v6, v103
v_cmp_eq_u32 vcc, -1, v6
s_cbranch_vccnz RT_93
RB_94:
HG_92:
v_add_f32 v252, v96, v98
v_add_f32 v253, v97, v99
v_add_f32 v252, v252, v100
v_add_f32 v253, v253, v101
v_add_f32 v252, v252, v102
v_add_f32 v253, v253, v103
v_mov_b32 v5, v252
s_nop 1
v_permlane16_swap_b32 v252, v5
s_nop 0
v_add_f32 v252, v252, v5
v_mov_b32 v5, v252
s_nop 1
v_permlane32_swap_b32 v252, v5
s_nop 0
v_add_f32 v252, v252, v5
v_mov_b32 v5, v253
s_nop 1
v_permlane16_swap_b32 v253, v5
s_nop 0
v_add_f32 v253, v253, v5
v_mov_b32 v5, v253
s_nop 1
v_permlane32_swap_b32 v253, v5
s_nop 0
v_add_f32 v253, v253, v5
v_mul_f32 v252, 0x3ae38e39, v252
v_mul_f32 v253, 0x3ae38e39, v253
v_fma_f32 v253, -v252, v252, v253
v_max_f32 v253, 0, v253
v_add_f32 v253, 0x3727c5ac, v253
v_rsq_f32 v253, v253
v_lshlrev_b32 v5, 3, v2
v_add_u32 v5, 162816, v5
ds_write_b64 v5, v[252:253]
HG_81:
s_lshl_b32 s52, s20, 4
s_add_u32 s52, s52, 16
v_add_u32 v6, s52, v2
v_mul_u32_u24 v6, 40, v6
v_lshl_add_u32 v14, v3, 3, v6
v_add_u32 v14, 92160, v14
v_mul_u32_u24 v15, 11520, v3
v_add_u32 v15, v15, v6
v_add_u32 v15, 92192, v15
s_waitcnt lgkmcnt(0)
v_pk_fma_f32 v[172:173], v[116:117], v[250:251], v[172:173] op_sel:[0,0,0] op_sel_hi:[1,0,1] neg_lo:[0,1,0] neg_hi:[0,1,0]
v_pk_fma_f32 v[174:175], v[118:119], v[250:251], v[174:175] op_sel:[0,0,0] op_sel_hi:[1,0,1] neg_lo:[0,1,0] neg_hi:[0,1,0]
v_pk_mul_f32 v[172:173], v[172:173], v[250:251] op_sel:[0,1] op_sel_hi:[1,1]
v_pk_mul_f32 v[174:175], v[174:175], v[250:251] op_sel:[0,1] op_sel_hi:[1,1]
v_cvt_pk_bf16_f32 v40, v172, v173
v_cvt_pk_bf16_f32 v41, v174, v175
v_pk_fma_f32 v[176:177], v[120:121], v[250:251], v[176:177] op_sel:[0,0,0] op_sel_hi:[1,0,1] neg_lo:[0,1,0] neg_hi:[0,1,0]
v_pk_fma_f32 v[178:179], v[122:123], v[250:251], v[178:179] op_sel:[0,0,0] op_sel_hi:[1,0,1] neg_lo:[0,1,0] neg_hi:[0,1,0]
v_pk_mul_f32 v[176:177], v[176:177], v[250:251] op_sel:[0,1] op_sel_hi:[1,1]
v_pk_mul_f32 v[178:179], v[178:179], v[250:251] op_sel:[0,1] op_sel_hi:[1,1]
v_cvt_pk_bf16_f32 v42, v176, v177
v_cvt_pk_bf16_f32 v43, v178, v179
v_pk_fma_f32 v[180:181], v[124:125], v[250:251], v[180:181] op_sel:[0,0,0] op_sel_hi:[1,0,1] neg_lo:[0,1,0] neg_hi:[0,1,0]
v_pk_fma_f32 v[182:183], v[126:127], v[250:251], v[182:183] op_sel:[0,0,0] op_sel_hi:[1,0,1] neg_lo:[0,1,0] neg_hi:[0,1,0]
v_pk_mul_f32 v[180:181], v[180:181], v[250:251] op_sel:[0,1] op_sel_hi:[1,1]
v_pk_mul_f32 v[182:183], v[182:183], v[250:251] op_sel:[0,1] op_sel_hi:[1,1]
v_cvt_pk_bf16_f32 v44, v180, v181
v_cvt_pk_bf16_f32 v45, v182, v183
v_pk_fma_f32 v[184:185], v[128:129], v[250:251], v[184:185] op_sel:[0,0,0] op_sel_hi:[1,0,1] neg_lo:[0,1,0] neg_hi:[0,1,0]
v_pk_fma_f32 v[186:187], v[130:131], v[250:251], v[186:187] op_sel:[0,0,0] op_sel_hi:[1,0,1] neg_lo:[0,1,0] neg_hi:[0,1,0]
v_pk_mul_f32 v[184:185], v[184:185], v[250:251] op_sel:[0,1] op_sel_hi:[1,1]
v_pk_mul_f32 v[186:187], v[186:187], v[250:251] op_sel:[0,1] op_sel_hi:[1,1]
v_cvt_pk_bf16_f32 v46, v184, v185
v_cvt_pk_bf16_f32 v47, v186, v187
v_pk_fma_f32 v[188:189], v[132:133], v[250:251], v[188:189] op_sel:[0,0,0] op_sel_hi:[1,0,1] neg_lo:[0,1,0] neg_hi:[0,1,0]
v_pk_fma_f32 v[190:191], v[134:135], v[250:251], v[190:191] op_sel:[0,0,0] op_sel_hi:[1,0,1] neg_lo:[0,1,0] neg_hi:[0,1,0]
v_pk_mul_f32 v[188:189], v[188:189], v[250:251] op_sel:[0,1] op_sel_hi:[1,1]
v_pk_mul_f32 v[190:191], v[190:191], v[250:251] op_sel:[0,1] op_sel_hi:[1,1]
v_cvt_pk_bf16_f32 v48, v188, v189
v_cvt_pk_bf16_f32 v49, v190, v191
v_pk_fma_f32 v[192:193], v[136:137], v[250:251], v[192:193] op_sel:[0,0,0] op_sel_hi:[1,0,1] neg_lo:[0,1,0] neg_hi:[0,1,0]
v_pk_fma_f32 v[194:195], v[138:139], v[250:251], v[194:195] op_sel:[0,0,0] op_sel_hi:[1,0,1] neg_lo:[0,1,0] neg_hi:[0,1,0]
v_pk_mul_f32 v[192:193], v[192:193], v[250:251] op_sel:[0,1] op_sel_hi:[1,1]
v_pk_mul_f32 v[194:195], v[194:195], v[250:251] op_sel:[0,1] op_sel_hi:[1,1]
v_cvt_pk_bf16_f32 v50, v192, v193
v_cvt_pk_bf16_f32 v51, v194, v195
v_pk_fma_f32 v[196:197], v[140:141], v[250:251], v[196:197] op_sel:[0,0,0] op_sel_hi:[1,0,1] neg_lo:[0,1,0] neg_hi:[0,1,0]
v_pk_fma_f32 v[198:199], v[142:143], v[250:251], v[198:199] op_sel:[0,0,0] op_sel_hi:[1,0,1] neg_lo:[0,1,0] neg_hi:[0,1,0]
v_pk_mul_f32 v[196:197], v[196:197], v[250:251] op_sel:[0,1] op_sel_hi:[1,1]
v_pk_mul_f32 v[198:199], v[198:199], v[250:251] op_sel:[0,1] op_sel_hi:[1,1]
v_cvt_pk_bf16_f32 v52, v196, v197
v_cvt_pk_bf16_f32 v53, v198, v199
s_barrier
ds_write_b64 v14, v[40:41] offset:0
s_add_u32 m0, s25, 18432
s_add_u32 s40, s66, 18432
buffer_load_dwordx4 v1, s[8:11], s40 offen lds
ds_write_b64 v14, v[42:43] offset:5760
s_add_u32 m0, s25, 26624
s_add_u32 s40, s66, 26624
buffer_load_dwordx4 v1, s[8:11], s40 offen lds
ds_write_b64 v14, v[44:45] offset:11520
s_add_u32 m0, s25, 34816
s_add_u32 s40, s66, 34816
buffer_load_dwordx4 v1, s[8:11], s40 offen lds
ds_write_b64 v14, v[46:47] offset:17280
s_add_u32 m0, s25, 43008
s_add_u32 s40, s66, 43008
buffer_load_dwordx4 v1, s[8:11], s40 offen lds
ds_write_b64 v14, v[50:51] offset:23040
s_add_u32 m0, s25, 51200
s_add_u32 s40, s66, 51200
buffer_load_dwordx4 v1, s[8:11], s40 offen lds
ds_write_b64 v14, v[52:53] offset:28800
s_add_u32 m0, s25, 59392
s_add_u32 s40, s66, 59392
buffer_load_dwordx4 v1, s[8:11], s40 offen lds
v_cmp_gt_u32 vcc, 3, v3
s_and_saveexec_b64 s[38:39], vcc
ds_write_b32 v15, v48
ds_write_b32 v15, v49 offset:5760
s_mov_b64 exec, s[38:39]
s_cmp_ge_u32 s20, 3
s_cbranch_scc0 QEE_97
s_sub_u32 s53, s20, 3
s_lshl_b32 s52, s53, 10
s_add_u32 s52, s52, 129024
v_add_u32 v5, s52, v1
ds_read_b128 v[56:59], v5 offset:0
ds_read_b128 v[60:63], v5 offset:5120
ds_read_b128 v[64:67], v5 offset:10240
ds_read_b128 v[68:71], v5 offset:15360
s_lshl_b32 s52, s53, 6
s_add_u32 s52, s52, 161792
v_lshlrev_b32 v5, 4, v3
v_add_u32 v5, s52, v5
ds_read_b128 v[72:75], v5
v_lshlrev_b32 v5, 3, v2
v_add_u32 v5, 162816, v5
ds_read_b64 v[252:253], v5
s_waitcnt lgkmcnt(0)
v_add_f32 v56, v56, v60
v_add_f32 v64, v64, v68
v_add_f32 v57, v57, v61
v_add_f32 v65, v65, v69
v_add_f32 v58, v58, v62
v_add_f32 v66, v66, v70
v_add_f32 v59, v59, v63
v_add_f32 v67, v67, v71
v_add_f32 v56, v56, v64
v_add_f32 v57, v57, v65
v_add_f32 v58, v58, v66
v_add_f32 v59, v59, v67
v_pk_fma_f32 v[56:57], v[72:73], v[252:253], v[56:57] op_sel:[0,0,0] op_sel_hi:[1,0,1] neg_lo:[0,1,0] neg_hi:[0,1,0]
v_pk_fma_f32 v[58:59], v[74:75], v[252:253], v[58:59] op_sel:[0,0,0] op_sel_hi:[1,0,1] neg_lo:[0,1,0] neg_hi:[0,1,0]
v_pk_mul_f32 v[56:57], v[56:57], v[252:253] op_sel:[0,1] op_sel_hi:[1,1]
v_pk_mul_f32 v[58:59], v[58:59], v[252:253] op_sel:[0,1] op_sel_hi:[1,1]
v_cvt_pk_bf16_f32 v76, v56, v57
v_cvt_pk_bf16_f32 v77, v58, v59
v_mul_u32_u24 v6, 40, v2
s_cmp_eq_u32 s53, 4
s_cbranch_scc1 QE4_96
s_mul_i32 s52, s53, 5760
s_add_u32 s52, s52, 92160
v_lshl_add_u32 v5, v3, 3, v6
v_add_u32 v5, s52, v5
ds_write_b64 v5, v[76:77]
s_branch QEE_97
QE4_96:
v_mul_u32_u24 v5, 11520, v3
v_add_u32 v5, v5, v6
v_add_u32 v5, 92192, v5
v_cmp_gt_u32 vcc, 3, v3
s_and_saveexec_b64 s[38:39], vcc
ds_write_b32 v5, v76
ds_write_b32 v5, v77 offset:5760
s_mov_b64 exec, s[38:39]
QEE_97:
s_waitcnt lgkmcnt(0)
s_barrier
s_cmp_lt_u32 s20, 4
s_cbranch_scc0 AI_99
ds_read_b64 v[32:33], v216 offset:0
ds_read_b64 v[34:35], v216 offset:8
ds_read_b64 v[36:37], v216 offset:16
ds_read_b64 v[38:39], v216 offset:24
ds_read_b32 v40, v216 offset:32
v_mov_b32 v41, 0
ds_read_b64 v[42:43], v216 offset:320
ds_read_b64 v[44:45], v216 offset:328
ds_read_b64 v[46:47], v216 offset:336
ds_read_b64 v[48:49], v216 offset:344
ds_read_b32 v50, v216 offset:352
v_mov_b32 v51, 0
ds_read_b64 v[52:53], v216 offset:640
ds_read_b64 v[54:55], v216 offset:648
ds_read_b64 v[56:57], v216 offset:656
ds_read_b64 v[58:59], v216 offset:664
ds_read_b32 v60, v216 offset:672
v_mov_b32 v61, 0
ds_read_b64 v[64:65], v216 offset:23680
ds_read_b64 v[66:67], v216 offset:23688
ds_read_b64 v[68:69], v216 offset:23696
ds_read_b64 v[70:71], v216 offset:23704
ds_read_b32 v72, v216 offset:23712
v_mov_b32 v73, 0
ds_read_b64_tr_b16 v[96:97], v217 offset:0
ds_read_b64_tr_b16 v[98:99], v217 offset:8
ds_read_b64_tr_b16 v[100:101], v217 offset:16
ds_read_b64_tr_b16 v[102:103], v217 offset:24
ds_read_b64_tr_b16 v[104:105], v217 offset:32
ds_read_b64_tr_b16 v[106:107], v217 offset:320
ds_read_b64_tr_b16 v[108:109], v217 offset:328
ds_read_b64_tr_b16 v[110:111], v217 offset:336
ds_read_b64_tr_b16 v[112:113], v217 offset:344
ds_read_b64_tr_b16 v[114:115], v217 offset:352
ds_read_b64_tr_b16 v[116:117], v217 offset:640
ds_read_b64_tr_b16 v[118:119], v217 offset:648
ds_read_b64_tr_b16 v[120:121], v217 offset:656
ds_read_b64_tr_b16 v[122:123], v217 offset:664
ds_read_b64_tr_b16 v[124:125], v217 offset:672
s_add_u32 m0, s25, 67584
s_add_u32 s40, s66, 67584
buffer_load_dwordx4 v1, s[8:11], s40 offen lds
s_cmp_lt_u32 s20, 7
s_cbranch_scc0 DS_100
s_add_u32 m0, s25, 75776
s_add_u32 s40, s66, 75776
buffer_load_dwordx4 v1, s[8:11], s40 offen lds
DS_100:
s_waitcnt lgkmcnt(15)
v_mfma_f32_4x4x4_16b_bf16 v[76:79], v[32:33], v[64:65], v[204:207]
v_mfma_f32_4x4x4_16b_bf16 v[80:83], v[42:43], v[64:65], v[208:211]
v_mfma_f32_4x4x4_16b_bf16 v[84:87], v[52:53], v[64:65], v[212:215]
v_mfma_f32_4x4x4_16b_bf16 v[76:79], v[34:35], v[66:67], v[76:79]
v_mfma_f32_4x4x4_16b_bf16 v[80:83], v[44:45], v[66:67], v[80:83]
v_mfma_f32_4x4x4_16b_bf16 v[84:87], v[54:55], v[66:67], v[84:87]
v_mfma_f32_4x4x4_16b_bf16 v[76:79], v[36:37], v[68:69], v[76:79]
v_mfma_f32_4x4x4_16b_bf16 v[80:83], v[46:47], v[68:69], v[80:83]
v_mfma_f32_4x4x4_16b_bf16 v[84:87], v[56:57], v[68:69], v[84:87]
v_mfma_f32_4x4x4_16b_bf16 v[76:79], v[38:39], v[70:71], v[76:79]
v_mfma_f32_4x4x4_16b_bf16 v[80:83], v[48:49], v[70:71], v[80:83]
v_mfma_f32_4x4x4_16b_bf16 v[84:87], v[58:59], v[70:71], v[84:87]
v_mfma_f32_4x4x4_16b_bf16 v[76:79], v[40:41], v[72:73], v[76:79]
v_mfma_f32_4x4x4_16b_bf16 v[80:83], v[50:51], v[72:73], v[80:83]
v_mfma_f32_4x4x4_16b_bf16 v[84:87], v[60:61], v[72:73], v[84:87]
s_add_u32 m0, s25, 82944
s_add_u32 s40, s65, 0
buffer_load_dwordx4 v1, s[8:11], s40 offen lds
v_max3_f32 v29, v76, v77, v78
v_max3_f32 v29, v29, v79, v80
v_max3_f32 v29, v29, v81, v82
v_max3_f32 v29, v29, v83, v84
v_max3_f32 v29, v29, v85, v86
v_max_f32 v29, v29, v87
s_mov_b32 s52, 0x3eae1a93
v_mul_f32 v29, s52, v29
v_mov_b32 v28, s52
v_pk_fma_f32 v[76:77], v[76:77], v[28:29], v[28:29] op_sel:[0,0,1] op_sel_hi:[1,0,1] neg_lo:[0,0,1] neg_hi:[0,0,1]
v_pk_fma_f32 v[78:79], v[78:79], v[28:29], v[28:29] op_sel:[0,0,1] op_sel_hi:[1,0,1] neg_lo:[0,0,1] neg_hi:[0,0,1]
v_pk_fma_f32 v[80:81], v[80:81], v[28:29], v[28:29] op_sel:[0,0,1] op_sel_hi:[1,0,1] neg_lo:[0,0,1] neg_hi:[0,0,1]
v_pk_fma_f32 v[82:83], v[82:83], v[28:29], v[28:29] op_sel:[0,0,1] op_sel_hi:[1,0,1] neg_lo:[0,0,1] neg_hi:[0,0,1]
v_pk_fma_f32 v[84:85], v[84:85], v[28:29], v[28:29] op_sel:[0,0,1] op_sel_hi:[1,0,1] neg_lo:[0,0,1] neg_hi:[0,0,1]
v_pk_fma_f32 v[86:87], v[86:87], v[28:29], v[28:29] op_sel:[0,0,1] op_sel_hi:[1,0,1] neg_lo:[0,0,1] neg_hi:[0,0,1]
v_exp_f32 v76, v76
v_exp_f32 v77, v77
v_exp_f32 v78, v78
v_exp_f32 v79, v79
v_exp_f32 v80, v80
v_exp_f32 v81, v81
v_exp_f32 v82, v82
v_exp_f32 v83, v83
v_exp_f32 v84, v84
v_exp_f32 v85, v85
v_exp_f32 v86, v86
v_exp_f32 v87, v87
v_cvt_pk_bf16_f32 v88, v76, v77
v_cvt_pk_bf16_f32 v89, v78, v79
v_cvt_pk_bf16_f32 v90, v80, v81
v_cvt_pk_bf16_f32 v91, v82, v83
v_cvt_pk_bf16_f32 v92, v84, v85
v_cvt_pk_bf16_f32 v93, v86, v87
v_mov_b32 v128, 0
v_mov_b32 v129, 0
v_mov_b32 v130, 0
v_mov_b32 v131, 0
v_mov_b32 v132, 0
v_mov_b32 v133, 0
v_mov_b32 v134, 0
v_mov_b32 v135, 0
v_mov_b32 v136, 0
v_mov_b32 v137, 0
v_mov_b32 v138, 0
v_mov_b32 v139, 0
v_mov_b32 v140, 0
v_mov_b32 v141, 0
v_mov_b32 v142, 0
v_mov_b32 v143, 0
v_mov_b32 v144, 0
v_mov_b32 v145, 0
v_mov_b32 v146, 0
v_mov_b32 v147, 0
s_waitcnt lgkmcnt(0)
v_mfma_f32_4x4x4_16b_bf16 v[128:131], v[96:97], v[88:89], v[128:131]
v_mfma_f32_4x4x4_16b_bf16 v[132:135], v[98:99], v[88:89], v[132:135]
v_mfma_f32_4x4x4_16b_bf16 v[136:139], v[100:101], v[88:89], v[136:139]
v_mfma_f32_4x4x4_16b_bf16 v[140:143], v[102:103], v[88:89], v[140:143]
v_mfma_f32_4x4x4_16b_bf16 v[144:147], v[104:105], v[88:89], v[144:147]
v_mfma_f32_4x4x4_16b_bf16 v[128:131], v[106:107], v[90:91], v[128:131]
v_mfma_f32_4x4x4_16b_bf16 v[132:135], v[108:109], v[90:91], v[132:135]
v_mfma_f32_4x4x4_16b_bf16 v[136:139], v[110:111], v[90:91], v[136:139]
v_mfma_f32_4x4x4_16b_bf16 v[140:143], v[112:113], v[90:91], v[140:143]
v_mfma_f32_4x4x4_16b_bf16 v[144:147], v[114:115], v[90:91], v[144:147]
v_mfma_f32_4x4x4_16b_bf16 v[128:131], v[116:117], v[92:93], v[128:131]
v_mfma_f32_4x4x4_16b_bf16 v[132:135], v[118:119], v[92:93], v[132:135]
v_mfma_f32_4x4x4_16b_bf16 v[136:139], v[120:121], v[92:93], v[136:139]
v_mfma_f32_4x4x4_16b_bf16 v[140:143], v[122:123], v[92:93], v[140:143]
v_mfma_f32_4x4x4_16b_bf16 v[144:147], v[124:125], v[92:93], v[144:147]
v_pk_add_f32 v[30:31], v[76:77], v[78:79]
v_pk_add_f32 v[28:29], v[80:81], v[82:83]
v_pk_add_f32 v[30:31], v[30:31], v[84:85]
v_pk_add_f32 v[28:29], v[28:29], v[86:87]
v_pk_add_f32 v[30:31], v[30:31], v[28:29]
v_add_f32 v30, v30, v31
v_rcp_f32 v30, v30
s_mul_i32 s52, s24, 4718592
s_add_u32 s52, s52, 16564224
s_mul_i32 s53, s21, 147456
s_add_u32 s52, s52, s53
s_lshl_b32 s53, s22, 10
s_add_u32 s53, s53, s52
s_lshr_b32 s54, s22, 3
s_add_u32 s54, s54, 16
s_lshl_b32 s54, s54, 10
s_add_u32 s54, s54, s52
s_bfe_u32 s55, s22, 0x20001
s_lshl_b32 s55, s55, 8
s_add_u32 s54, s54, s55
s_and_b32 s55, s22, 1
s_lshl_b32 s55, s55, 3
s_add_u32 s54, s54, s55
v_pk_mul_f32 v[128:129], v[128:129], v[30:31] op_sel:[0,0] op_sel_hi:[1,0]
v_pk_mul_f32 v[130:131], v[130:131], v[30:31] op_sel:[0,0] op_sel_hi:[1,0]
v_pk_mul_f32 v[132:133], v[132:133], v[30:31] op_sel:[0,0] op_sel_hi:[1,0]
v_pk_mul_f32 v[134:135], v[134:135], v[30:31] op_sel:[0,0] op_sel_hi:[1,0]
v_pk_mul_f32 v[136:137], v[136:137], v[30:31] op_sel:[0,0] op_sel_hi:[1,0]
v_pk_mul_f32 v[138:139], v[138:139], v[30:31] op_sel:[0,0] op_sel_hi:[1,0]
v_pk_mul_f32 v[140:141], v[140:141], v[30:31] op_sel:[0,0] op_sel_hi:[1,0]
v_pk_mul_f32 v[142:143], v[142:143], v[30:31] op_sel:[0,0] op_sel_hi:[1,0]
v_pk_mul_f32 v[144:145], v[144:145], v[30:31] op_sel:[0,0] op_sel_hi:[1,0]
v_cvt_pk_bf16_f32 v152, v128, v129
v_cvt_pk_bf16_f32 v153, v130, v131
v_cvt_pk_bf16_f32 v154, v132, v133
v_cvt_pk_bf16_f32 v155, v134, v135
v_cvt_pk_bf16_f32 v156, v136, v137
v_cvt_pk_bf16_f32 v157, v138, v139
v_cvt_pk_bf16_f32 v158, v140, v141
v_cvt_pk_bf16_f32 v159, v142, v143
v_cvt_pk_bf16_f32 v160, v144, v145
s_cmp_eq_u32 s23, 0
s_cbranch_scc0 HS_101
buffer_store_dwordx4 v[152:155], v218, s[8:11], s53 offen
buffer_store_dwordx4 v[156:159], v218, s[8:11], s53 offen offset:256
buffer_store_dword v160, v219, s[8:11], s54 offen
HJ_102:
s_cmp_lt_u32 s20, 1
s_cbranch_scc0 DS_103
s_add_u32 m0, s25, 91136
s_add_u32 s40, s65, 8192
buffer_load_dwordx4 v1, s[8:11], s40 offen lds
DS_103:
s_add_u32 m0, s25, 129024
s_add_u32 s40, s65, 9216
buffer_load_dwordx4 v1, s[8:11], s40 offen lds
s_add_u32 m0, s25, 137216
s_add_u32 s40, s65, 17408
buffer_load_dwordx4 v1, s[8:11], s40 offen lds
s_cmp_lt_u32 s20, 7
s_cbranch_scc0 DS_104
s_add_u32 m0, s25, 145408
s_add_u32 s40, s65, 25600
buffer_load_dwordx4 v1, s[8:11], s40 offen lds
DS_104:
s_branch AT_98
AI_99:
s_add_u32 m0, s25, 67584
s_add_u32 s40, s66, 67584
buffer_load_dwordx4 v1, s[8:11], s40 offen lds
s_cmp_lt_u32 s20, 7
s_cbranch_scc0 DS_105
s_add_u32 m0, s25, 75776
s_add_u32 s40, s66, 75776
buffer_load_dwordx4 v1, s[8:11], s40 offen lds
DS_105:
s_add_u32 m0, s25, 82944
s_add_u32 s40, s65, 0
buffer_load_dwordx4 v1, s[8:11], s40 offen lds
s_cmp_lt_u32 s20, 1
s_cbranch_scc0 DS_106
s_add_u32 m0, s25, 91136
s_add_u32 s40, s65, 8192
buffer_load_dwordx4 v1, s[8:11], s40 offen lds
DS_106:
s_add_u32 m0, s25, 129024
s_add_u32 s40, s65, 9216
buffer_load_dwordx4 v1, s[8:11], s40 offen lds
s_add_u32 m0, s25, 137216
s_add_u32 s40, s65, 17408
buffer_load_dwordx4 v1, s[8:11], s40 offen lds
s_cmp_lt_u32 s20, 7
s_cbranch_scc0 DS_107
s_add_u32 m0, s25, 145408
s_add_u32 s40, s65, 25600
buffer_load_dwordx4 v1, s[8:11], s40 offen lds
DS_107:
AT_98:
s_mul_i32 s45, s24, 4718592
s_add_u32 s45, s45, 16564224
s_add_u32 s45, s45, s71
s_lshl_b32 s44, s30, 13
s_add_u32 s44, s44, s45
s_lshl_b32 s43, s30, 10
s_add_u32 s43, s43, s45
s_add_u32 s43, s43, 16384
s_mul_i32 s47, s30, 4608
v_add_u32 v220, s47, v1
v_add_u32 v221, 0x10000, v220
v_add_u32 v222, 0x20000, v220
v_and_b32 v224, 7, v4
v_lshlrev_b32 v224, 4, v224
v_lshl_add_u32 v224, v3, 7, v224
v_add_u32 v224, s47, v224
v_add_u32 v224, 4096, v224
v_add_u32 v225, 0x10000, v224
v_add_u32 v226, 0x20000, v224
s_mov_b32 s39, 20000
s_mov_b64 exec, 0xffff
LP_108:
buffer_load_dword v6, v247, s[8:11], s43 offen sc1
s_waitcnt vmcnt(0)
v_cmp_eq_u32 vcc, -1, v6
s_sub_u32 s39, s39, 1
s_cbranch_scc1 LX_109
s_cbranch_vccnz LP_108
LX_109:
s_mov_b64 exec, -1
buffer_load_dwordx4 v[16:19], v1, s[8:11], s43 offen offset:0 sc1
buffer_load_dwordx4 v[20:23], v1, s[8:11], s44 offen offset:0 sc1
buffer_load_dwordx4 v[24:27], v1, s[8:11], s44 offen offset:1024 sc1
buffer_load_dwordx4 v[28:31], v1, s[8:11], s44 offen offset:2048 sc1
buffer_load_dwordx4 v[32:35], v1, s[8:11], s44 offen offset:3072 sc1
s_barrier
ds_read_b128 v[116:119], v220 offset:0
ds_read_b128 v[120:123], v220 offset:1024
ds_read_b128 v[124:127], v220 offset:2048
ds_read_b128 v[128:131], v220 offset:3072
ds_read_b128 v[132:135], v224 offset:0
ds_read_b128 v[136:139], v220 offset:9216
ds_read_b128 v[140:143], v220 offset:10240
ds_read_b128 v[144:147], v220 offset:11264
ds_read_b128 v[148:151], v220 offset:12288
ds_read_b128 v[152:155], v224 offset:9216
v_mov_b32 v172, 0
v_mov_b32 v173, 0
v_mov_b32 v174, 0
v_mov_b32 v175, 0
v_mov_b32 v176, 0
v_mov_b32 v177, 0
v_mov_b32 v178, 0
v_mov_b32 v179, 0
v_mov_b32 v180, 0
v_mov_b32 v181, 0
v_mov_b32 v182, 0
v_mov_b32 v183, 0
v_mov_b32 v184, 0
v_mov_b32 v185, 0
v_mov_b32 v186, 0
v_mov_b32 v187, 0
v_mov_b32 v188, 0
v_mov_b32 v189, 0
v_mov_b32 v190, 0
v_mov_b32 v191, 0
s_waitcnt vmcnt(4)
v_max3_u32 v6, v16, v17, v18
v_max_u32 v6, v6, v19
v_cmp_eq_u32 vcc, -1, v6
s_cbranch_vccnz RT_110
RB_111:
s_waitcnt lgkmcnt(9)
v_mfma_f32_16x16x32_bf16 v[172:175], v[116:119], v[16:19], v[172:175]
ds_read_b128 v[116:119], v220 offset:18432
s_add_u32 s40, s44, 4096
buffer_load_dwordx4 v[36:39], v1, s[8:11], s40 offen offset:0 sc1
s_waitcnt lgkmcnt(9)
v_mfma_f32_16x16x32_bf16 v[176:179], v[120:123], v[16:19], v[176:179]
ds_read_b128 v[120:123], v220 offset:19456
s_waitcnt lgkmcnt(9)
v_mfma_f32_16x16x32_bf16 v[180:183], v[124:127], v[16:19], v[180:183]
ds_read_b128 v[124:127], v220 offset:20480
s_waitcnt lgkmcnt(9)
v_mfma_f32_16x16x32_bf16 v[184:187], v[128:131], v[16:19], v[184:187]
ds_read_b128 v[128:131], v220 offset:21504
s_waitcnt vmcnt(4)
v_cmp_eq_u32 vcc, -1, v20
s_waitcnt lgkmcnt(9)
v_mfma_f32_16x16x32_bf16 v[188:191], v[132:135], v[16:19], v[188:191]
ds_read_b128 v[132:135], v224 offset:18432
s_cbranch_vccnz RT_113
RB_114:
s_waitcnt lgkmcnt(9)
v_mfma_f32_16x16x32_bf16 v[172:175], v[136:139], v[20:23], v[172:175]
ds_read_b128 v[136:139], v220 offset:27648
s_add_u32 s40, s44, 4096
buffer_load_dwordx4 v[40:43], v1, s[8:11], s40 offen offset:1024 sc1
s_waitcnt lgkmcnt(9)
v_mfma_f32_16x16x32_bf16 v[176:179], v[140:143], v[20:23], v[176:179]
ds_read_b128 v[140:143], v220 offset:28672
s_waitcnt lgkmcnt(9)
v_mfma_f32_16x16x32_bf16 v[180:183], v[144:147], v[20:23], v[180:183]
ds_read_b128 v[144:147], v220 offset:29696
s_waitcnt lgkmcnt(9)
v_mfma_f32_16x16x32_bf16 v[184:187], v[148:151], v[20:23], v[184:187]
ds_read_b128 v[148:151], v220 offset:30720
s_waitcnt vmcnt(4)
v_cmp_eq_u32 vcc, -1, v24
s_waitcnt lgkmcnt(9)
v_mfma_f32_16x16x32_bf16 v[188:191], v[152:155], v[20:23], v[188:191]
ds_read_b128 v[152:155], v224 offset:27648
s_cbranch_vccnz RT_116
RB_117:
s_waitcnt lgkmcnt(9)
v_mfma_f32_16x16x32_bf16 v[172:175], v[116:119], v[24:27], v[172:175]
ds_read_b128 v[116:119], v220 offset:36864
s_add_u32 s40, s44, 4096
buffer_load_dwordx4 v[44:47], v1, s[8:11], s40 offen offset:2048 sc1
s_waitcnt lgkmcnt(9)
v_mfma_f32_16x16x32_bf16 v[176:179], v[120:123], v[24:27], v[176:179]
ds_read_b128 v[120:123], v220 offset:37888
s_waitcnt lgkmcnt(9)
v_mfma_f32_16x16x32_bf16 v[180:183], v[124:127], v[24:27], v[180:183]
ds_read_b128 v[124:127], v220 offset:38912
s_waitcnt lgkmcnt(9)
v_mfma_f32_16x16x32_bf16 v[184:187], v[128:131], v[24:27], v[184:187]
ds_read_b128 v[128:131], v220 offset:39936
s_waitcnt vmcnt(4)
v_cmp_eq_u32 vcc, -1, v28
s_waitcnt lgkmcnt(9)
v_mfma_f32_16x16x32_bf16 v[188:191], v[132:135], v[24:27], v[188:191]
ds_read_b128 v[132:135], v224 offset:36864
s_cbranch_vccnz RT_119
RB_120:
s_waitcnt lgkmcnt(9)
v_mfma_f32_16x16x32_bf16 v[172:175], v[136:139], v[28:31], v[172:175]
ds_read_b128 v[136:139], v220 offset:46080
s_add_u32 s40, s44, 4096
buffer_load_dwordx4 v[48:51], v1, s[8:11], s40 offen offset:3072 sc1
s_waitcnt lgkmcnt(9)
v_mfma_f32_16x16x32_bf16 v[176:179], v[140:143], v[28:31], v[176:179]
ds_read_b128 v[140:143], v220 offset:47104
s_waitcnt lgkmcnt(9)
v_mfma_f32_16x16x32_bf16 v[180:183], v[144:147], v[28:31], v[180:183]
ds_read_b128 v[144:147], v220 offset:48128
s_waitcnt lgkmcnt(9)
v_mfma_f32_16x16x32_bf16 v[184:187], v[148:151], v[28:31], v[184:187]
ds_read_b128 v[148:151], v220 offset:49152
s_waitcnt vmcnt(4)
v_cmp_eq_u32 vcc, -1, v32
s_waitcnt lgkmcnt(9)
v_mfma_f32_16x16x32_bf16 v[188:191], v[152:155], v[28:31], v[188:191]
ds_read_b128 v[152:155], v224 offset:46080
s_cmp_eq_u32 s24, 0
s_cbranch_scc0 PC_122
v_mov_b32 v228, -1
v_mov_b32 v229, -1
v_mov_b32 v230, -1
v_mov_b32 v231, -1
s_mov_b32 s49, 10993664
s_add_u32 s46, s49, s90
s_add_u32 s47, s49, s91
s_add_u32 s48, s49, s92
s_cmp_eq_u32 s23, 0
s_cbranch_scc0 HS_123
buffer_store_dwordx4 v[228:231], v1, s[8:11], s46 offen
s_mov_b64 exec, s[72:73]
buffer_store_dwordx2 v[228:229], v7, s[8:11], s47 offen
s_mov_b64 exec, -1
s_mov_b64 exec, s[82:83]
buffer_store_dwordx2 v[228:229], v202, s[8:11], s48 offen
s_mov_b64 exec, -1
HJ_124:
PC_122:
s_add_u32 m0, s25, 92160
s_add_u32 s40, s65, 32768
buffer_load_dwordx4 v1, s[8:11], s40 offen lds
s_add_u32 m0, s25, 100352
s_add_u32 s40, s65, 40960
buffer_load_dwordx4 v1, s[8:11], s40 offen lds
s_cbranch_vccnz RT_125
RB_126:
s_waitcnt lgkmcnt(9)
v_mfma_f32_16x16x32_bf16 v[172:175], v[116:119], v[32:35], v[172:175]
ds_read_b128 v[116:119], v220 offset:55296
s_waitcnt lgkmcnt(9)
v_mfma_f32_16x16x32_bf16 v[176:179], v[120:123], v[32:35], v[176:179]
ds_read_b128 v[120:123], v220 offset:56320
s_waitcnt lgkmcnt(9)
v_mfma_f32_16x16x32_bf16 v[180:183], v[124:127], v[32:35], v[180:183]
ds_read_b128 v[124:127], v220 offset:57344
s_waitcnt lgkmcnt(9)
v_mfma_f32_16x16x32_bf16 v[184:187], v[128:131], v[32:35], v[184:187]
ds_read_b128 v[128:131], v220 offset:58368
s_waitcnt vmcnt(5)
v_cmp_eq_u32 vcc, -1, v36
s_waitcnt lgkmcnt(9)
v_mfma_f32_16x16x32_bf16 v[188:191], v[132:135], v[32:35], v[188:191]
ds_read_b128 v[132:135], v224 offset:55296
s_add_u32 m0, s25, 108544
s_add_u32 s40, s65, 49152
buffer_load_dwordx4 v1, s[8:11], s40 offen lds
s_cmp_lt_u32 s20, 7
s_cbranch_scc0 DS_128
s_add_u32 m0, s25, 116736
s_add_u32 s40, s65, 57344
buffer_load_dwordx4 v1, s[8:11], s40 offen lds
DS_128:
s_barrier
s_add_u32 m0, s25, 0
s_add_u32 s40, s65, 64512
buffer_load_dwordx4 v1, s[8:11], s40 offen lds
s_add_u32 m0, s25, 8192
s_add_u32 s40, s65, 72704
buffer_load_dwordx4 v1, s[8:11], s40 offen lds
s_cbranch_vccnz RT_129
RB_130:
s_waitcnt lgkmcnt(9)
v_mfma_f32_16x16x32_bf16 v[172:175], v[136:139], v[36:39], v[172:175]
ds_read_b128 v[136:139], v220 offset:64512
s_waitcnt lgkmcnt(9)
v_mfma_f32_16x16x32_bf16 v[176:179], v[140:143], v[36:39], v[176:179]
ds_read_b128 v[140:143], v221 offset:0
s_waitcnt lgkmcnt(9)
v_mfma_f32_16x16x32_bf16 v[180:183], v[144:147], v[36:39], v[180:183]
ds_read_b128 v[144:147], v221 offset:1024
s_waitcnt lgkmcnt(9)
v_mfma_f32_16x16x32_bf16 v[184:187], v[148:151], v[36:39], v[184:187]
ds_read_b128 v[148:151], v221 offset:2048
s_waitcnt vmcnt(7)
v_cmp_eq_u32 vcc, -1, v40
s_waitcnt lgkmcnt(9)
v_mfma_f32_16x16x32_bf16 v[188:191], v[152:155], v[36:39], v[188:191]
ds_read_b128 v[152:155], v224 offset:64512
s_add_u32 m0, s25, 16384
s_add_u32 s40, s65, 80896
buffer_load_dwordx4 v1, s[8:11], s40 offen lds
s_cmp_lt_u32 s20, 3
s_cbranch_scc0 DS_132
s_add_u32 m0, s25, 24576
s_add_u32 s40, s65, 89088
buffer_load_dwordx4 v1, s[8:11], s40 offen lds
DS_132:
s_cbranch_vccnz RT_133
RB_134:
s_waitcnt lgkmcnt(9)
v_mfma_f32_16x16x32_bf16 v[172:175], v[116:119], v[40:43], v[172:175]
ds_read_b128 v[116:119], v221 offset:8192
s_waitcnt lgkmcnt(9)
v_mfma_f32_16x16x32_bf16 v[176:179], v[120:123], v[40:43], v[176:179]
ds_read_b128 v[120:123], v221 offset:9216
s_waitcnt lgkmcnt(9)
v_mfma_f32_16x16x32_bf16 v[180:183], v[124:127], v[40:43], v[180:183]
ds_read_b128 v[124:127], v221 offset:10240
s_waitcnt lgkmcnt(9)
v_mfma_f32_16x16x32_bf16 v[184:187], v[128:131], v[40:43], v[184:187]
ds_read_b128 v[128:131], v221 offset:11264
s_waitcnt vmcnt(7)
v_cmp_eq_u32 vcc, -1, v44
s_waitcnt lgkmcnt(9)
v_mfma_f32_16x16x32_bf16 v[188:191], v[132:135], v[40:43], v[188:191]
ds_read_b128 v[132:135], v225 offset:8192
s_add_u32 m0, s25, 27648
s_add_u32 s40, s65, 92160
buffer_load_dwordx4 v1, s[8:11], s40 offen lds
s_add_u32 m0, s25, 35840
s_add_u32 s40, s65, 100352
buffer_load_dwordx4 v1, s[8:11], s40 offen lds
s_cbranch_vccnz RT_136
RB_137:
s_waitcnt lgkmcnt(9)
v_mfma_f32_16x16x32_bf16 v[172:175], v[136:139], v[44:47], v[172:175]
s_waitcnt lgkmcnt(8)
v_mfma_f32_16x16x32_bf16 v[176:179], v[140:143], v[44:47], v[176:179]
s_waitcnt lgkmcnt(7)
v_mfma_f32_16x16x32_bf16 v[180:183], v[144:147], v[44:47], v[180:183]
s_waitcnt lgkmcnt(6)
v_mfma_f32_16x16x32_bf16 v[184:187], v[148:151], v[44:47], v[184:187]
s_waitcnt vmcnt(8)
v_cmp_eq_u32 vcc, -1, v48
s_waitcnt lgkmcnt(5)
v_mfma_f32_16x16x32_bf16 v[188:191], v[152:155], v[44:47], v[188:191]
s_cmp_lt_u32 s20, 2
s_cbranch_scc0 DS_139
s_add_u32 m0, s25, 44032
s_add_u32 s40, s65, 108544
buffer_load_dwordx4 v1, s[8:11], s40 offen lds
DS_139:
s_cbranch_vccnz RT_140
RB_141:
s_waitcnt lgkmcnt(4)
v_mfma_f32_16x16x32_bf16 v[172:175], v[116:119], v[48:51], v[172:175]
s_waitcnt lgkmcnt(3)
v_mfma_f32_16x16x32_bf16 v[176:179], v[120:123], v[48:51], v[176:179]
s_waitcnt lgkmcnt(2)
v_mfma_f32_16x16x32_bf16 v[180:183], v[124:127], v[48:51], v[180:183]
s_waitcnt lgkmcnt(1)
v_mfma_f32_16x16x32_bf16 v[184:187], v[128:131], v[48:51], v[184:187]
s_waitcnt lgkmcnt(0)
v_mfma_f32_16x16x32_bf16 v[188:191], v[132:135], v[48:51], v[188:191]
s_barrier
s_add_u32 m0, s25, 46080
s_add_u32 s40, s65, 110592
buffer_load_dwordx4 v1, s[8:11], s40 offen lds
s_add_u32 m0, s25, 54272
s_add_u32 s40, s65, 118784
buffer_load_dwordx4 v1, s[8:11], s40 offen lds
s_cmp_lt_u32 s20, 2
s_cbranch_scc0 DS_143
s_add_u32 m0, s25, 62464
s_add_u32 s40, s65, 126976
buffer_load_dwordx4 v1, s[8:11], s40 offen lds
DS_143:
s_mul_i32 s47, s29, 4608
s_add_u32 s47, s47, 64512
v_add_u32 v220, s47, v1
v_and_b32 v221, 31, v4
v_lshlrev_b32 v221, 4, v221
v_add_u32 v221, s47, v221
s_mov_b64 exec, s[74:75]
ds_write_b128 v221, v[188:191] offset:4096
s_mov_b64 exec, -1
s_cmp_eq_u32 s30, 0
s_cbranch_scc0 PE_144
ds_write_b128 v220, v[180:183] offset:2048
ds_write_b128 v220, v[184:187] offset:3072
s_branch PE_145
PE_144:
ds_write_b128 v220, v[172:175]
ds_write_b128 v220, v[176:179] offset:1024
PE_145:
s_waitcnt lgkmcnt(0)
s_barrier
ds_read_b128 v[40:43], v221 offset:4096
s_cmp_eq_u32 s30, 0
s_cbranch_scc0 PE_146
ds_read_b128 v[32:35], v220
ds_read_b128 v[36:39], v220 offset:1024
s_waitcnt lgkmcnt(0)
v_pk_add_f32 v[32:33], v[32:33], v[172:173]
v_pk_add_f32 v[34:35], v[34:35], v[174:175]
v_pk_add_f32 v[36:37], v[36:37], v[176:177]
v_pk_add_f32 v[38:39], v[38:39], v[178:179]
s_branch PE_147
PE_146:
ds_read_b128 v[32:35], v220 offset:2048
ds_read_b128 v[36:39], v220 offset:3072
s_waitcnt lgkmcnt(0)
v_pk_add_f32 v[32:33], v[32:33], v[180:181]
v_pk_add_f32 v[34:35], v[34:35], v[182:183]
v_pk_add_f32 v[36:37], v[36:37], v[184:185]
v_pk_add_f32 v[38:39], v[38:39], v[186:187]
PE_147:
v_pk_add_f32 v[40:41], v[40:41], v[188:189]
v_pk_add_f32 v[42:43], v[42:43], v[190:191]
v_lshlrev_b32 v44, 16, v8
v_and_b32 v45, 0xffff0000, v8
v_pk_add_f32 v[32:33], v[32:33], v[44:45]
v_cvt_pk_bf16_f32 v8, v32, v33
v_lshlrev_b32 v46, 16, v9
v_and_b32 v47, 0xffff0000, v9
v_pk_add_f32 v[34:35], v[34:35], v[46:47]
v_cvt_pk_bf16_f32 v9, v34, v35
v_lshlrev_b32 v44, 16, v10
v_and_b32 v45, 0xffff0000, v10
v_pk_add_f32 v[36:37], v[36:37], v[44:45]
v_cvt_pk_bf16_f32 v10, v36, v37
v_lshlrev_b32 v46, 16, v11
v_and_b32 v47, 0xffff0000, v11
v_pk_add_f32 v[38:39], v[38:39], v[46:47]
v_cvt_pk_bf16_f32 v11, v38, v39
v_lshlrev_b32 v44, 16, v12
v_and_b32 v45, 0xffff0000, v12
v_pk_add_f32 v[40:41], v[40:41], v[44:45]
v_cvt_pk_bf16_f32 v12, v40, v41
v_lshlrev_b32 v46, 16, v13
v_and_b32 v47, 0xffff0000, v13
v_pk_add_f32 v[42:43], v[42:43], v[46:47]
v_cvt_pk_bf16_f32 v13, v42, v43
s_mul_i32 s45, s24, 5242880
s_add_u32 s45, s45, 8372224
s_add_u32 s46, s45, s90
s_add_u32 s47, s45, s91
s_add_u32 s48, s45, s92
s_cmp_eq_u32 s23, 0
s_cbranch_scc0 HS_148
buffer_store_dwordx4 v[8:11], v1, s[8:11], s46 offen
v_cndmask_b32_e64 v50, 0, v12, s[72:73]
v_cndmask_b32_e64 v51, 0, v13, s[72:73]
v_mov_b32 v52, 0
v_mov_b32 v53, 0
v_mfma_f32_16x16x32_bf16 v[56:59], v[236:239], v[8:11], 0
v_mfma_f32_16x16x32_bf16 v[60:63], v[8:11], v[8:11], 0
s_mov_b64 exec, s[72:73]
buffer_store_dwordx2 v[12:13], v7, s[8:11], s47 offen
s_mov_b64 exec, -1
v_mfma_f32_16x16x32_bf16 v[56:59], v[236:239], v[50:53], v[56:59]
v_mfma_f32_16x16x32_bf16 v[60:63], v[50:53], v[50:53], v[60:63]
s_nop 7
v_cndmask_b32_e64 v60, v60, v61, s[76:77]
v_cndmask_b32_e64 v60, v60, v62, s[78:79]
v_cndmask_b32_e64 v57, v60, v63, s[80:81]
s_mov_b64 exec, s[82:83]
buffer_store_dwordx2 v[56:57], v202, s[8:11], s48 offen
s_mov_b64 exec, -1
HJ_149:
s_mul_i32 s45, s24, 5242880
s_add_u32 s45, s45, 8372224
s_add_u32 s46, s45, s70
s_mov_b32 s39, 20000
s_mov_b64 exec, 0xffff
LP_150:
buffer_load_dword v6, v246, s[8:11], s46 offen sc1
s_waitcnt vmcnt(0)
v_cmp_eq_u32 vcc, -1, v6
s_sub_u32 s39, s39, 1
s_cbranch_scc1 LX_151
s_cbranch_vccnz LP_150
LX_151:
s_mov_b64 exec, -1
s_add_u32 s40, s46, 16384
buffer_load_dwordx4 v[16:19], v1, s[8:11], s40 offen offset:0 sc1
s_add_u32 s40, s46, 16384
buffer_load_dwordx4 v[20:23], v1, s[8:11], s40 offen offset:1024 sc1
buffer_load_dwordx4 v[24:27], v1, s[8:11], s46 offen offset:0 sc1
buffer_load_dwordx4 v[28:31], v1, s[8:11], s46 offen offset:1024 sc1
buffer_load_dwordx4 v[32:35], v1, s[8:11], s46 offen offset:2048 sc1
s_barrier
ds_read_b128 v[116:119], v248 offset:17408
ds_read_b128 v[120:123], v248 offset:18432
ds_read_b128 v[124:127], v248 offset:19456
ds_read_b128 v[128:131], v248 offset:20480
ds_read_b128 v[132:135], v248 offset:21504
ds_read_b128 v[136:139], v248 offset:22528
ds_read_b128 v[140:143], v248 offset:23552
ds_read_b128 v[144:147], v248 offset:24576
ds_read_b128 v[148:151], v248 offset:25600
ds_read_b128 v[152:155], v248 offset:63488
v_mov_b32 v172, 0
v_mov_b32 v173, 0
v_mov_b32 v174, 0
v_mov_b32 v175, 0
v_mov_b32 v176, 0
v_mov_b32 v177, 0
v_mov_b32 v178, 0
v_mov_b32 v179, 0
v_mov_b32 v180, 0
v_mov_b32 v181, 0
v_mov_b32 v182, 0
v_mov_b32 v183, 0
v_mov_b32 v184, 0
v_mov_b32 v185, 0
v_mov_b32 v186, 0
v_mov_b32 v187, 0
v_mov_b32 v188, 0
v_mov_b32 v189, 0
v_mov_b32 v190, 0
v_mov_b32 v191, 0
s_waitcnt vmcnt(4)
v_max_u32 v6, v16, v18
v_cmp_eq_u32 vcc, -1, v6
s_cbranch_vccnz RT_152
RB_153:
s_waitcnt lgkmcnt(9)
v_mfma_f32_16x16x32_bf16 v[172:175], v[116:119], v[16:19], v[172:175]
ds_read_b128 v[116:119], v248 offset:64512
buffer_load_dwordx4 v[36:39], v1, s[8:11], s46 offen offset:3072 sc1
s_waitcnt lgkmcnt(9)
v_mfma_f32_16x16x32_bf16 v[176:179], v[120:123], v[16:19], v[176:179]
ds_read_b128 v[120:123], v249 offset:0
s_waitcnt lgkmcnt(9)
v_mfma_f32_16x16x32_bf16 v[180:183], v[124:127], v[16:19], v[180:183]
ds_read_b128 v[124:127], v249 offset:1024
s_waitcnt lgkmcnt(9)
v_mfma_f32_16x16x32_bf16 v[184:187], v[128:131], v[16:19], v[184:187]
ds_read_b128 v[128:131], v249 offset:2048
s_waitcnt vmcnt(4)
v_max_u32 v6, v20, v22
v_cmp_eq_u32 vcc, -1, v6
s_waitcnt lgkmcnt(9)
v_mfma_f32_16x16x32_bf16 v[188:191], v[132:135], v[16:19], v[188:191]
ds_read_b128 v[132:135], v249 offset:3072
s_cbranch_vccnz RT_155
RB_156:
s_waitcnt lgkmcnt(9)
v_mfma_f32_16x16x32_bf16 v[172:175], v[136:139], v[20:23], v[172:175]
ds_read_b128 v[136:139], v249 offset:4096
s_add_u32 s40, s46, 4096
buffer_load_dwordx4 v[40:43], v1, s[8:11], s40 offen offset:0 sc1
s_waitcnt lgkmcnt(9)
v_mfma_f32_16x16x32_bf16 v[176:179], v[140:143], v[20:23], v[176:179]
ds_read_b128 v[140:143], v249 offset:5120
s_waitcnt lgkmcnt(9)
v_mfma_f32_16x16x32_bf16 v[180:183], v[144:147], v[20:23], v[180:183]
ds_read_b128 v[144:147], v249 offset:6144
s_waitcnt lgkmcnt(9)
v_mfma_f32_16x16x32_bf16 v[184:187], v[148:151], v[20:23], v[184:187]
ds_read_b128 v[148:151], v249 offset:7168
s_waitcnt vmcnt(4)
v_cmp_eq_u32 vcc, -1, v24
s_waitcnt lgkmcnt(9)
v_mfma_f32_16x16x32_bf16 v[188:191], v[152:155], v[20:23], v[188:191]
ds_read_b128 v[152:155], v249 offset:8192
s_cbranch_vccnz RT_158
RB_159:
s_waitcnt lgkmcnt(9)
v_mfma_f32_16x16x32_bf16 v[172:175], v[116:119], v[24:27], v[172:175]
ds_read_b128 v[116:119], v249 offset:9216
s_add_u32 s40, s46, 4096
buffer_load_dwordx4 v[44:47], v1, s[8:11], s40 offen offset:1024 sc1
s_waitcnt lgkmcnt(9)
v_mfma_f32_16x16x32_bf16 v[176:179], v[120:123], v[24:27], v[176:179]
ds_read_b128 v[120:123], v249 offset:10240
s_waitcnt lgkmcnt(9)
v_mfma_f32_16x16x32_bf16 v[180:183], v[124:127], v[24:27], v[180:183]
ds_read_b128 v[124:127], v249 offset:11264
s_waitcnt lgkmcnt(9)
v_mfma_f32_16x16x32_bf16 v[184:187], v[128:131], v[24:27], v[184:187]
ds_read_b128 v[128:131], v249 offset:12288
s_waitcnt vmcnt(4)
v_cmp_eq_u32 vcc, -1, v28
s_waitcnt lgkmcnt(9)
v_mfma_f32_16x16x32_bf16 v[188:191], v[132:135], v[24:27], v[188:191]
ds_read_b128 v[132:135], v249 offset:13312
s_cbranch_vccnz RT_161
RB_162:
s_waitcnt lgkmcnt(9)
v_mfma_f32_16x16x32_bf16 v[172:175], v[136:139], v[28:31], v[172:175]
ds_read_b128 v[136:139], v249 offset:14336
s_add_u32 s40, s46, 4096
buffer_load_dwordx4 v[48:51], v1, s[8:11], s40 offen offset:2048 sc1
s_waitcnt lgkmcnt(9)
v_mfma_f32_16x16x32_bf16 v[176:179], v[140:143], v[28:31], v[176:179]
ds_read_b128 v[140:143], v249 offset:15360
s_waitcnt lgkmcnt(9)
v_mfma_f32_16x16x32_bf16 v[180:183], v[144:147], v[28:31], v[180:183]
ds_read_b128 v[144:147], v249 offset:16384
s_waitcnt lgkmcnt(9)
v_mfma_f32_16x16x32_bf16 v[184:187], v[148:151], v[28:31], v[184:187]
ds_read_b128 v[148:151], v249 offset:17408
s_waitcnt vmcnt(4)
v_cmp_eq_u32 vcc, -1, v32
s_waitcnt lgkmcnt(9)
v_mfma_f32_16x16x32_bf16 v[188:191], v[152:155], v[28:31], v[188:191]
ds_read_b128 v[152:155], v249 offset:18432
s_cbranch_vccnz RT_164
RB_165:
s_waitcnt lgkmcnt(9)
v_mfma_f32_16x16x32_bf16 v[172:175], v[116:119], v[32:35], v[172:175]
ds_read_b128 v[116:119], v249 offset:19456
s_add_u32 s40, s46, 4096
buffer_load_dwordx4 v[52:55], v1, s[8:11], s40 offen offset:3072 sc1
s_waitcnt lgkmcnt(9)
v_mfma_f32_16x16x32_bf16 v[176:179], v[120:123], v[32:35], v[176:179]
ds_read_b128 v[120:123], v249 offset:20480
s_waitcnt lgkmcnt(9)
v_mfma_f32_16x16x32_bf16 v[180:183], v[124:127], v[32:35], v[180:183]
ds_read_b128 v[124:127], v248 offset:26624
s_waitcnt lgkmcnt(9)
v_mfma_f32_16x16x32_bf16 v[184:187], v[128:131], v[32:35], v[184:187]
ds_read_b128 v[128:131], v248 offset:27648
s_waitcnt vmcnt(4)
v_cmp_eq_u32 vcc, -1, v36
s_waitcnt lgkmcnt(9)
v_mfma_f32_16x16x32_bf16 v[188:191], v[132:135], v[32:35], v[188:191]
ds_read_b128 v[132:135], v248 offset:28672
s_cbranch_vccnz RT_167
RB_168:
s_waitcnt lgkmcnt(9)
v_mfma_f32_16x16x32_bf16 v[172:175], v[136:139], v[36:39], v[172:175]
ds_read_b128 v[136:139], v248 offset:29696
s_add_u32 s40, s46, 8192
buffer_load_dwordx4 v[56:59], v1, s[8:11], s40 offen offset:0 sc1
s_waitcnt lgkmcnt(9)
v_mfma_f32_16x16x32_bf16 v[176:179], v[140:143], v[36:39], v[176:179]
ds_read_b128 v[140:143], v248 offset:30720
s_waitcnt lgkmcnt(9)
v_mfma_f32_16x16x32_bf16 v[180:183], v[144:147], v[36:39], v[180:183]
ds_read_b128 v[144:147], v248 offset:31744
s_waitcnt lgkmcnt(9)
v_mfma_f32_16x16x32_bf16 v[184:187], v[148:151], v[36:39], v[184:187]
ds_read_b128 v[148:151], v248 offset:32768
s_waitcnt vmcnt(4)
v_cmp_eq_u32 vcc, -1, v40
s_waitcnt lgkmcnt(9)
v_mfma_f32_16x16x32_bf16 v[188:191], v[152:155], v[36:39], v[188:191]
ds_read_b128 v[152:155], v248 offset:33792
s_cbranch_vccnz RT_170
RB_171:
s_waitcnt lgkmcnt(9)
v_mfma_f32_16x16x32_bf16 v[172:175], v[116:119], v[40:43], v[172:175]
ds_read_b128 v[116:119], v248 offset:34816
s_add_u32 s40, s46, 8192
buffer_load_dwordx4 v[60:63], v1, s[8:11], s40 offen offset:1024 sc1
s_waitcnt lgkmcnt(9)
v_mfma_f32_16x16x32_bf16 v[176:179], v[120:123], v[40:43], v[176:179]
ds_read_b128 v[120:123], v248 offset:35840
s_waitcnt lgkmcnt(9)
v_mfma_f32_16x16x32_bf16 v[180:183], v[124:127], v[40:43], v[180:183]
ds_read_b128 v[124:127], v248 offset:36864
s_waitcnt lgkmcnt(9)
v_mfma_f32_16x16x32_bf16 v[184:187], v[128:131], v[40:43], v[184:187]
ds_read_b128 v[128:131], v248 offset:37888
s_waitcnt vmcnt(4)
v_cmp_eq_u32 vcc, -1, v44
s_waitcnt lgkmcnt(9)
v_mfma_f32_16x16x32_bf16 v[188:191], v[132:135], v[40:43], v[188:191]
ds_read_b128 v[132:135], v248 offset:38912
s_cbranch_vccnz RT_173
RB_174:
s_waitcnt lgkmcnt(9)
v_mfma_f32_16x16x32_bf16 v[172:175], v[136:139], v[44:47], v[172:175]
ds_read_b128 v[136:139], v248 offset:39936
s_add_u32 s40, s46, 8192
buffer_load_dwordx4 v[64:67], v1, s[8:11], s40 offen offset:2048 sc1
s_waitcnt lgkmcnt(9)
v_mfma_f32_16x16x32_bf16 v[176:179], v[140:143], v[44:47], v[176:179]
ds_read_b128 v[140:143], v248 offset:40960
s_waitcnt lgkmcnt(9)
v_mfma_f32_16x16x32_bf16 v[180:183], v[144:147], v[44:47], v[180:183]
ds_read_b128 v[144:147], v248 offset:41984
s_waitcnt lgkmcnt(9)
v_mfma_f32_16x16x32_bf16 v[184:187], v[148:151], v[44:47], v[184:187]
ds_read_b128 v[148:151], v248 offset:43008
s_waitcnt vmcnt(4)
v_cmp_eq_u32 vcc, -1, v48
s_waitcnt lgkmcnt(9)
v_mfma_f32_16x16x32_bf16 v[188:191], v[152:155], v[44:47], v[188:191]
ds_read_b128 v[152:155], v248 offset:44032
s_cbranch_vccnz RT_176
RB_177:
s_waitcnt lgkmcnt(9)
v_mfma_f32_16x16x32_bf16 v[172:175], v[116:119], v[48:51], v[172:175]
ds_read_b128 v[116:119], v248 offset:45056
s_add_u32 s40, s46, 8192
buffer_load_dwordx4 v[68:71], v1, s[8:11], s40 offen offset:3072 sc1
s_waitcnt lgkmcnt(9)
v_mfma_f32_16x16x32_bf16 v[176:179], v[120:123], v[48:51], v[176:179]
ds_read_b128 v[120:123], v248 offset:46080
s_waitcnt lgkmcnt(9)
v_mfma_f32_16x16x32_bf16 v[180:183], v[124:127], v[48:51], v[180:183]
ds_read_b128 v[124:127], v248 offset:47104
s_waitcnt lgkmcnt(9)
v_mfma_f32_16x16x32_bf16 v[184:187], v[128:131], v[48:51], v[184:187]
ds_read_b128 v[128:131], v248 offset:48128
s_waitcnt vmcnt(4)
v_cmp_eq_u32 vcc, -1, v52
s_waitcnt lgkmcnt(9)
v_mfma_f32_16x16x32_bf16 v[188:191], v[132:135], v[48:51], v[188:191]
ds_read_b128 v[132:135], v248 offset:49152
s_barrier
s_cbranch_vccnz RT_179
RB_180:
s_waitcnt lgkmcnt(9)
v_mfma_f32_16x16x32_bf16 v[172:175], v[136:139], v[52:55], v[172:175]
ds_read_b128 v[136:139], v248 offset:50176
s_add_u32 s40, s46, 12288
buffer_load_dwordx4 v[72:75], v1, s[8:11], s40 offen offset:0 sc1
s_waitcnt lgkmcnt(9)
v_mfma_f32_16x16x32_bf16 v[176:179], v[140:143], v[52:55], v[176:179]
ds_read_b128 v[140:143], v248 offset:51200
s_waitcnt lgkmcnt(9)
v_mfma_f32_16x16x32_bf16 v[180:183], v[144:147], v[52:55], v[180:183]
ds_read_b128 v[144:147], v248 offset:52224
s_waitcnt lgkmcnt(9)
v_mfma_f32_16x16x32_bf16 v[184:187], v[148:151], v[52:55], v[184:187]
ds_read_b128 v[148:151], v248 offset:53248
s_waitcnt vmcnt(4)
v_cmp_eq_u32 vcc, -1, v56
s_waitcnt lgkmcnt(9)
v_mfma_f32_16x16x32_bf16 v[188:191], v[152:155], v[52:55], v[188:191]
ds_read_b128 v[152:155], v248 offset:54272
s_cbranch_vccnz RT_182
RB_183:
s_waitcnt lgkmcnt(9)
v_mfma_f32_16x16x32_bf16 v[172:175], v[116:119], v[56:59], v[172:175]
ds_read_b128 v[116:119], v248 offset:55296
s_add_u32 s40, s46, 12288
buffer_load_dwordx4 v[76:79], v1, s[8:11], s40 offen offset:1024 sc1
s_waitcnt lgkmcnt(9)
v_mfma_f32_16x16x32_bf16 v[176:179], v[120:123], v[56:59], v[176:179]
ds_read_b128 v[120:123], v248 offset:56320
s_waitcnt lgkmcnt(9)
v_mfma_f32_16x16x32_bf16 v[180:183], v[124:127], v[56:59], v[180:183]
ds_read_b128 v[124:127], v248 offset:57344
s_waitcnt lgkmcnt(9)
v_mfma_f32_16x16x32_bf16 v[184:187], v[128:131], v[56:59], v[184:187]
ds_read_b128 v[128:131], v1 offset:0
s_waitcnt vmcnt(4)
v_cmp_eq_u32 vcc, -1, v60
s_waitcnt lgkmcnt(9)
v_mfma_f32_16x16x32_bf16 v[188:191], v[132:135], v[56:59], v[188:191]
ds_read_b128 v[132:135], v1 offset:1024
s_cbranch_vccnz RT_185
RB_186:
s_waitcnt lgkmcnt(9)
v_mfma_f32_16x16x32_bf16 v[172:175], v[136:139], v[60:63], v[172:175]
ds_read_b128 v[136:139], v1 offset:2048
s_add_u32 s40, s46, 12288
buffer_load_dwordx4 v[80:83], v1, s[8:11], s40 offen offset:2048 sc1
s_waitcnt lgkmcnt(9)
v_mfma_f32_16x16x32_bf16 v[176:179], v[140:143], v[60:63], v[176:179]
ds_read_b128 v[140:143], v1 offset:3072
s_waitcnt lgkmcnt(9)
v_mfma_f32_16x16x32_bf16 v[180:183], v[144:147], v[60:63], v[180:183]
ds_read_b128 v[144:147], v1 offset:4096
s_waitcnt lgkmcnt(9)
v_mfma_f32_16x16x32_bf16 v[184:187], v[148:151], v[60:63], v[184:187]
ds_read_b128 v[148:151], v1 offset:5120
s_waitcnt vmcnt(4)
v_cmp_eq_u32 vcc, -1, v64
s_waitcnt lgkmcnt(9)
v_mfma_f32_16x16x32_bf16 v[188:191], v[152:155], v[60:63], v[188:191]
ds_read_b128 v[152:155], v1 offset:6144
s_cbranch_vccnz RT_188
RB_189:
s_waitcnt lgkmcnt(9)
v_mfma_f32_16x16x32_bf16 v[172:175], v[116:119], v[64:67], v[172:175]
ds_read_b128 v[116:119], v1 offset:7168
s_add_u32 s40, s46, 12288
buffer_load_dwordx4 v[84:87], v1, s[8:11], s40 offen offset:3072 sc1
s_waitcnt lgkmcnt(9)
v_mfma_f32_16x16x32_bf16 v[176:179], v[120:123], v[64:67], v[176:179]
ds_read_b128 v[120:123], v1 offset:8192
s_waitcnt lgkmcnt(9)
v_mfma_f32_16x16x32_bf16 v[180:183], v[124:127], v[64:67], v[180:183]
ds_read_b128 v[124:127], v1 offset:9216
s_waitcnt lgkmcnt(9)
v_mfma_f32_16x16x32_bf16 v[184:187], v[128:131], v[64:67], v[184:187]
ds_read_b128 v[128:131], v1 offset:10240
s_waitcnt vmcnt(4)
v_cmp_eq_u32 vcc, -1, v68
s_waitcnt lgkmcnt(9)
v_mfma_f32_16x16x32_bf16 v[188:191], v[132:135], v[64:67], v[188:191]
ds_read_b128 v[132:135], v1 offset:11264
s_add_u32 s40, s46, 16384
buffer_load_dwordx4 v[88:91], v1, s[8:11], s40 offen offset:2048 sc1
s_add_u32 s40, s46, 16384
buffer_load_dwordx4 v[92:95], v1, s[8:11], s40 offen offset:3072 sc1
s_cbranch_vccnz RT_191
RB_192:
s_waitcnt lgkmcnt(9)
v_mfma_f32_16x16x32_bf16 v[172:175], v[136:139], v[68:71], v[172:175]
ds_read_b128 v[136:139], v1 offset:12288
s_waitcnt lgkmcnt(9)
v_mfma_f32_16x16x32_bf16 v[176:179], v[140:143], v[68:71], v[176:179]
ds_read_b128 v[140:143], v1 offset:13312
s_waitcnt lgkmcnt(9)
v_mfma_f32_16x16x32_bf16 v[180:183], v[144:147], v[68:71], v[180:183]
ds_read_b128 v[144:147], v1 offset:14336
s_waitcnt lgkmcnt(9)
v_mfma_f32_16x16x32_bf16 v[184:187], v[148:151], v[68:71], v[184:187]
ds_read_b128 v[148:151], v1 offset:15360
s_waitcnt vmcnt(5)
v_cmp_eq_u32 vcc, -1, v72
s_waitcnt lgkmcnt(9)
v_mfma_f32_16x16x32_bf16 v[188:191], v[152:155], v[68:71], v[188:191]
ds_read_b128 v[152:155], v1 offset:16384
s_cmp_eq_u32 s24, 0
s_cbranch_scc0 BC_194
s_mov_b32 s43, 21282816
s_add_u32 s41, s43, s68
s_add_u32 s42, s43, s69
v_mov_b32 v220, -1
v_mov_b32 v221, -1
v_mov_b32 v222, -1
v_mov_b32 v223, -1
s_cmp_eq_u32 s23, 0
s_cbranch_scc0 HS_195
buffer_store_dwordx4 v[220:223], v1, s[8:11], s41 offen
s_mov_b64 exec, 0xffff
buffer_store_dwordx2 v[220:221], v202, s[8:11], s42 offen
s_mov_b64 exec, -1
HJ_196:
BC_194:
s_add_u32 m0, s25, 64512
s_add_u32 s40, s67, 0
buffer_load_dwordx4 v1, s[8:11], s40 offen lds
s_cbranch_vccnz RT_197
RB_198:
s_waitcnt lgkmcnt(9)
v_mfma_f32_16x16x32_bf16 v[172:175], v[116:119], v[72:75], v[172:175]
ds_read_b128 v[116:119], v1 offset:17408
s_waitcnt lgkmcnt(9)
v_mfma_f32_16x16x32_bf16 v[176:179], v[120:123], v[72:75], v[176:179]
ds_read_b128 v[120:123], v1 offset:18432
s_waitcnt lgkmcnt(9)
v_mfma_f32_16x16x32_bf16 v[180:183], v[124:127], v[72:75], v[180:183]
ds_read_b128 v[124:127], v1 offset:19456
s_waitcnt lgkmcnt(9)
v_mfma_f32_16x16x32_bf16 v[184:187], v[128:131], v[72:75], v[184:187]
ds_read_b128 v[128:131], v1 offset:20480
s_waitcnt vmcnt(5)
v_cmp_eq_u32 vcc, -1, v76
s_waitcnt lgkmcnt(9)
v_mfma_f32_16x16x32_bf16 v[188:191], v[132:135], v[72:75], v[188:191]
ds_read_b128 v[132:135], v1 offset:21504
s_add_u32 m0, s25, 72704
s_add_u32 s40, s67, 8192
buffer_load_dwordx4 v1, s[8:11], s40 offen lds
s_cbranch_vccnz RT_200
RB_201:
s_waitcnt lgkmcnt(9)
v_mfma_f32_16x16x32_bf16 v[172:175], v[136:139], v[76:79], v[172:175]
ds_read_b128 v[136:139], v1 offset:22528
s_waitcnt vmcnt(2)
v_max3_u32 v244, v88, v89, v90
v_max3_u32 v245, v91, v92, v93
s_waitcnt lgkmcnt(9)
v_mfma_f32_16x16x32_bf16 v[176:179], v[140:143], v[76:79], v[176:179]
ds_read_b128 v[140:143], v1 offset:23552
v_max3_u32 v244, v244, v94, v95
v_max_u32 v244, v244, v245
s_waitcnt lgkmcnt(9)
v_mfma_f32_16x16x32_bf16 v[180:183], v[144:147], v[76:79], v[180:183]
ds_read_b128 v[144:147], v1 offset:24576
v_cmp_eq_u32_e64 s[86:87], -1, v244
v_add_f32 v250, v88, v90
s_waitcnt lgkmcnt(9)
v_mfma_f32_16x16x32_bf16 v[184:187], v[148:151], v[76:79], v[184:187]
ds_read_b128 v[148:151], v1 offset:25600
v_add_f32 v251, v89, v91
v_add_f32 v244, v92, v94
s_waitcnt vmcnt(5)
v_cmp_eq_u32 vcc, -1, v80
s_waitcnt lgkmcnt(9)
v_mfma_f32_16x16x32_bf16 v[188:191], v[152:155], v[76:79], v[188:191]
ds_read_b128 v[152:155], v1 offset:26624
v_add_f32 v245, v93, v95
v_add_f32 v250, v250, v244
s_add_u32 m0, s25, 80896
s_add_u32 s40, s67, 16384
buffer_load_dwordx4 v1, s[8:11], s40 offen lds
s_cbranch_vccnz RT_203
RB_204:
s_waitcnt lgkmcnt(9)
v_mfma_f32_16x16x32_bf16 v[172:175], v[116:119], v[80:83], v[172:175]
ds_read_b128 v[116:119], v241 offset:512
v_add_f32 v251, v251, v245
v_mov_b32 v244, v250
s_waitcnt lgkmcnt(9)
v_mfma_f32_16x16x32_bf16 v[176:179], v[120:123], v[80:83], v[176:179]
ds_read_b128 v[120:123], v241 offset:576
v_mov_b32 v245, v251
v_permlane16_swap_b32 v250, v244
s_waitcnt lgkmcnt(9)
v_mfma_f32_16x16x32_bf16 v[180:183], v[124:127], v[80:83], v[180:183]
ds_read_b128 v[124:127], v241 offset:640
v_permlane16_swap_b32 v251, v245
v_add_f32 v250, v250, v244
s_waitcnt lgkmcnt(9)
v_mfma_f32_16x16x32_bf16 v[184:187], v[128:131], v[80:83], v[184:187]
ds_read_b128 v[128:131], v241 offset:704
v_add_f32 v251, v251, v245
v_mov_b32 v244, v250
s_waitcnt vmcnt(5)
v_cmp_eq_u32 vcc, -1, v84
s_waitcnt lgkmcnt(9)
v_mfma_f32_16x16x32_bf16 v[188:191], v[132:135], v[80:83], v[188:191]
ds_read_b128 v[132:135], v241 offset:768
v_mov_b32 v245, v251
v_permlane32_swap_b32 v250, v244
s_add_u32 m0, s25, 89088
s_add_u32 s40, s67, 24576
buffer_load_dwordx4 v1, s[8:11], s40 offen lds
s_cmp_lt_u32 s20, 4
s_cbranch_scc0 DS_206
s_add_u32 m0, s25, 97280
s_add_u32 s40, s67, 32768
buffer_load_dwordx4 v1, s[8:11], s40 offen lds
DS_206:
s_cbranch_vccnz RT_207
RB_208:
s_waitcnt lgkmcnt(9)
v_mfma_f32_16x16x32_bf16 v[172:175], v[136:139], v[84:87], v[172:175]
v_permlane32_swap_b32 v251, v245
v_add_f32 v250, v250, v244
s_waitcnt lgkmcnt(8)
v_mfma_f32_16x16x32_bf16 v[176:179], v[140:143], v[84:87], v[176:179]
v_add_f32 v251, v251, v245
v_mul_f32 v250, 0x3ae38e39, v250
s_waitcnt lgkmcnt(7)
v_mfma_f32_16x16x32_bf16 v[180:183], v[144:147], v[84:87], v[180:183]
v_mul_f32 v251, 0x3ae38e39, v251
v_fma_f32 v251, -v250, v250, v251
s_waitcnt lgkmcnt(6)
v_mfma_f32_16x16x32_bf16 v[184:187], v[148:151], v[84:87], v[184:187]
v_max_f32 v251, 0, v251
v_add_f32 v251, 0x3727c5ac, v251
s_waitcnt lgkmcnt(5)
v_mfma_f32_16x16x32_bf16 v[188:191], v[152:155], v[84:87], v[188:191]
v_rsq_f32 v251, v251
s_add_u32 m0, s25, 129024
s_add_u32 s40, s67, 36864
buffer_load_dwordx4 v1, s[8:11], s40 offen lds
s_add_u32 m0, s25, 137216
s_add_u32 s40, s67, 45056
buffer_load_dwordx4 v1, s[8:11], s40 offen lds
s_cmp_lg_u64 s[86:87], 0
s_cbranch_scc1 ST_210
SB_211:
s_cmp_lt_u32 s20, 2
s_cbranch_scc0 DS_215
s_add_u32 m0, s25, 145408
s_add_u32 s40, s67, 53248
buffer_load_dwordx4 v1, s[8:11], s40 offen lds
DS_215:
v_mul_f32 v252, 0x3fb8aa3b, v251
s_lshl_b32 s52, s20, 4
v_add_u32 v6, s52, v2
v_mul_u32_u24 v14, 168, v6
v_mul_u32_u24 v15, 104, v6
v_mul_u32_u24 v6, 40, v3
v_add3_u32 v14, v14, v6, 0
v_add_u32 v14, 101376, v14
v_mul_u32_u24 v6, 24, v3
v_add_u32 v15, v15, v6
s_waitcnt lgkmcnt(0)
v_pk_fma_f32 v[172:173], v[116:117], v[250:251], v[172:173] op_sel:[0,0,0] op_sel_hi:[1,0,1] neg_lo:[0,1,0] neg_hi:[0,1,0]
v_pk_fma_f32 v[174:175], v[118:119], v[250:251], v[174:175] op_sel:[0,0,0] op_sel_hi:[1,0,1] neg_lo:[0,1,0] neg_hi:[0,1,0]
v_pk_fma_f32 v[176:177], v[120:121], v[250:251], v[176:177] op_sel:[0,0,0] op_sel_hi:[1,0,1] neg_lo:[0,1,0] neg_hi:[0,1,0]
v_pk_fma_f32 v[178:179], v[122:123], v[250:251], v[178:179] op_sel:[0,0,0] op_sel_hi:[1,0,1] neg_lo:[0,1,0] neg_hi:[0,1,0]
v_pk_fma_f32 v[180:181], v[124:125], v[250:251], v[180:181] op_sel:[0,0,0] op_sel_hi:[1,0,1] neg_lo:[0,1,0] neg_hi:[0,1,0]
v_pk_fma_f32 v[182:183], v[126:127], v[250:251], v[182:183] op_sel:[0,0,0] op_sel_hi:[1,0,1] neg_lo:[0,1,0] neg_hi:[0,1,0]
v_pk_fma_f32 v[184:185], v[128:129], v[250:251], v[184:185] op_sel:[0,0,0] op_sel_hi:[1,0,1] neg_lo:[0,1,0] neg_hi:[0,1,0]
v_pk_fma_f32 v[186:187], v[130:131], v[250:251], v[186:187] op_sel:[0,0,0] op_sel_hi:[1,0,1] neg_lo:[0,1,0] neg_hi:[0,1,0]
v_pk_fma_f32 v[188:189], v[132:133], v[250:251], v[188:189] op_sel:[0,0,0] op_sel_hi:[1,0,1] neg_lo:[0,1,0] neg_hi:[0,1,0]
v_pk_fma_f32 v[190:191], v[134:135], v[250:251], v[190:191] op_sel:[0,0,0] op_sel_hi:[1,0,1] neg_lo:[0,1,0] neg_hi:[0,1,0]
v_max3_f32 v5, v172, v173, v174
v_min3_f32 v6, v172, v173, v174
v_max3_f32 v5, v5, v175, v176
v_min3_f32 v6, v6, v175, v176
v_max3_f32 v5, v5, v177, v178
v_min3_f32 v6, v6, v177, v178
v_max3_f32 v5, v5, v179, v180
v_min3_f32 v6, v6, v179, v180
v_mov_b32 v144, v5
v_mov_b32 v145, v6
s_nop 0
v_permlane16_swap_b32 v5, v144
v_permlane16_swap_b32 v6, v145
v_max_f32 v5, v5, v144
v_min_f32 v6, v6, v145
v_mul_f32 v5, v252, v5
v_mul_f32 v6, v252, v6
v_pk_fma_f32 v[144:145], v[172:173], v[252:253], v[4:5] op_sel:[0,0,1] op_sel_hi:[1,0,1] neg_lo:[0,0,1] neg_hi:[0,0,1]
v_pk_fma_f32 v[154:155], v[172:173], v[252:253], v[6:7] op_sel:[0,0,0] op_sel_hi:[1,0,0] neg_lo:[1,0,0] neg_hi:[1,0,0]
v_pk_fma_f32 v[146:147], v[174:175], v[252:253], v[4:5] op_sel:[0,0,1] op_sel_hi:[1,0,1] neg_lo:[0,0,1] neg_hi:[0,0,1]
v_pk_fma_f32 v[156:157], v[174:175], v[252:253], v[6:7] op_sel:[0,0,0] op_sel_hi:[1,0,0] neg_lo:[1,0,0] neg_hi:[1,0,0]
v_pk_fma_f32 v[148:149], v[176:177], v[252:253], v[4:5] op_sel:[0,0,1] op_sel_hi:[1,0,1] neg_lo:[0,0,1] neg_hi:[0,0,1]
v_pk_fma_f32 v[158:159], v[176:177], v[252:253], v[6:7] op_sel:[0,0,0] op_sel_hi:[1,0,0] neg_lo:[1,0,0] neg_hi:[1,0,0]
v_pk_fma_f32 v[150:151], v[178:179], v[252:253], v[4:5] op_sel:[0,0,1] op_sel_hi:[1,0,1] neg_lo:[0,0,1] neg_hi:[0,0,1]
v_pk_fma_f32 v[160:161], v[178:179], v[252:253], v[6:7] op_sel:[0,0,0] op_sel_hi:[1,0,0] neg_lo:[1,0,0] neg_hi:[1,0,0]
v_fma_f32 v152, v180, v252, -v5
v_fma_f32 v162, -v180, v252, v6
v_exp_f32 v144, v144
v_exp_f32 v145, v145
v_exp_f32 v146, v146
v_exp_f32 v147, v147
v_exp_f32 v148, v148
v_exp_f32 v149, v149
v_exp_f32 v150, v150
v_exp_f32 v151, v151
v_exp_f32 v152, v152
v_exp_f32 v154, v154
v_exp_f32 v155, v155
v_exp_f32 v156, v156
v_exp_f32 v157, v157
v_exp_f32 v158, v158
v_exp_f32 v159, v159
v_exp_f32 v160, v160
v_exp_f32 v161, v161
v_exp_f32 v162, v162
v_pk_add_f32 v[172:173], v[144:145], v[146:147]
v_pk_add_f32 v[174:175], v[154:155], v[156:157]
v_pk_add_f32 v[172:173], v[172:173], v[148:149]
v_pk_add_f32 v[174:175], v[174:175], v[158:159]
v_pk_add_f32 v[172:173], v[172:173], v[150:151]
v_pk_add_f32 v[174:175], v[174:175], v[160:161]
v_add_f32 v5, v172, v173
v_add_f32 v6, v174, v175
v_add_f32 v5, v5, v152
v_add_f32 v6, v6, v162
v_mov_b32 v176, v5
v_mov_b32 v177, v6
s_nop 0
v_permlane16_swap_b32 v5, v176
v_permlane16_swap_b32 v6, v177
v_add_f32 v5, v5, v176
v_add_f32 v6, v6, v177
v_rcp_f32 v5, v5
v_rcp_f32 v6, v6
v_pk_mul_f32 v[144:145], v[144:145], v[4:5] op_sel:[0,1] op_sel_hi:[1,1]
v_pk_mul_f32 v[154:155], v[154:155], v[6:7] op_sel:[0,0] op_sel_hi:[1,0]
v_pk_mul_f32 v[146:147], v[146:147], v[4:5] op_sel:[0,1] op_sel_hi:[1,1]
v_pk_mul_f32 v[156:157], v[156:157], v[6:7] op_sel:[0,0] op_sel_hi:[1,0]
v_pk_mul_f32 v[148:149], v[148:149], v[4:5] op_sel:[0,1] op_sel_hi:[1,1]
v_pk_mul_f32 v[158:159], v[158:159], v[6:7] op_sel:[0,0] op_sel_hi:[1,0]
v_pk_mul_f32 v[150:151], v[150:151], v[4:5] op_sel:[0,1] op_sel_hi:[1,1]
v_pk_mul_f32 v[160:161], v[160:161], v[6:7] op_sel:[0,0] op_sel_hi:[1,0]
v_mul_f32 v152, v5, v152
v_mul_f32 v162, v6, v162
v_cvt_pk_bf16_f32 v96, v144, v145
v_cvt_pk_bf16_f32 v97, v146, v147
v_cvt_pk_bf16_f32 v98, v148, v149
v_cvt_pk_bf16_f32 v99, v150, v151
v_cvt_pk_bf16_f32 v100, v152, 0
v_cvt_pk_bf16_f32 v101, v154, v155
v_cvt_pk_bf16_f32 v102, v156, v157
v_cvt_pk_bf16_f32 v103, v158, v159
v_cvt_pk_bf16_f32 v104, v160, v161
v_cvt_pk_bf16_f32 v105, v162, 0
v_mul_f32 v181, v251, v181
v_mul_f32 v182, v251, v182
v_mul_f32 v183, v251, v183
v_mul_f32 v184, v251, v184
v_mul_f32 v185, v251, v185
v_mul_f32 v186, v251, v186
v_mul_f32 v187, v251, v187
v_mul_f32 v188, v251, v188
v_mul_f32 v189, v251, v189
v_cvt_pk_bf16_f32 v106, v181, v182
v_cvt_pk_bf16_f32 v107, v183, v184
v_cvt_pk_bf16_f32 v108, v185, v186
v_cvt_pk_bf16_f32 v109, v187, v188
v_cvt_pk_bf16_f32 v110, v189, 1.0
v_mov_b32 v111, 0
s_barrier
ds_write_b64 v14, v[96:97] offset:0
ds_write_b64 v14, v[98:99] offset:8
ds_write_b64 v14, v[100:101] offset:16
ds_write_b64 v14, v[102:103] offset:24
ds_write_b64 v14, v[104:105] offset:32
ds_write_b64 v15, v[106:107] offset:0
ds_write_b64 v15, v[108:109] offset:8
ds_write_b64 v15, v[110:111] offset:16
s_add_u32 m0, s25, 18432
s_add_u32 s40, s67, 55296
buffer_load_dwordx4 v1, s[8:11], s40 offen lds
s_cmp_lt_u32 s20, 1
s_cbranch_scc0 DS_216
s_add_u32 m0, s25, 26624
s_add_u32 s40, s67, 63488
buffer_load_dwordx4 v1, s[8:11], s40 offen lds
DS_216:
s_mul_i32 s54, s24, 1048576
s_mul_i32 s55, s22, 65536
s_add_u32 s54, s54, s55
s_add_u32 s94, s54, 26001408
s_cmp_ge_u32 s20, 3
s_cselect_b32 s52, 1, 0
s_mul_i32 s53, s52, 3
s_sub_u32 s53, s20, s53
v_bfe_u32 v112, v4, 2, 2
v_lshlrev_b32 v112, 2, v112
v_lshrrev_b32 v113, 1, v3
v_add_u32 v112, v112, v113
v_and_b32 v113, 1, v3
v_lshl_add_u32 v112, v113, 4, v112
v_and_b32 v113, 3, v4
v_lshlrev_b32 v113, 3, v113
v_mul_u32_u24 v114, 168, v112
v_add_u32 v114, v114, v113
v_mul_u32_u24 v115, 104, v112
v_add_u32 v115, v115, v113
s_mul_i32 s54, s52, 80
s_lshl_b32 s55, s53, 5
s_add_u32 s54, s54, s55
s_add_u32 s54, s54, 101376
v_add_u32 v114, s54, v114
s_mul_i32 s54, s52, 48
s_add_u32 s54, s54, 0
v_add_u32 v115, s54, v115
s_waitcnt lgkmcnt(0)
s_barrier
s_cmp_lt_u32 s20, 6
s_cbranch_scc0 KV_217
ds_read_b64_tr_b16 v[116:117], v114 offset:0
ds_read_b64_tr_b16 v[132:133], v115 offset:0
ds_read_b64_tr_b16 v[148:149], v115 offset:32
ds_read_b64_tr_b16 v[118:119], v114 offset:336
ds_read_b64_tr_b16 v[134:135], v115 offset:208
ds_read_b64_tr_b16 v[150:151], v115 offset:240
ds_read_b64_tr_b16 v[120:121], v114 offset:5376
ds_read_b64_tr_b16 v[136:137], v115 offset:3328
ds_read_b64_tr_b16 v[152:153], v115 offset:3360
ds_read_b64_tr_b16 v[122:123], v114 offset:5712
ds_read_b64_tr_b16 v[138:139], v115 offset:3536
ds_read_b64_tr_b16 v[154:155], v115 offset:3568
ds_read_b64_tr_b16 v[124:125], v114 offset:10752
ds_read_b64_tr_b16 v[140:141], v115 offset:6656
ds_read_b64_tr_b16 v[156:157], v115 offset:6688
ds_read_b64_tr_b16 v[126:127], v114 offset:11088
ds_read_b64_tr_b16 v[142:143], v115 offset:6864
ds_read_b64_tr_b16 v[158:159], v115 offset:6896
ds_read_b64_tr_b16 v[128:129], v114 offset:16128
ds_read_b64_tr_b16 v[144:145], v115 offset:9984
ds_read_b64_tr_b16 v[160:161], v115 offset:10016
ds_read_b64_tr_b16 v[130:131], v114 offset:16464
ds_read_b64_tr_b16 v[146:147], v115 offset:10192
ds_read_b64_tr_b16 v[162:163], v115 offset:10224
v_mov_b32 v164, 0
v_mov_b32 v165, 0
v_mov_b32 v166, 0
v_mov_b32 v167, 0
v_mov_b32 v168, 0
v_mov_b32 v169, 0
v_mov_b32 v170, 0
v_mov_b32 v171, 0
s_mul_i32 s54, s52, 10
s_lshl_b32 s55, s53, 2
s_add_u32 s54, s54, s55
v_add_u32 v96, s54, v3
v_mul_u32_u24 v96, 160, v96
v_add_u32 v97, s55, v3
v_lshlrev_b32 v98, 3, v4
v_add_u32 v98, 3200, v98
v_lshl_add_u32 v99, v2, 3, v96
v_subrev_u32 v100, 16, v99
v_add_u32 v101, 112, v99
v_cmp_le_u32 vcc, 12, v2
s_nop 1
v_cndmask_b32 v99, v99, v100, vcc
v_cmp_eq_u32 vcc, 10, v2
s_nop 1
v_cndmask_b32 v99, v99, v98, vcc
v_cmp_eq_u32 vcc, 11, v2
s_nop 1
v_cndmask_b32 v99, v99, v98, vcc
v_cmp_le_u32 vcc, 6, v2
s_nop 1
v_cndmask_b32 v101, v101, v98, vcc
v_cmp_le_u32 vcc, 10, v97
s_nop 1
v_cndmask_b32 v99, v99, v98, vcc
v_cndmask_b32 v101, v101, v98, vcc
s_mul_i32 s55, s21, 4096
s_add_u32 s55, s55, s94
s_waitcnt lgkmcnt(15)
v_mfma_f32_16x16x32_bf16 v[164:167], v[116:119], v[132:135], v[164:167]
v_mfma_f32_16x16x32_bf16 v[168:171], v[116:119], v[148:151], v[168:171]
s_waitcnt lgkmcnt(12)
v_mfma_f32_16x16x32_bf16 v[164:167], v[120:123], v[136:139], v[164:167]
v_mfma_f32_16x16x32_bf16 v[168:171], v[120:123], v[152:155], v[168:171]
s_waitcnt lgkmcnt(6)
v_mfma_f32_16x16x32_bf16 v[164:167], v[124:127], v[140:143], v[164:167]
v_mfma_f32_16x16x32_bf16 v[168:171], v[124:127], v[156:159], v[168:171]
s_waitcnt lgkmcnt(0)
v_mfma_f32_16x16x32_bf16 v[164:167], v[128:131], v[144:147], v[164:167]
v_mfma_f32_16x16x32_bf16 v[168:171], v[128:131], v[160:163], v[168:171]
s_nop 6
v_cvt_pk_bf16_f32 v102, v164, v165
v_cvt_pk_bf16_f32 v103, v166, v167
v_cvt_pk_bf16_f32 v104, v168, v169
v_cvt_pk_bf16_f32 v105, v170, v171
buffer_store_dwordx2 v[102:103], v99, s[8:11], s55 offen sc1
buffer_store_dwordx2 v[104:105], v101, s[8:11], s55 offen sc1
KV_217:
s_barrier
s_add_u32 m0, s25, 110592
s_add_u32 s40, s67, 64512
buffer_load_dwordx4 v1, s[8:11], s40 offen lds
s_add_u32 m0, s25, 118784
s_add_u32 s40, s67, 72704
buffer_load_dwordx4 v1, s[8:11], s40 offen lds
s_cmp_lt_u32 s20, 2
s_cbranch_scc0 DS_218
s_add_u32 m0, s25, 126976
s_add_u32 s40, s67, 80896
buffer_load_dwordx4 v1, s[8:11], s40 offen lds
DS_218:
ds_read_b128 v[116:119], v1 offset:27648
ds_read_b128 v[120:123], v1 offset:28672
ds_read_b128 v[124:127], v1 offset:29696
ds_read_b128 v[128:131], v1 offset:30720
ds_read_b128 v[132:135], v1 offset:31744
ds_read_b128 v[136:139], v1 offset:32768
ds_read_b128 v[140:143], v1 offset:33792
ds_read_b128 v[144:147], v1 offset:34816
v_mov_b32 v192, 0
v_mov_b32 v193, 0
v_mov_b32 v194, 0
v_mov_b32 v195, 0
v_mov_b32 v196, 0
v_mov_b32 v197, 0
v_mov_b32 v198, 0
v_mov_b32 v199, 0
s_waitcnt lgkmcnt(7)
v_mfma_f32_16x16x32_bf16 v[192:195], v[116:119], v[16:19], v[192:195]
ds_read_b128 v[116:119], v1 offset:35840
s_waitcnt lgkmcnt(7)
v_mfma_f32_16x16x32_bf16 v[196:199], v[120:123], v[16:19], v[196:199]
ds_read_b128 v[120:123], v1 offset:36864
s_waitcnt lgkmcnt(7)
v_mfma_f32_16x16x32_bf16 v[192:195], v[124:127], v[20:23], v[192:195]
ds_read_b128 v[124:127], v1 offset:37888
s_waitcnt lgkmcnt(7)
v_mfma_f32_16x16x32_bf16 v[196:199], v[128:131], v[20:23], v[196:199]
ds_read_b128 v[128:131], v1 offset:38912
s_waitcnt lgkmcnt(7)
v_mfma_f32_16x16x32_bf16 v[192:195], v[132:135], v[24:27], v[192:195]
ds_read_b128 v[132:135], v1 offset:39936
s_waitcnt lgkmcnt(7)
v_mfma_f32_16x16x32_bf16 v[196:199], v[136:139], v[24:27], v[196:199]
ds_read_b128 v[136:139], v1 offset:40960
s_waitcnt lgkmcnt(7)
v_mfma_f32_16x16x32_bf16 v[192:195], v[140:143], v[28:31], v[192:195]
ds_read_b128 v[140:143], v1 offset:41984
s_waitcnt lgkmcnt(7)
v_mfma_f32_16x16x32_bf16 v[196:199], v[144:147], v[28:31], v[196:199]
ds_read_b128 v[144:147], v1 offset:43008
s_waitcnt lgkmcnt(7)
v_mfma_f32_16x16x32_bf16 v[192:195], v[116:119], v[32:35], v[192:195]
ds_read_b128 v[116:119], v1 offset:44032
s_waitcnt lgkmcnt(7)
v_mfma_f32_16x16x32_bf16 v[196:199], v[120:123], v[32:35], v[196:199]
ds_read_b128 v[120:123], v1 offset:45056
s_waitcnt lgkmcnt(7)
v_mfma_f32_16x16x32_bf16 v[192:195], v[124:127], v[36:39], v[192:195]
ds_read_b128 v[124:127], v1 offset:46080
s_waitcnt lgkmcnt(7)
v_mfma_f32_16x16x32_bf16 v[196:199], v[128:131], v[36:39], v[196:199]
ds_read_b128 v[128:131], v1 offset:47104
s_waitcnt lgkmcnt(7)
v_mfma_f32_16x16x32_bf16 v[192:195], v[132:135], v[40:43], v[192:195]
ds_read_b128 v[132:135], v1 offset:48128
s_waitcnt lgkmcnt(7)
v_mfma_f32_16x16x32_bf16 v[196:199], v[136:139], v[40:43], v[196:199]
ds_read_b128 v[136:139], v1 offset:49152
s_waitcnt lgkmcnt(7)
v_mfma_f32_16x16x32_bf16 v[192:195], v[140:143], v[44:47], v[192:195]
ds_read_b128 v[140:143], v1 offset:50176
s_waitcnt lgkmcnt(7)
v_mfma_f32_16x16x32_bf16 v[196:199], v[144:147], v[44:47], v[196:199]
ds_read_b128 v[144:147], v1 offset:51200
s_waitcnt lgkmcnt(7)
v_mfma_f32_16x16x32_bf16 v[192:195], v[116:119], v[48:51], v[192:195]
ds_read_b128 v[116:119], v1 offset:52224
s_waitcnt lgkmcnt(7)
v_mfma_f32_16x16x32_bf16 v[196:199], v[120:123], v[48:51], v[196:199]
ds_read_b128 v[120:123], v1 offset:53248
s_waitcnt lgkmcnt(7)
v_mfma_f32_16x16x32_bf16 v[192:195], v[124:127], v[52:55], v[192:195]
ds_read_b128 v[124:127], v1 offset:54272
s_waitcnt lgkmcnt(7)
v_mfma_f32_16x16x32_bf16 v[196:199], v[128:131], v[52:55], v[196:199]
ds_read_b128 v[128:131], v1 offset:55296
s_waitcnt lgkmcnt(7)
v_mfma_f32_16x16x32_bf16 v[192:195], v[132:135], v[56:59], v[192:195]
ds_read_b128 v[132:135], v1 offset:56320
s_waitcnt lgkmcnt(7)
v_mfma_f32_16x16x32_bf16 v[196:199], v[136:139], v[56:59], v[196:199]
ds_read_b128 v[136:139], v1 offset:57344
s_waitcnt lgkmcnt(7)
v_mfma_f32_16x16x32_bf16 v[192:195], v[140:143], v[60:63], v[192:195]
ds_read_b128 v[140:143], v1 offset:58368
s_waitcnt lgkmcnt(7)
v_mfma_f32_16x16x32_bf16 v[196:199], v[144:147], v[60:63], v[196:199]
ds_read_b128 v[144:147], v1 offset:59392
s_waitcnt lgkmcnt(7)
v_mfma_f32_16x16x32_bf16 v[192:195], v[116:119], v[64:67], v[192:195]
ds_read_b128 v[116:119], v1 offset:60416
s_waitcnt lgkmcnt(7)
v_mfma_f32_16x16x32_bf16 v[196:199], v[120:123], v[64:67], v[196:199]
ds_read_b128 v[120:123], v1 offset:61440
s_waitcnt lgkmcnt(7)
v_mfma_f32_16x16x32_bf16 v[192:195], v[124:127], v[68:71], v[192:195]
ds_read_b128 v[124:127], v1 offset:62464
s_waitcnt lgkmcnt(7)
v_mfma_f32_16x16x32_bf16 v[196:199], v[128:131], v[68:71], v[196:199]
ds_read_b128 v[128:131], v1 offset:63488
s_waitcnt lgkmcnt(7)
v_mfma_f32_16x16x32_bf16 v[192:195], v[132:135], v[72:75], v[192:195]
ds_read_b128 v[132:135], v241 offset:832
s_waitcnt lgkmcnt(7)
v_mfma_f32_16x16x32_bf16 v[196:199], v[136:139], v[72:75], v[196:199]
ds_read_b128 v[136:139], v241 offset:896
s_waitcnt lgkmcnt(7)
v_mfma_f32_16x16x32_bf16 v[192:195], v[140:143], v[76:79], v[192:195]
s_waitcnt lgkmcnt(6)
v_mfma_f32_16x16x32_bf16 v[196:199], v[144:147], v[76:79], v[196:199]
s_waitcnt lgkmcnt(5)
v_mfma_f32_16x16x32_bf16 v[192:195], v[116:119], v[80:83], v[192:195]
s_waitcnt lgkmcnt(4)
v_mfma_f32_16x16x32_bf16 v[196:199], v[120:123], v[80:83], v[196:199]
s_waitcnt lgkmcnt(3)
v_mfma_f32_16x16x32_bf16 v[192:195], v[124:127], v[84:87], v[192:195]
s_waitcnt lgkmcnt(2)
v_mfma_f32_16x16x32_bf16 v[196:199], v[128:131], v[84:87], v[196:199]
s_add_u32 s97, s97, 1
v_mov_b32 v5, s97
ds_write_b32 v203, v5
s_cmp_lt_u32 s20, 7
s_cbranch_scc0 KE_219
s_add_u32 s40, s94, 0
buffer_load_dwordx2 v[72:73], v254, s[8:11], s40 offen sc1
s_add_u32 s40, s94, 4096
buffer_load_dwordx2 v[74:75], v254, s[8:11], s40 offen sc1
s_add_u32 s40, s94, 8192
buffer_load_dwordx2 v[76:77], v254, s[8:11], s40 offen sc1
s_add_u32 s40, s94, 12288
buffer_load_dwordx2 v[78:79], v254, s[8:11], s40 offen sc1
s_add_u32 s40, s94, 16384
buffer_load_dwordx2 v[80:81], v254, s[8:11], s40 offen sc1
s_add_u32 s40, s94, 20480
buffer_load_dwordx2 v[82:83], v254, s[8:11], s40 offen sc1
s_add_u32 s40, s94, 24576
buffer_load_dwordx2 v[84:85], v254, s[8:11], s40 offen sc1
s_add_u32 s40, s94, 28672
buffer_load_dwordx2 v[86:87], v254, s[8:11], s40 offen sc1
s_add_u32 s40, s94, 32768
buffer_load_dwordx2 v[88:89], v254, s[8:11], s40 offen sc1
s_add_u32 s40, s94, 36864
buffer_load_dwordx2 v[90:91], v254, s[8:11], s40 offen sc1
s_add_u32 s40, s94, 40960
buffer_load_dwordx2 v[92:93], v254, s[8:11], s40 offen sc1
s_add_u32 s40, s94, 45056
buffer_load_dwordx2 v[94:95], v254, s[8:11], s40 offen sc1
s_add_u32 s40, s94, 49152
buffer_load_dwordx2 v[96:97], v254, s[8:11], s40 offen sc1
s_add_u32 s40, s94, 53248
buffer_load_dwordx2 v[98:99], v254, s[8:11], s40 offen sc1
s_add_u32 s40, s94, 57344
buffer_load_dwordx2 v[100:101], v254, s[8:11], s40 offen sc1
s_add_u32 s40, s94, 61440
buffer_load_dwordx2 v[102:103], v254, s[8:11], s40 offen sc1
KE_219:
s_cmp_eq_u32 s24, 0
s_cbranch_scc0 GD_220
s_cmp_ge_u32 s20, 7
s_cbranch_scc0 BW_221
s_sub_u32 m0, s25, 7168
s_add_u32 s40, s64, 84992
buffer_load_dwordx4 v1, s[8:11], s40 offen lds
s_sub_u32 m0, s25, 6144
s_add_u32 s40, s64, 86016
buffer_load_dwordx4 v1, s[8:11], s40 offen lds
s_sub_u32 m0, s25, 5120
s_add_u32 s40, s64, 87040
buffer_load_dwordx4 v1, s[8:11], s40 offen lds
s_sub_u32 m0, s25, 4096
s_add_u32 s40, s64, 88064
buffer_load_dwordx4 v1, s[8:11], s40 offen lds
s_sub_u32 m0, s25, 3072
s_add_u32 s40, s64, 89088
buffer_load_dwordx4 v1, s[8:11], s40 offen lds
s_sub_u32 m0, s25, 2048
s_add_u32 s40, s64, 90112
buffer_load_dwordx4 v1, s[8:11], s40 offen lds
s_sub_u32 m0, s25, 1024
s_add_u32 s40, s64, 91136
buffer_load_dwordx4 v1, s[8:11], s40 offen lds
s_add_u32 m0, s25, 0
s_add_u32 s40, s64, 92160
buffer_load_dwordx4 v1, s[8:11], s40 offen lds
s_add_u32 m0, s25, 1024
s_add_u32 s40, s64, 93184
buffer_load_dwordx4 v1, s[8:11], s40 offen lds
s_add_u32 m0, s25, 2048
s_add_u32 s40, s64, 94208
buffer_load_dwordx4 v1, s[8:11], s40 offen lds
s_add_u32 m0, s25, 3072
s_add_u32 s40, s64, 95232
buffer_load_dwordx4 v1, s[8:11], s40 offen lds
s_add_u32 m0, s25, 4096
s_add_u32 s40, s64, 96256
buffer_load_dwordx4 v1, s[8:11], s40 offen lds
s_add_u32 m0, s25, 5120
s_add_u32 s40, s64, 97280
buffer_load_dwordx4 v1, s[8:11], s40 offen lds
s_add_u32 m0, s25, 6144
s_add_u32 s40, s64, 98304
buffer_load_dwordx4 v1, s[8:11], s40 offen lds
s_add_u32 m0, s25, 7168
s_add_u32 s40, s64, 99328
buffer_load_dwordx4 v1, s[8:11], s40 offen lds
s_add_u32 m0, s25, 8192
s_add_u32 s40, s64, 100352
buffer_load_dwordx4 v1, s[8:11], s40 offen lds
s_add_u32 m0, s25, 9216
s_add_u32 s40, s64, 101376
buffer_load_dwordx4 v1, s[8:11], s40 offen lds
s_add_u32 m0, s25, 10240
s_add_u32 s40, s64, 102400
buffer_load_dwordx4 v1, s[8:11], s40 offen lds
s_add_u32 m0, s25, 94208
s_add_u32 s40, s64, 57344
buffer_load_dwordx4 v1, s[8:11], s40 offen lds
s_add_u32 m0, s25, 95232
s_add_u32 s40, s64, 58368
buffer_load_dwordx4 v1, s[8:11], s40 offen lds
s_add_u32 m0, s25, 96256
s_add_u32 s40, s64, 59392
buffer_load_dwordx4 v1, s[8:11], s40 offen lds
s_add_u32 m0, s25, 97280
s_add_u32 s40, s64, 60416
buffer_load_dwordx4 v1, s[8:11], s40 offen lds
s_add_u32 m0, s25, 98304
s_add_u32 s40, s64, 61440
buffer_load_dwordx4 v1, s[8:11], s40 offen lds
s_add_u32 m0, s25, 99328
s_add_u32 s40, s64, 62464
buffer_load_dwordx4 v1, s[8:11], s40 offen lds
s_add_u32 m0, s25, 100352
s_add_u32 s40, s64, 63488
buffer_load_dwordx4 v1, s[8:11], s40 offen lds
s_add_u32 m0, s25, 101376
s_add_u32 s40, s64, 64512
buffer_load_dwordx4 v1, s[8:11], s40 offen lds
s_add_u32 m0, s25, 102400
s_add_u32 s40, s64, 65536
buffer_load_dwordx4 v1, s[8:11], s40 offen lds
BW_221:
GD_220:
s_waitcnt lgkmcnt(0)
v_pk_fma_f32 v[192:193], v[132:133], v[250:251], v[192:193] op_sel:[0,0,0] op_sel_hi:[1,0,1] neg_lo:[0,1,0] neg_hi:[0,1,0]
v_pk_fma_f32 v[194:195], v[134:135], v[250:251], v[194:195] op_sel:[0,0,0] op_sel_hi:[1,0,1] neg_lo:[0,1,0] neg_hi:[0,1,0]
v_pk_fma_f32 v[196:197], v[136:137], v[250:251], v[196:197] op_sel:[0,0,0] op_sel_hi:[1,0,1] neg_lo:[0,1,0] neg_hi:[0,1,0]
v_fma_f32 v198, -v250, v138, v198
v_max3_f32 v5, v190, v191, v192
v_min3_f32 v6, v190, v191, v192
v_max3_f32 v5, v5, v193, v194
v_min3_f32 v6, v6, v193, v194
v_max3_f32 v5, v5, v195, v196
v_min3_f32 v6, v6, v195, v196
v_max3_f32 v5, v5, v197, v198
v_min3_f32 v6, v6, v197, v198
v_mov_b32 v144, v5
v_mov_b32 v145, v6
s_nop 0
v_permlane16_swap_b32 v5, v144
v_permlane16_swap_b32 v6, v145
v_max_f32 v5, v5, v144
v_min_f32 v6, v6, v145
v_mul_f32 v5, v252, v5
v_mul_f32 v6, v252, v6
v_pk_fma_f32 v[144:145], v[190:191], v[252:253], v[4:5] op_sel:[0,0,1] op_sel_hi:[1,0,1] neg_lo:[0,0,1] neg_hi:[0,0,1]
v_pk_fma_f32 v[154:155], v[190:191], v[252:253], v[6:7] op_sel:[0,0,0] op_sel_hi:[1,0,0] neg_lo:[1,0,0] neg_hi:[1,0,0]
v_pk_fma_f32 v[146:147], v[192:193], v[252:253], v[4:5] op_sel:[0,0,1] op_sel_hi:[1,0,1] neg_lo:[0,0,1] neg_hi:[0,0,1]
v_pk_fma_f32 v[156:157], v[192:193], v[252:253], v[6:7] op_sel:[0,0,0] op_sel_hi:[1,0,0] neg_lo:[1,0,0] neg_hi:[1,0,0]
v_pk_fma_f32 v[148:149], v[194:195], v[252:253], v[4:5] op_sel:[0,0,1] op_sel_hi:[1,0,1] neg_lo:[0,0,1] neg_hi:[0,0,1]
v_pk_fma_f32 v[158:159], v[194:195], v[252:253], v[6:7] op_sel:[0,0,0] op_sel_hi:[1,0,0] neg_lo:[1,0,0] neg_hi:[1,0,0]
v_pk_fma_f32 v[150:151], v[196:197], v[252:253], v[4:5] op_sel:[0,0,1] op_sel_hi:[1,0,1] neg_lo:[0,0,1] neg_hi:[0,0,1]
v_pk_fma_f32 v[160:161], v[196:197], v[252:253], v[6:7] op_sel:[0,0,0] op_sel_hi:[1,0,0] neg_lo:[1,0,0] neg_hi:[1,0,0]
v_fma_f32 v152, v198, v252, -v5
v_fma_f32 v162, -v198, v252, v6
v_exp_f32 v144, v144
v_exp_f32 v145, v145
v_exp_f32 v146, v146
v_exp_f32 v147, v147
v_exp_f32 v148, v148
v_exp_f32 v149, v149
v_exp_f32 v150, v150
v_exp_f32 v151, v151
v_exp_f32 v152, v152
v_exp_f32 v154, v154
v_exp_f32 v155, v155
v_exp_f32 v156, v156
v_exp_f32 v157, v157
v_exp_f32 v158, v158
v_exp_f32 v159, v159
v_exp_f32 v160, v160
v_exp_f32 v161, v161
v_exp_f32 v162, v162
v_pk_add_f32 v[190:191], v[144:145], v[146:147]
v_pk_add_f32 v[192:193], v[154:155], v[156:157]
v_pk_add_f32 v[190:191], v[190:191], v[148:149]
v_pk_add_f32 v[192:193], v[192:193], v[158:159]
v_pk_add_f32 v[190:191], v[190:191], v[150:151]
v_pk_add_f32 v[192:193], v[192:193], v[160:161]
v_add_f32 v5, v190, v191
v_add_f32 v6, v192, v193
v_add_f32 v5, v5, v152
v_add_f32 v6, v6, v162
v_mov_b32 v194, v5
v_mov_b32 v195, v6
s_nop 0
v_permlane16_swap_b32 v5, v194
v_permlane16_swap_b32 v6, v195
v_add_f32 v5, v5, v194
v_add_f32 v6, v6, v195
v_rcp_f32 v5, v5
v_rcp_f32 v6, v6
v_pk_mul_f32 v[144:145], v[144:145], v[4:5] op_sel:[0,1] op_sel_hi:[1,1]
v_pk_mul_f32 v[154:155], v[154:155], v[6:7] op_sel:[0,0] op_sel_hi:[1,0]
v_pk_mul_f32 v[146:147], v[146:147], v[4:5] op_sel:[0,1] op_sel_hi:[1,1]
v_pk_mul_f32 v[156:157], v[156:157], v[6:7] op_sel:[0,0] op_sel_hi:[1,0]
v_pk_mul_f32 v[148:149], v[148:149], v[4:5] op_sel:[0,1] op_sel_hi:[1,1]
v_pk_mul_f32 v[158:159], v[158:159], v[6:7] op_sel:[0,0] op_sel_hi:[1,0]
v_pk_mul_f32 v[150:151], v[150:151], v[4:5] op_sel:[0,1] op_sel_hi:[1,1]
v_pk_mul_f32 v[160:161], v[160:161], v[6:7] op_sel:[0,0] op_sel_hi:[1,0]
v_mul_f32 v152, v5, v152
v_mul_f32 v162, v6, v162
v_cvt_pk_bf16_f32 v16, v144, v145
v_cvt_pk_bf16_f32 v17, v146, v147
v_cvt_pk_bf16_f32 v18, v148, v149
v_cvt_pk_bf16_f32 v19, v150, v151
v_cvt_pk_bf16_f32 v20, v152, 0
v_cvt_pk_bf16_f32 v21, v154, v155
v_cvt_pk_bf16_f32 v22, v156, v157
v_cvt_pk_bf16_f32 v23, v158, v159
v_cvt_pk_bf16_f32 v24, v160, v161
v_cvt_pk_bf16_f32 v25, v162, 0
v_mov_b32 v26, 0
v_mov_b32 v27, 0
s_cmp_eq_u32 s24, 0
s_cbranch_scc0 K7_222
s_cmp_ge_u32 s20, 7
s_cbranch_scc0 K7_222
s_mov_b32 s39, 20000
FW_223:
ds_read_b32 v5, v240
s_waitcnt lgkmcnt(0)
v_cmp_gt_u32 vcc, s97, v5
s_sub_u32 s39, s39, 1
s_cbranch_scc1 FX_224
s_cbranch_vccnz FW_223
FX_224:
s_add_u32 m0, s25, 20480
s_add_u32 s40, s64, 112640
buffer_load_dwordx4 v1, s[8:11], s40 offen lds
s_add_u32 m0, s25, 21504
s_add_u32 s40, s64, 113664
buffer_load_dwordx4 v1, s[8:11], s40 offen lds
s_add_u32 m0, s25, 22528
s_add_u32 s40, s64, 114688
buffer_load_dwordx4 v1, s[8:11], s40 offen lds
s_add_u32 m0, s25, 23552
s_add_u32 s40, s64, 115712
buffer_load_dwordx4 v1, s[8:11], s40 offen lds
s_add_u32 m0, s25, 24576
s_add_u32 s40, s64, 116736
buffer_load_dwordx4 v1, s[8:11], s40 offen lds
s_add_u32 m0, s25, 25600
s_add_u32 s40, s64, 117760
buffer_load_dwordx4 v1, s[8:11], s40 offen lds
s_add_u32 m0, s25, 26624
s_add_u32 s40, s64, 118784
buffer_load_dwordx4 v1, s[8:11], s40 offen lds
s_add_u32 m0, s25, 27648
s_add_u32 s40, s64, 119808
buffer_load_dwordx4 v1, s[8:11], s40 offen lds
s_add_u32 m0, s25, 28672
s_add_u32 s40, s64, 120832
buffer_load_dwordx4 v1, s[8:11], s40 offen lds
s_add_u32 m0, s25, 29696
s_sub_u32 s40, s64, 7168
buffer_load_dwordx4 v1, s[8:11], s40 offen lds
s_add_u32 m0, s25, 30720
s_sub_u32 s40, s64, 6144
buffer_load_dwordx4 v1, s[8:11], s40 offen lds
s_add_u32 m0, s25, 31744
s_sub_u32 s40, s64, 5120
buffer_load_dwordx4 v1, s[8:11], s40 offen lds
s_add_u32 m0, s25, 32768
s_sub_u32 s40, s64, 4096
buffer_load_dwordx4 v1, s[8:11], s40 offen lds
s_add_u32 m0, s25, 33792
s_sub_u32 s40, s64, 3072
buffer_load_dwordx4 v1, s[8:11], s40 offen lds
s_add_u32 m0, s25, 34816
s_sub_u32 s40, s64, 2048
buffer_load_dwordx4 v1, s[8:11], s40 offen lds
s_add_u32 m0, s25, 35840
s_sub_u32 s40, s64, 1024
buffer_load_dwordx4 v1, s[8:11], s40 offen lds
s_add_u32 m0, s25, 36864
s_add_u32 s40, s64, 0
buffer_load_dwordx4 v1, s[8:11], s40 offen lds
s_add_u32 m0, s25, 37888
s_add_u32 s40, s64, 1024
buffer_load_dwordx4 v1, s[8:11], s40 offen lds
s_add_u32 m0, s25, 38912
s_add_u32 s40, s64, 2048
buffer_load_dwordx4 v1, s[8:11], s40 offen lds
s_add_u32 m0, s25, 39936
s_add_u32 s40, s64, 3072
buffer_load_dwordx4 v1, s[8:11], s40 offen lds
s_add_u32 m0, s25, 40960
s_add_u32 s40, s64, 4096
buffer_load_dwordx4 v1, s[8:11], s40 offen lds
s_add_u32 m0, s25, 41984
s_add_u32 s40, s64, 5120
buffer_load_dwordx4 v1, s[8:11], s40 offen lds
s_add_u32 m0, s25, 43008
s_add_u32 s40, s64, 6144
buffer_load_dwordx4 v1, s[8:11], s40 offen lds
s_add_u32 m0, s25, 44032
s_add_u32 s40, s64, 7168
buffer_load_dwordx4 v1, s[8:11], s40 offen lds
s_add_u32 m0, s25, 45056
s_add_u32 s40, s64, 8192
buffer_load_dwordx4 v1, s[8:11], s40 offen lds
s_add_u32 m0, s25, 46080
s_add_u32 s40, s64, 9216
buffer_load_dwordx4 v1, s[8:11], s40 offen lds
s_add_u32 m0, s25, 47104
s_add_u32 s40, s64, 10240
buffer_load_dwordx4 v1, s[8:11], s40 offen lds
s_add_u32 m0, s25, 48128
s_add_u32 s40, s64, 11264
buffer_load_dwordx4 v1, s[8:11], s40 offen lds
s_add_u32 m0, s25, 49152
s_add_u32 s40, s64, 12288
buffer_load_dwordx4 v1, s[8:11], s40 offen lds
s_add_u32 m0, s25, 50176
s_add_u32 s40, s64, 13312
buffer_load_dwordx4 v1, s[8:11], s40 offen lds
s_add_u32 m0, s25, 51200
s_add_u32 s40, s64, 14336
buffer_load_dwordx4 v1, s[8:11], s40 offen lds
s_add_u32 m0, s25, 52224
s_add_u32 s40, s64, 15360
buffer_load_dwordx4 v1, s[8:11], s40 offen lds
s_add_u32 m0, s25, 53248
s_add_u32 s40, s64, 16384
buffer_load_dwordx4 v1, s[8:11], s40 offen lds
s_add_u32 m0, s25, 54272
s_add_u32 s40, s64, 17408
buffer_load_dwordx4 v1, s[8:11], s40 offen lds
s_add_u32 m0, s25, 55296
s_add_u32 s40, s64, 18432
buffer_load_dwordx4 v1, s[8:11], s40 offen lds
s_add_u32 m0, s25, 56320
s_add_u32 s40, s64, 19456
buffer_load_dwordx4 v1, s[8:11], s40 offen lds
K7_222:
s_cmp_lt_u32 s20, 7
s_cbranch_scc0 KG_225
s_mov_b32 s39, 20000
s_mov_b32 s50, 0xffff
s_branch GF_228
GP_226:
s_bitcmp1_b32 s50, 0
s_cbranch_scc0 GL_229
s_add_u32 s40, s94, 0
buffer_load_dwordx2 v[72:73], v254, s[8:11], s40 offen sc1
GL_229:
s_bitcmp1_b32 s50, 1
s_cbranch_scc0 GL_230
s_add_u32 s40, s94, 4096
buffer_load_dwordx2 v[74:75], v254, s[8:11], s40 offen sc1
GL_230:
s_bitcmp1_b32 s50, 2
s_cbranch_scc0 GL_231
s_add_u32 s40, s94, 8192
buffer_load_dwordx2 v[76:77], v254, s[8:11], s40 offen sc1
GL_231:
s_bitcmp1_b32 s50, 3
s_cbranch_scc0 GL_232
s_add_u32 s40, s94, 12288
buffer_load_dwordx2 v[78:79], v254, s[8:11], s40 offen sc1
GL_232:
s_bitcmp1_b32 s50, 4
s_cbranch_scc0 GL_233
s_add_u32 s40, s94, 16384
buffer_load_dwordx2 v[80:81], v254, s[8:11], s40 offen sc1
GL_233:
s_bitcmp1_b32 s50, 5
s_cbranch_scc0 GL_234
s_add_u32 s40, s94, 20480
buffer_load_dwordx2 v[82:83], v254, s[8:11], s40 offen sc1
GL_234:
s_bitcmp1_b32 s50, 6
s_cbranch_scc0 GL_235
s_add_u32 s40, s94, 24576
buffer_load_dwordx2 v[84:85], v254, s[8:11], s40 offen sc1
GL_235:
s_bitcmp1_b32 s50, 7
s_cbranch_scc0 GL_236
s_add_u32 s40, s94, 28672
buffer_load_dwordx2 v[86:87], v254, s[8:11], s40 offen sc1
GL_236:
s_bitcmp1_b32 s50, 8
s_cbranch_scc0 GL_237
s_add_u32 s40, s94, 32768
buffer_load_dwordx2 v[88:89], v254, s[8:11], s40 offen sc1
GL_237:
s_bitcmp1_b32 s50, 9
s_cbranch_scc0 GL_238
s_add_u32 s40, s94, 36864
buffer_load_dwordx2 v[90:91], v254, s[8:11], s40 offen sc1
GL_238:
s_bitcmp1_b32 s50, 10
s_cbranch_scc0 GL_239
s_add_u32 s40, s94, 40960
buffer_load_dwordx2 v[92:93], v254, s[8:11], s40 offen sc1
GL_239:
s_bitcmp1_b32 s50, 11
s_cbranch_scc0 GL_240
s_add_u32 s40, s94, 45056
buffer_load_dwordx2 v[94:95], v254, s[8:11], s40 offen sc1
GL_240:
s_bitcmp1_b32 s50, 12
s_cbranch_scc0 GL_241
s_add_u32 s40, s94, 49152
buffer_load_dwordx2 v[96:97], v254, s[8:11], s40 offen sc1
GL_241:
s_bitcmp1_b32 s50, 13
s_cbranch_scc0 GL_242
s_add_u32 s40, s94, 53248
buffer_load_dwordx2 v[98:99], v254, s[8:11], s40 offen sc1
GL_242:
s_bitcmp1_b32 s50, 14
s_cbranch_scc0 GL_243
s_add_u32 s40, s94, 57344
buffer_load_dwordx2 v[100:101], v254, s[8:11], s40 offen sc1
GL_243:
s_bitcmp1_b32 s50, 15
s_cbranch_scc0 GL_244
s_add_u32 s40, s94, 61440
buffer_load_dwordx2 v[102:103], v254, s[8:11], s40 offen sc1
GL_244:
GF_228:
s_waitcnt vmcnt(0)
s_mov_b32 s50, 0
v_max3_u32 v5, v72, v74, v76
v_max3_u32 v6, v78, v80, v82
v_max3_u32 v5, v5, v84, v86
v_max3_u32 v6, v6, v88, v90
v_max3_u32 v5, v5, v92, v94
v_max3_u32 v6, v6, v96, v98
v_max3_u32 v5, v5, v100, v102
v_max_u32 v5, v5, v6
v_cmp_eq_u32 vcc, -1, v5
s_cbranch_vccz GX_227
v_cmp_eq_u32 vcc, -1, v72
s_cmp_lg_u64 vcc, 0
s_cselect_b32 s51, 1, 0
s_or_b32 s50, s50, s51
v_cmp_eq_u32 vcc, -1, v74
s_cmp_lg_u64 vcc, 0
s_cselect_b32 s51, 2, 0
s_or_b32 s50, s50, s51
v_cmp_eq_u32 vcc, -1, v76
s_cmp_lg_u64 vcc, 0
s_cselect_b32 s51, 4, 0
s_or_b32 s50, s50, s51
v_cmp_eq_u32 vcc, -1, v78
s_cmp_lg_u64 vcc, 0
s_cselect_b32 s51, 8, 0
s_or_b32 s50, s50, s51
v_cmp_eq_u32 vcc, -1, v80
s_cmp_lg_u64 vcc, 0
s_cselect_b32 s51, 16, 0
s_or_b32 s50, s50, s51
v_cmp_eq_u32 vcc, -1, v82
s_cmp_lg_u64 vcc, 0
s_cselect_b32 s51, 32, 0
s_or_b32 s50, s50, s51
v_cmp_eq_u32 vcc, -1, v84
s_cmp_lg_u64 vcc, 0
s_cselect_b32 s51, 64, 0
s_or_b32 s50, s50, s51
v_cmp_eq_u32 vcc, -1, v86
s_cmp_lg_u64 vcc, 0
s_cselect_b32 s51, 128, 0
s_or_b32 s50, s50, s51
v_cmp_eq_u32 vcc, -1, v88
s_cmp_lg_u64 vcc, 0
s_cselect_b32 s51, 256, 0
s_or_b32 s50, s50, s51
v_cmp_eq_u32 vcc, -1, v90
s_cmp_lg_u64 vcc, 0
s_cselect_b32 s51, 512, 0
s_or_b32 s50, s50, s51
v_cmp_eq_u32 vcc, -1, v92
s_cmp_lg_u64 vcc, 0
s_cselect_b32 s51, 1024, 0
s_or_b32 s50, s50, s51
v_cmp_eq_u32 vcc, -1, v94
s_cmp_lg_u64 vcc, 0
s_cselect_b32 s51, 2048, 0
s_or_b32 s50, s50, s51
v_cmp_eq_u32 vcc, -1, v96
s_cmp_lg_u64 vcc, 0
s_cselect_b32 s51, 4096, 0
s_or_b32 s50, s50, s51
v_cmp_eq_u32 vcc, -1, v98
s_cmp_lg_u64 vcc, 0
s_cselect_b32 s51, 8192, 0
s_or_b32 s50, s50, s51
v_cmp_eq_u32 vcc, -1, v100
s_cmp_lg_u64 vcc, 0
s_cselect_b32 s51, 16384, 0
s_or_b32 s50, s50, s51
v_cmp_eq_u32 vcc, -1, v102
s_cmp_lg_u64 vcc, 0
s_cselect_b32 s51, 32768, 0
s_or_b32 s50, s50, s51
s_sub_u32 s39, s39, 1
s_cbranch_scc0 GP_226
GX_227:
v_mov_b32 v108, 0x00003f80
v_mov_b32 v109, 0x3f800000
v_mov_b32 v104, 0
v_mov_b32 v105, 0
v_mov_b32 v106, 0
v_mov_b32 v107, 0
v_dot2c_f32_bf16 v104, v72, v108
v_dot2c_f32_bf16 v106, v73, v108
v_dot2c_f32_bf16 v105, v72, v109
v_dot2c_f32_bf16 v107, v73, v109
v_dot2c_f32_bf16 v104, v74, v108
v_dot2c_f32_bf16 v106, v75, v108
v_dot2c_f32_bf16 v105, v74, v109
v_dot2c_f32_bf16 v107, v75, v109
v_dot2c_f32_bf16 v104, v76, v108
v_dot2c_f32_bf16 v106, v77, v108
v_dot2c_f32_bf16 v105, v76, v109
v_dot2c_f32_bf16 v107, v77, v109
v_dot2c_f32_bf16 v104, v78, v108
v_dot2c_f32_bf16 v106, v79, v108
v_dot2c_f32_bf16 v105, v78, v109
v_dot2c_f32_bf16 v107, v79, v109
v_dot2c_f32_bf16 v104, v80, v108
v_dot2c_f32_bf16 v106, v81, v108
v_dot2c_f32_bf16 v105, v80, v109
v_dot2c_f32_bf16 v107, v81, v109
v_dot2c_f32_bf16 v104, v82, v108
v_dot2c_f32_bf16 v106, v83, v108
v_dot2c_f32_bf16 v105, v82, v109
v_dot2c_f32_bf16 v107, v83, v109
v_dot2c_f32_bf16 v104, v84, v108
v_dot2c_f32_bf16 v106, v85, v108
v_dot2c_f32_bf16 v105, v84, v109
v_dot2c_f32_bf16 v107, v85, v109
v_dot2c_f32_bf16 v104, v86, v108
v_dot2c_f32_bf16 v106, v87, v108
v_dot2c_f32_bf16 v105, v86, v109
v_dot2c_f32_bf16 v107, v87, v109
v_dot2c_f32_bf16 v104, v88, v108
v_dot2c_f32_bf16 v106, v89, v108
v_dot2c_f32_bf16 v105, v88, v109
v_dot2c_f32_bf16 v107, v89, v109
v_dot2c_f32_bf16 v104, v90, v108
v_dot2c_f32_bf16 v106, v91, v108
v_dot2c_f32_bf16 v105, v90, v109
v_dot2c_f32_bf16 v107, v91, v109
v_dot2c_f32_bf16 v104, v92, v108
v_dot2c_f32_bf16 v106, v93, v108
v_dot2c_f32_bf16 v105, v92, v109
v_dot2c_f32_bf16 v107, v93, v109
v_dot2c_f32_bf16 v104, v94, v108
v_dot2c_f32_bf16 v106, v95, v108
v_dot2c_f32_bf16 v105, v94, v109
v_dot2c_f32_bf16 v107, v95, v109
v_dot2c_f32_bf16 v104, v96, v108
v_dot2c_f32_bf16 v106, v97, v108
v_dot2c_f32_bf16 v105, v96, v109
v_dot2c_f32_bf16 v107, v97, v109
v_dot2c_f32_bf16 v104, v98, v108
v_dot2c_f32_bf16 v106, v99, v108
v_dot2c_f32_bf16 v105, v98, v109
v_dot2c_f32_bf16 v107, v99, v109
v_dot2c_f32_bf16 v104, v100, v108
v_dot2c_f32_bf16 v106, v101, v108
v_dot2c_f32_bf16 v105, v100, v109
v_dot2c_f32_bf16 v107, v101, v109
v_dot2c_f32_bf16 v104, v102, v108
v_dot2c_f32_bf16 v106, v103, v108
v_dot2c_f32_bf16 v105, v102, v109
v_dot2c_f32_bf16 v107, v103, v109
s_nop 1
v_cvt_pk_bf16_f32 v110, v104, v105
v_cvt_pk_bf16_f32 v111, v106, v107
ds_write_b64 v255, v[110:111]
KG_225:
s_waitcnt lgkmcnt(0)
s_barrier
v_add_u32 v5, 152576, v1
ds_read_b128 v[72:75], v5 offset:0
ds_read_b128 v[76:79], v5 offset:1024
ds_read_b128 v[80:83], v5 offset:2048
ds_read_b128 v[84:87], v5 offset:3072
ds_read_b128 v[88:91], v5 offset:4096
ds_read_b128 v[92:95], v5 offset:5120
ds_read_b128 v[96:99], v5 offset:6144
ds_read_b128 v[100:103], v5 offset:7168
ds_read_b128 v[104:107], v5 offset:8192
v_mov_b32 v112, 0
v_mov_b32 v113, 0
v_mov_b32 v114, 0
v_mov_b32 v115, 0
v_mov_b32 v116, 0
v_mov_b32 v117, 0
v_mov_b32 v118, 0
v_mov_b32 v119, 0
v_mov_b32 v120, 0
v_mov_b32 v121, 0
v_mov_b32 v122, 0
v_mov_b32 v123, 0
s_waitcnt lgkmcnt(0)
v_mfma_f32_16x16x32_bf16 v[112:115], v[72:75], v[16:19], v[112:115]
v_mfma_f32_16x16x32_bf16 v[116:119], v[84:87], v[16:19], v[116:119]
v_mfma_f32_16x16x32_bf16 v[120:123], v[96:99], v[16:19], v[120:123]
v_mfma_f32_16x16x32_bf16 v[112:115], v[76:79], v[20:23], v[112:115]
v_mfma_f32_16x16x32_bf16 v[116:119], v[88:91], v[20:23], v[116:119]
v_mfma_f32_16x16x32_bf16 v[120:123], v[100:103], v[20:23], v[120:123]
v_mfma_f32_16x16x32_bf16 v[112:115], v[80:83], v[24:27], v[112:115]
v_mfma_f32_16x16x32_bf16 v[116:119], v[92:95], v[24:27], v[116:119]
v_mfma_f32_16x16x32_bf16 v[120:123], v[104:107], v[24:27], v[120:123]
s_mul_i32 s52, s24, 4718592
s_add_u32 s52, s52, 18923520
s_add_u32 s53, s52, s68
s_add_u32 s54, s52, s69
v_lshrrev_b32 v5, 1, v3
v_lshlrev_b32 v5, 2, v5
v_lshl_add_u32 v5, v2, 4, v5
s_nop 0
v_add_f32 v121, 0x358637bd, v121
v_rcp_f32 v121, v121
s_nop 0
v_mul_f32 v112, v121, v112
v_mul_f32 v113, v121, v113
v_mul_f32 v114, v121, v114
v_mul_f32 v115, v121, v115
v_mul_f32 v116, v121, v116
v_mul_f32 v117, v121, v117
v_mul_f32 v118, v121, v118
v_mul_f32 v119, v121, v119
v_mul_f32 v120, v121, v120
v_cvt_pk_bf16_f32 v128, v112, v113
v_cvt_pk_bf16_f32 v129, v114, v115
v_cvt_pk_bf16_f32 v130, v116, v117
v_cvt_pk_bf16_f32 v131, v118, v119
v_mov_b32 v6, v120
s_nop 1
v_permlane16_swap_b32 v120, v6
s_nop 0
v_cvt_pk_bf16_f32 v132, v120, v6
s_cmp_eq_u32 s23, 0
s_cbranch_scc0 HS_246
buffer_store_dwordx4 v[128:131], v1, s[8:11], s53 offen
buffer_store_dword v132, v5, s[8:11], s54 offen
HJ_247:
s_mul_i32 s45, s24, 4718592
s_add_u32 s45, s45, 18923520
s_add_u32 s45, s45, s71
s_lshl_b32 s44, s30, 13
s_add_u32 s44, s44, s45
s_lshl_b32 s43, s30, 10
s_add_u32 s43, s43, s45
s_add_u32 s43, s43, 16384
s_mul_i32 s47, s30, 4608
v_add_u32 v220, s47, v1
v_add_u32 v221, 0x10000, v220
v_add_u32 v222, 0x20000, v220
v_and_b32 v224, 7, v4
v_lshlrev_b32 v224, 4, v224
v_lshl_add_u32 v224, v3, 7, v224
v_add_u32 v224, s47, v224
v_add_u32 v224, 4096, v224
v_add_u32 v225, 0x10000, v224
v_add_u32 v226, 0x20000, v224
s_mov_b32 s39, 20000
s_mov_b64 exec, 0xffff
LP_248:
buffer_load_dword v6, v247, s[8:11], s43 offen sc1
s_waitcnt vmcnt(0)
v_cmp_eq_u32 vcc, -1, v6
s_sub_u32 s39, s39, 1
s_cbranch_scc1 LX_249
s_cbranch_vccnz LP_248
LX_249:
s_mov_b64 exec, -1
buffer_load_dwordx4 v[16:19], v1, s[8:11], s43 offen offset:0 sc1
buffer_load_dwordx4 v[20:23], v1, s[8:11], s44 offen offset:0 sc1
buffer_load_dwordx4 v[24:27], v1, s[8:11], s44 offen offset:1024 sc1
buffer_load_dwordx4 v[28:31], v1, s[8:11], s44 offen offset:2048 sc1
buffer_load_dwordx4 v[32:35], v1, s[8:11], s44 offen offset:3072 sc1
s_barrier
ds_read_b128 v[116:119], v220 offset:64512
ds_read_b128 v[120:123], v221 offset:0
ds_read_b128 v[124:127], v221 offset:1024
ds_read_b128 v[128:131], v221 offset:2048
ds_read_b128 v[132:135], v224 offset:64512
ds_read_b128 v[136:139], v221 offset:8192
ds_read_b128 v[140:143], v221 offset:9216
ds_read_b128 v[144:147], v221 offset:10240
ds_read_b128 v[148:151], v221 offset:11264
ds_read_b128 v[152:155], v225 offset:8192
v_mov_b32 v172, 0
v_mov_b32 v173, 0
v_mov_b32 v174, 0
v_mov_b32 v175, 0
v_mov_b32 v176, 0
v_mov_b32 v177, 0
v_mov_b32 v178, 0
v_mov_b32 v179, 0
v_mov_b32 v180, 0
v_mov_b32 v181, 0
v_mov_b32 v182, 0
v_mov_b32 v183, 0
v_mov_b32 v184, 0
v_mov_b32 v185, 0
v_mov_b32 v186, 0
v_mov_b32 v187, 0
v_mov_b32 v188, 0
v_mov_b32 v189, 0
v_mov_b32 v190, 0
v_mov_b32 v191, 0
s_waitcnt vmcnt(4)
v_max3_u32 v6, v16, v17, v18
v_max_u32 v6, v6, v19
v_cmp_eq_u32 vcc, -1, v6
s_cbranch_vccnz RT_250
RB_251:
s_waitcnt lgkmcnt(9)
v_mfma_f32_16x16x32_bf16 v[172:175], v[116:119], v[16:19], v[172:175]
ds_read_b128 v[116:119], v221 offset:17408
s_add_u32 s40, s44, 4096
buffer_load_dwordx4 v[36:39], v1, s[8:11], s40 offen offset:0 sc1
s_waitcnt lgkmcnt(9)
v_mfma_f32_16x16x32_bf16 v[176:179], v[120:123], v[16:19], v[176:179]
ds_read_b128 v[120:123], v221 offset:18432
s_waitcnt lgkmcnt(9)
v_mfma_f32_16x16x32_bf16 v[180:183], v[124:127], v[16:19], v[180:183]
ds_read_b128 v[124:127], v221 offset:19456
s_waitcnt lgkmcnt(9)
v_mfma_f32_16x16x32_bf16 v[184:187], v[128:131], v[16:19], v[184:187]
ds_read_b128 v[128:131], v221 offset:20480
s_waitcnt vmcnt(4)
v_cmp_eq_u32 vcc, -1, v20
s_waitcnt lgkmcnt(9)
v_mfma_f32_16x16x32_bf16 v[188:191], v[132:135], v[16:19], v[188:191]
ds_read_b128 v[132:135], v225 offset:17408
s_cbranch_vccnz RT_253
RB_254:
s_waitcnt lgkmcnt(9)
v_mfma_f32_16x16x32_bf16 v[172:175], v[136:139], v[20:23], v[172:175]
ds_read_b128 v[136:139], v221 offset:26624
s_add_u32 s40, s44, 4096
buffer_load_dwordx4 v[40:43], v1, s[8:11], s40 offen offset:1024 sc1
s_waitcnt lgkmcnt(9)
v_mfma_f32_16x16x32_bf16 v[176:179], v[140:143], v[20:23], v[176:179]
ds_read_b128 v[140:143], v221 offset:27648
s_waitcnt lgkmcnt(9)
v_mfma_f32_16x16x32_bf16 v[180:183], v[144:147], v[20:23], v[180:183]
ds_read_b128 v[144:147], v221 offset:28672
s_waitcnt lgkmcnt(9)
v_mfma_f32_16x16x32_bf16 v[184:187], v[148:151], v[20:23], v[184:187]
ds_read_b128 v[148:151], v221 offset:29696
s_waitcnt vmcnt(4)
v_cmp_eq_u32 vcc, -1, v24
s_waitcnt lgkmcnt(9)
v_mfma_f32_16x16x32_bf16 v[188:191], v[152:155], v[20:23], v[188:191]
ds_read_b128 v[152:155], v225 offset:26624
s_cbranch_vccnz RT_256
RB_257:
s_waitcnt lgkmcnt(9)
v_mfma_f32_16x16x32_bf16 v[172:175], v[116:119], v[24:27], v[172:175]
ds_read_b128 v[116:119], v221 offset:63488
s_add_u32 s40, s44, 4096
buffer_load_dwordx4 v[44:47], v1, s[8:11], s40 offen offset:2048 sc1
s_waitcnt lgkmcnt(9)
v_mfma_f32_16x16x32_bf16 v[176:179], v[120:123], v[24:27], v[176:179]
ds_read_b128 v[120:123], v221 offset:64512
s_waitcnt lgkmcnt(9)
v_mfma_f32_16x16x32_bf16 v[180:183], v[124:127], v[24:27], v[180:183]
ds_read_b128 v[124:127], v222 offset:0
s_waitcnt lgkmcnt(9)
v_mfma_f32_16x16x32_bf16 v[184:187], v[128:131], v[24:27], v[184:187]
ds_read_b128 v[128:131], v222 offset:1024
s_waitcnt vmcnt(4)
v_cmp_eq_u32 vcc, -1, v28
s_waitcnt lgkmcnt(9)
v_mfma_f32_16x16x32_bf16 v[188:191], v[132:135], v[24:27], v[188:191]
ds_read_b128 v[132:135], v225 offset:63488
s_cbranch_vccnz RT_259
RB_260:
s_waitcnt lgkmcnt(9)
v_mfma_f32_16x16x32_bf16 v[172:175], v[136:139], v[28:31], v[172:175]
ds_read_b128 v[136:139], v222 offset:7168
s_add_u32 s40, s44, 4096
buffer_load_dwordx4 v[48:51], v1, s[8:11], s40 offen offset:3072 sc1
s_waitcnt lgkmcnt(9)
v_mfma_f32_16x16x32_bf16 v[176:179], v[140:143], v[28:31], v[176:179]
ds_read_b128 v[140:143], v222 offset:8192
s_waitcnt lgkmcnt(9)
v_mfma_f32_16x16x32_bf16 v[180:183], v[144:147], v[28:31], v[180:183]
ds_read_b128 v[144:147], v222 offset:9216
s_waitcnt lgkmcnt(9)
v_mfma_f32_16x16x32_bf16 v[184:187], v[148:151], v[28:31], v[184:187]
ds_read_b128 v[148:151], v222 offset:10240
s_waitcnt vmcnt(4)
v_cmp_eq_u32 vcc, -1, v32
s_waitcnt lgkmcnt(9)
v_mfma_f32_16x16x32_bf16 v[188:191], v[152:155], v[28:31], v[188:191]
ds_read_b128 v[152:155], v226 offset:7168
s_cmp_eq_u32 s24, 0
s_cbranch_scc0 PC_262
v_mov_b32 v228, -1
v_mov_b32 v229, -1
v_mov_b32 v230, -1
v_mov_b32 v231, -1
s_mov_b32 s49, 13615104
s_add_u32 s46, s49, s90
s_add_u32 s47, s49, s91
s_add_u32 s48, s49, s92
s_cmp_eq_u32 s23, 0
s_cbranch_scc0 HS_263
buffer_store_dwordx4 v[228:231], v1, s[8:11], s46 offen
s_mov_b64 exec, s[72:73]
buffer_store_dwordx2 v[228:229], v7, s[8:11], s47 offen
s_mov_b64 exec, -1
s_mov_b64 exec, s[82:83]
buffer_store_dwordx2 v[228:229], v202, s[8:11], s48 offen
s_mov_b64 exec, -1
HJ_264:
PC_262:
s_cbranch_vccnz RT_265
RB_266:
s_waitcnt lgkmcnt(9)
v_mfma_f32_16x16x32_bf16 v[172:175], v[116:119], v[32:35], v[172:175]
ds_read_b128 v[116:119], v220 offset:18432
s_waitcnt lgkmcnt(9)
v_mfma_f32_16x16x32_bf16 v[176:179], v[120:123], v[32:35], v[176:179]
ds_read_b128 v[120:123], v220 offset:19456
s_waitcnt lgkmcnt(9)
v_mfma_f32_16x16x32_bf16 v[180:183], v[124:127], v[32:35], v[180:183]
ds_read_b128 v[124:127], v220 offset:20480
s_waitcnt lgkmcnt(9)
v_mfma_f32_16x16x32_bf16 v[184:187], v[128:131], v[32:35], v[184:187]
ds_read_b128 v[128:131], v220 offset:21504
s_waitcnt vmcnt(3)
v_cmp_eq_u32 vcc, -1, v36
s_waitcnt lgkmcnt(9)
v_mfma_f32_16x16x32_bf16 v[188:191], v[132:135], v[32:35], v[188:191]
ds_read_b128 v[132:135], v224 offset:18432
s_barrier
s_cmp_eq_u32 s24, 0
s_cbranch_scc0 GD_268
s_add_u32 m0, s25, 64512
s_add_u32 s40, s64, 27648
buffer_load_dwordx4 v1, s[8:11], s40 offen lds
s_add_u32 m0, s25, 72704
s_add_u32 s40, s64, 35840
buffer_load_dwordx4 v1, s[8:11], s40 offen lds
s_add_u32 m0, s25, 80896
s_add_u32 s40, s64, 44032
buffer_load_dwordx4 v1, s[8:11], s40 offen lds
s_add_u32 m0, s25, 89088
s_add_u32 s40, s64, 52224
buffer_load_dwordx4 v1, s[8:11], s40 offen lds
s_cmp_lt_u32 s20, 4
s_cbranch_scc0 DS_269
s_add_u32 m0, s25, 97280
s_add_u32 s40, s64, 60416
buffer_load_dwordx4 v1, s[8:11], s40 offen lds
DS_269:
GD_268:
s_cbranch_vccnz RT_270
RB_271:
s_waitcnt lgkmcnt(9)
v_mfma_f32_16x16x32_bf16 v[172:175], v[136:139], v[36:39], v[172:175]
ds_read_b128 v[136:139], v221 offset:45056
s_waitcnt lgkmcnt(9)
v_mfma_f32_16x16x32_bf16 v[176:179], v[140:143], v[36:39], v[176:179]
ds_read_b128 v[140:143], v221 offset:46080
s_waitcnt lgkmcnt(9)
v_mfma_f32_16x16x32_bf16 v[180:183], v[144:147], v[36:39], v[180:183]
ds_read_b128 v[144:147], v221 offset:47104
s_waitcnt lgkmcnt(9)
v_mfma_f32_16x16x32_bf16 v[184:187], v[148:151], v[36:39], v[184:187]
ds_read_b128 v[148:151], v221 offset:48128
s_waitcnt vmcnt(2)
v_cmp_eq_u32 vcc, -1, v40
s_waitcnt lgkmcnt(9)
v_mfma_f32_16x16x32_bf16 v[188:191], v[152:155], v[36:39], v[188:191]
ds_read_b128 v[152:155], v225 offset:45056
s_cbranch_vccnz RT_273
RB_274:
s_waitcnt lgkmcnt(9)
v_mfma_f32_16x16x32_bf16 v[172:175], v[116:119], v[40:43], v[172:175]
ds_read_b128 v[116:119], v221 offset:54272
s_waitcnt lgkmcnt(9)
v_mfma_f32_16x16x32_bf16 v[176:179], v[120:123], v[40:43], v[176:179]
ds_read_b128 v[120:123], v221 offset:55296
s_waitcnt lgkmcnt(9)
v_mfma_f32_16x16x32_bf16 v[180:183], v[124:127], v[40:43], v[180:183]
ds_read_b128 v[124:127], v221 offset:56320
s_waitcnt lgkmcnt(9)
v_mfma_f32_16x16x32_bf16 v[184:187], v[128:131], v[40:43], v[184:187]
ds_read_b128 v[128:131], v221 offset:57344
s_waitcnt vmcnt(1)
v_cmp_eq_u32 vcc, -1, v44
s_waitcnt lgkmcnt(9)
v_mfma_f32_16x16x32_bf16 v[188:191], v[132:135], v[40:43], v[188:191]
ds_read_b128 v[132:135], v225 offset:54272
s_cbranch_vccnz RT_276
RB_277:
s_waitcnt lgkmcnt(9)
v_mfma_f32_16x16x32_bf16 v[172:175], v[136:139], v[44:47], v[172:175]
s_waitcnt lgkmcnt(8)
v_mfma_f32_16x16x32_bf16 v[176:179], v[140:143], v[44:47], v[176:179]
s_waitcnt lgkmcnt(7)
v_mfma_f32_16x16x32_bf16 v[180:183], v[144:147], v[44:47], v[180:183]
s_waitcnt lgkmcnt(6)
v_mfma_f32_16x16x32_bf16 v[184:187], v[148:151], v[44:47], v[184:187]
s_waitcnt vmcnt(0)
v_cmp_eq_u32 vcc, -1, v48
s_waitcnt lgkmcnt(5)
v_mfma_f32_16x16x32_bf16 v[188:191], v[152:155], v[44:47], v[188:191]
s_cbranch_vccnz RT_279
RB_280:
s_waitcnt lgkmcnt(4)
v_mfma_f32_16x16x32_bf16 v[172:175], v[116:119], v[48:51], v[172:175]
s_waitcnt lgkmcnt(3)
v_mfma_f32_16x16x32_bf16 v[176:179], v[120:123], v[48:51], v[176:179]
s_waitcnt lgkmcnt(2)
v_mfma_f32_16x16x32_bf16 v[180:183], v[124:127], v[48:51], v[180:183]
s_waitcnt lgkmcnt(1)
v_mfma_f32_16x16x32_bf16 v[184:187], v[128:131], v[48:51], v[184:187]
s_waitcnt lgkmcnt(0)
v_mfma_f32_16x16x32_bf16 v[188:191], v[132:135], v[48:51], v[188:191]
s_barrier
s_cmp_eq_u32 s24, 0
s_cbranch_scc0 GD_282
s_add_u32 m0, s25, 110592
s_add_u32 s40, s64, 73728
buffer_load_dwordx4 v1, s[8:11], s40 offen lds
s_add_u32 m0, s25, 118784
s_add_u32 s40, s64, 81920
buffer_load_dwordx4 v1, s[8:11], s40 offen lds
s_cmp_lt_u32 s20, 2
s_cbranch_scc0 DS_283
s_add_u32 m0, s25, 126976
s_add_u32 s40, s64, 90112
buffer_load_dwordx4 v1, s[8:11], s40 offen lds
DS_283:
s_add_u32 m0, s25, 18432
s_add_u32 s40, s64, 110592
buffer_load_dwordx4 v1, s[8:11], s40 offen lds
s_cmp_lt_u32 s20, 1
s_cbranch_scc0 DS_284
s_add_u32 m0, s25, 26624
s_add_u32 s40, s64, 118784
buffer_load_dwordx4 v1, s[8:11], s40 offen lds
DS_284:
GD_282:
s_mul_i32 s47, s29, 4608
s_add_u32 s47, s47, 129024
v_add_u32 v220, s47, v1
v_and_b32 v221, 31, v4
v_lshlrev_b32 v221, 4, v221
v_add_u32 v221, s47, v221
s_mov_b64 exec, s[74:75]
ds_write_b128 v221, v[188:191] offset:4096
s_mov_b64 exec, -1
s_cmp_eq_u32 s30, 0
s_cbranch_scc0 PE_285
ds_write_b128 v220, v[180:183] offset:2048
ds_write_b128 v220, v[184:187] offset:3072
s_branch PE_286
PE_285:
ds_write_b128 v220, v[172:175]
ds_write_b128 v220, v[176:179] offset:1024
PE_286:
s_waitcnt lgkmcnt(0)
s_barrier
ds_read_b128 v[40:43], v221 offset:4096
s_cmp_eq_u32 s30, 0
s_cbranch_scc0 PE_287
ds_read_b128 v[32:35], v220
ds_read_b128 v[36:39], v220 offset:1024
s_waitcnt lgkmcnt(0)
v_pk_add_f32 v[32:33], v[32:33], v[172:173]
v_pk_add_f32 v[34:35], v[34:35], v[174:175]
v_pk_add_f32 v[36:37], v[36:37], v[176:177]
v_pk_add_f32 v[38:39], v[38:39], v[178:179]
s_branch PE_288
PE_287:
ds_read_b128 v[32:35], v220 offset:2048
ds_read_b128 v[36:39], v220 offset:3072
s_waitcnt lgkmcnt(0)
v_pk_add_f32 v[32:33], v[32:33], v[180:181]
v_pk_add_f32 v[34:35], v[34:35], v[182:183]
v_pk_add_f32 v[36:37], v[36:37], v[184:185]
v_pk_add_f32 v[38:39], v[38:39], v[186:187]
PE_288:
v_pk_add_f32 v[40:41], v[40:41], v[188:189]
v_pk_add_f32 v[42:43], v[42:43], v[190:191]
v_lshlrev_b32 v44, 16, v8
v_and_b32 v45, 0xffff0000, v8
v_pk_add_f32 v[32:33], v[32:33], v[44:45]
v_cvt_pk_bf16_f32 v8, v32, v33
v_lshlrev_b32 v46, 16, v9
v_and_b32 v47, 0xffff0000, v9
v_pk_add_f32 v[34:35], v[34:35], v[46:47]
v_cvt_pk_bf16_f32 v9, v34, v35
v_lshlrev_b32 v44, 16, v10
v_and_b32 v45, 0xffff0000, v10
v_pk_add_f32 v[36:37], v[36:37], v[44:45]
v_cvt_pk_bf16_f32 v10, v36, v37
v_lshlrev_b32 v46, 16, v11
v_and_b32 v47, 0xffff0000, v11
v_pk_add_f32 v[38:39], v[38:39], v[46:47]
v_cvt_pk_bf16_f32 v11, v38, v39
v_lshlrev_b32 v44, 16, v12
v_and_b32 v45, 0xffff0000, v12
v_pk_add_f32 v[40:41], v[40:41], v[44:45]
v_cvt_pk_bf16_f32 v12, v40, v41
v_lshlrev_b32 v46, 16, v13
v_and_b32 v47, 0xffff0000, v13
v_pk_add_f32 v[42:43], v[42:43], v[46:47]
v_cvt_pk_bf16_f32 v13, v42, v43
s_cmp_eq_u32 s24, 1
s_cbranch_scc1 PF_289
s_mul_i32 s45, s24, 5242880
s_add_u32 s45, s45, 10993664
s_add_u32 s46, s45, s90
s_add_u32 s47, s45, s91
s_add_u32 s48, s45, s92
s_cmp_eq_u32 s23, 0
s_cbranch_scc0 HS_290
buffer_store_dwordx4 v[8:11], v1, s[8:11], s46 offen
v_cndmask_b32_e64 v50, 0, v12, s[72:73]
v_cndmask_b32_e64 v51, 0, v13, s[72:73]
v_mov_b32 v52, 0
v_mov_b32 v53, 0
v_mfma_f32_16x16x32_bf16 v[56:59], v[236:239], v[8:11], 0
v_mfma_f32_16x16x32_bf16 v[60:63], v[8:11], v[8:11], 0
s_mov_b64 exec, s[72:73]
buffer_store_dwordx2 v[12:13], v7, s[8:11], s47 offen
s_mov_b64 exec, -1
v_mfma_f32_16x16x32_bf16 v[56:59], v[236:239], v[50:53], v[56:59]
v_mfma_f32_16x16x32_bf16 v[60:63], v[50:53], v[50:53], v[60:63]
s_nop 7
v_cndmask_b32_e64 v60, v60, v61, s[76:77]
v_cndmask_b32_e64 v60, v60, v62, s[78:79]
v_cndmask_b32_e64 v57, v60, v63, s[80:81]
s_mov_b64 exec, s[82:83]
buffer_store_dwordx2 v[56:57], v202, s[8:11], s48 offen
s_mov_b64 exec, -1
HJ_291:
s_cmp_eq_u32 s27, 1
s_cbranch_scc0 PH_292
s_cmp_eq_u32 s29, 3
s_cbranch_scc0 PH_292
s_mul_i32 s45, s21, 20480
s_add_u32 s45, s45, 16236544
s_sub_u32 s45, s45, s93
s_add_u32 s46, s45, s90
s_add_u32 s47, s45, s91
s_add_u32 s48, s45, s92
buffer_store_dwordx4 v[8:11], v1, s[8:11], s46 offen sc1
s_mov_b64 exec, s[72:73]
buffer_store_dwordx2 v[12:13], v7, s[8:11], s47 offen sc1
s_mov_b64 exec, -1
s_mov_b64 exec, s[82:83]
buffer_store_dwordx2 v[56:57], v202, s[8:11], s48 offen sc1
s_mov_b64 exec, -1
PH_292:
s_mov_b32 s24, 1
s_branch M_LOOP
PF_289:
s_lshl_b32 s46, s21, 3
s_lshl_b32 s47, s27, 2
s_add_u32 s46, s46, s47
s_add_u32 s46, s46, s29
s_mul_i32 s46, s46, 18432
s_mul_i32 s47, s28, 144
s_add_u32 s46, s46, s47
s_lshl_b32 s47, s30, 6
s_add_u32 s47, s47, s46
s_add_u32 s46, s46, 128
v_mul_u32_u24 v5, 1152, v2
v_lshl_add_u32 v6, v3, 4, v5
v_lshl_add_u32 v5, v3, 3, v5
buffer_store_dwordx4 v[8:11], v6, s[12:15], s47 offen
s_mov_b64 exec, s[72:73]
buffer_store_dwordx2 v[12:13], v5, s[12:15], s46 offen
M_END:
s_endpgm
HS_12:
buffer_store_dwordx4 v[220:223], v1, s[8:11], s41 offen sc1
s_mov_b64 exec, 0xffff
buffer_store_dwordx2 v[220:221], v202, s[8:11], s42 offen sc1
s_mov_b64 exec, -1
s_branch HJ_13
RT_17:
s_mov_b32 s39, 20000
RL_19:
s_add_u32 s40, s46, 16384
buffer_load_dwordx4 v[16:19], v1, s[8:11], s40 offen offset:0 sc1
s_add_u32 s40, s46, 16384
buffer_load_dwordx4 v[20:23], v1, s[8:11], s40 offen offset:1024 sc1
buffer_load_dwordx4 v[24:27], v1, s[8:11], s46 offen offset:0 sc1
buffer_load_dwordx4 v[28:31], v1, s[8:11], s46 offen offset:1024 sc1
buffer_load_dwordx4 v[32:35], v1, s[8:11], s46 offen offset:2048 sc1
s_waitcnt vmcnt(0)
v_max3_u32 v6, v16, v17, v18
v_max3_u32 v6, v6, v19, v20
v_max3_u32 v6, v6, v21, v22
v_max3_u32 v6, v6, v23, v24
v_max3_u32 v6, v6, v25, v26
v_max3_u32 v6, v6, v27, v28
v_max3_u32 v6, v6, v29, v30
v_max3_u32 v6, v6, v31, v32
v_max3_u32 v6, v6, v33, v34
v_max_u32 v6, v6, v35
v_cmp_eq_u32 vcc, -1, v6
s_sub_u32 s39, s39, 1
s_cbranch_scc1 RB_18
s_cbranch_vccnz RL_19
s_branch RB_18
RT_20:
s_mov_b32 s39, 20000
RL_22:
s_add_u32 s40, s46, 16384
buffer_load_dwordx4 v[20:23], v1, s[8:11], s40 offen offset:1024 sc1
buffer_load_dwordx4 v[24:27], v1, s[8:11], s46 offen offset:0 sc1
buffer_load_dwordx4 v[28:31], v1, s[8:11], s46 offen offset:1024 sc1
buffer_load_dwordx4 v[32:35], v1, s[8:11], s46 offen offset:2048 sc1
buffer_load_dwordx4 v[36:39], v1, s[8:11], s46 offen offset:3072 sc1
s_waitcnt vmcnt(0)
v_max3_u32 v6, v20, v21, v22
v_max3_u32 v6, v6, v23, v24
v_max3_u32 v6, v6, v25, v26
v_max3_u32 v6, v6, v27, v28
v_max3_u32 v6, v6, v29, v30
v_max3_u32 v6, v6, v31, v32
v_max3_u32 v6, v6, v33, v34
v_max3_u32 v6, v6, v35, v36
v_max3_u32 v6, v6, v37, v38
v_max_u32 v6, v6, v39
v_cmp_eq_u32 vcc, -1, v6
s_sub_u32 s39, s39, 1
s_cbranch_scc1 RB_21
s_cbranch_vccnz RL_22
s_branch RB_21
RT_23:
s_mov_b32 s39, 20000
RL_25:
buffer_load_dwordx4 v[24:27], v1, s[8:11], s46 offen offset:0 sc1
buffer_load_dwordx4 v[28:31], v1, s[8:11], s46 offen offset:1024 sc1
buffer_load_dwordx4 v[32:35], v1, s[8:11], s46 offen offset:2048 sc1
buffer_load_dwordx4 v[36:39], v1, s[8:11], s46 offen offset:3072 sc1
s_add_u32 s40, s46, 4096
buffer_load_dwordx4 v[40:43], v1, s[8:11], s40 offen offset:0 sc1
s_waitcnt vmcnt(0)
v_max3_u32 v6, v24, v25, v26
v_max3_u32 v6, v6, v27, v28
v_max3_u32 v6, v6, v29, v30
v_max3_u32 v6, v6, v31, v32
v_max3_u32 v6, v6, v33, v34
v_max3_u32 v6, v6, v35, v36
v_max3_u32 v6, v6, v37, v38
v_max3_u32 v6, v6, v39, v40
v_max3_u32 v6, v6, v41, v42
v_max_u32 v6, v6, v43
v_cmp_eq_u32 vcc, -1, v6
s_sub_u32 s39, s39, 1
s_cbranch_scc1 RB_24
s_cbranch_vccnz RL_25
s_branch RB_24
RT_26:
s_mov_b32 s39, 20000
RL_28:
buffer_load_dwordx4 v[28:31], v1, s[8:11], s46 offen offset:1024 sc1
buffer_load_dwordx4 v[32:35], v1, s[8:11], s46 offen offset:2048 sc1
buffer_load_dwordx4 v[36:39], v1, s[8:11], s46 offen offset:3072 sc1
s_add_u32 s40, s46, 4096
buffer_load_dwordx4 v[40:43], v1, s[8:11], s40 offen offset:0 sc1
s_add_u32 s40, s46, 4096
buffer_load_dwordx4 v[44:47], v1, s[8:11], s40 offen offset:1024 sc1
s_waitcnt vmcnt(0)
v_max3_u32 v6, v28, v29, v30
v_max3_u32 v6, v6, v31, v32
v_max3_u32 v6, v6, v33, v34
v_max3_u32 v6, v6, v35, v36
v_max3_u32 v6, v6, v37, v38
v_max3_u32 v6, v6, v39, v40
v_max3_u32 v6, v6, v41, v42
v_max3_u32 v6, v6, v43, v44
v_max3_u32 v6, v6, v45, v46
v_max_u32 v6, v6, v47
v_cmp_eq_u32 vcc, -1, v6
s_sub_u32 s39, s39, 1
s_cbranch_scc1 RB_27
s_cbranch_vccnz RL_28
s_branch RB_27
RT_29:
s_mov_b32 s39, 20000
RL_31:
buffer_load_dwordx4 v[32:35], v1, s[8:11], s46 offen offset:2048 sc1
buffer_load_dwordx4 v[36:39], v1, s[8:11], s46 offen offset:3072 sc1
s_add_u32 s40, s46, 4096
buffer_load_dwordx4 v[40:43], v1, s[8:11], s40 offen offset:0 sc1
s_add_u32 s40, s46, 4096
buffer_load_dwordx4 v[44:47], v1, s[8:11], s40 offen offset:1024 sc1
s_add_u32 s40, s46, 4096
buffer_load_dwordx4 v[48:51], v1, s[8:11], s40 offen offset:2048 sc1
s_waitcnt vmcnt(0)
v_max3_u32 v6, v32, v33, v34
v_max3_u32 v6, v6, v35, v36
v_max3_u32 v6, v6, v37, v38
v_max3_u32 v6, v6, v39, v40
v_max3_u32 v6, v6, v41, v42
v_max3_u32 v6, v6, v43, v44
v_max3_u32 v6, v6, v45, v46
v_max3_u32 v6, v6, v47, v48
v_max3_u32 v6, v6, v49, v50
v_max_u32 v6, v6, v51
v_cmp_eq_u32 vcc, -1, v6
s_sub_u32 s39, s39, 1
s_cbranch_scc1 RB_30
s_cbranch_vccnz RL_31
s_branch RB_30
RT_32:
s_mov_b32 s39, 20000
RL_34:
buffer_load_dwordx4 v[36:39], v1, s[8:11], s46 offen offset:3072 sc1
s_add_u32 s40, s46, 4096
buffer_load_dwordx4 v[40:43], v1, s[8:11], s40 offen offset:0 sc1
s_add_u32 s40, s46, 4096
buffer_load_dwordx4 v[44:47], v1, s[8:11], s40 offen offset:1024 sc1
s_add_u32 s40, s46, 4096
buffer_load_dwordx4 v[48:51], v1, s[8:11], s40 offen offset:2048 sc1
s_add_u32 s40, s46, 4096
buffer_load_dwordx4 v[52:55], v1, s[8:11], s40 offen offset:3072 sc1
s_waitcnt vmcnt(0)
v_max3_u32 v6, v36, v37, v38
v_max3_u32 v6, v6, v39, v40
v_max3_u32 v6, v6, v41, v42
v_max3_u32 v6, v6, v43, v44
v_max3_u32 v6, v6, v45, v46
v_max3_u32 v6, v6, v47, v48
v_max3_u32 v6, v6, v49, v50
v_max3_u32 v6, v6, v51, v52
v_max3_u32 v6, v6, v53, v54
v_max_u32 v6, v6, v55
v_cmp_eq_u32 vcc, -1, v6
s_sub_u32 s39, s39, 1
s_cbranch_scc1 RB_33
s_cbranch_vccnz RL_34
s_branch RB_33
RT_35:
s_mov_b32 s39, 20000
RL_37:
s_add_u32 s40, s46, 4096
buffer_load_dwordx4 v[40:43], v1, s[8:11], s40 offen offset:0 sc1
s_add_u32 s40, s46, 4096
buffer_load_dwordx4 v[44:47], v1, s[8:11], s40 offen offset:1024 sc1
s_add_u32 s40, s46, 4096
buffer_load_dwordx4 v[48:51], v1, s[8:11], s40 offen offset:2048 sc1
s_add_u32 s40, s46, 4096
buffer_load_dwordx4 v[52:55], v1, s[8:11], s40 offen offset:3072 sc1
s_add_u32 s40, s46, 8192
buffer_load_dwordx4 v[56:59], v1, s[8:11], s40 offen offset:0 sc1
s_waitcnt vmcnt(0)
v_max3_u32 v6, v40, v41, v42
v_max3_u32 v6, v6, v43, v44
v_max3_u32 v6, v6, v45, v46
v_max3_u32 v6, v6, v47, v48
v_max3_u32 v6, v6, v49, v50
v_max3_u32 v6, v6, v51, v52
v_max3_u32 v6, v6, v53, v54
v_max3_u32 v6, v6, v55, v56
v_max3_u32 v6, v6, v57, v58
v_max_u32 v6, v6, v59
v_cmp_eq_u32 vcc, -1, v6
s_sub_u32 s39, s39, 1
s_cbranch_scc1 RB_36
s_cbranch_vccnz RL_37
s_branch RB_36
RT_38:
s_mov_b32 s39, 20000
RL_40:
s_add_u32 s40, s46, 4096
buffer_load_dwordx4 v[44:47], v1, s[8:11], s40 offen offset:1024 sc1
s_add_u32 s40, s46, 4096
buffer_load_dwordx4 v[48:51], v1, s[8:11], s40 offen offset:2048 sc1
s_add_u32 s40, s46, 4096
buffer_load_dwordx4 v[52:55], v1, s[8:11], s40 offen offset:3072 sc1
s_add_u32 s40, s46, 8192
buffer_load_dwordx4 v[56:59], v1, s[8:11], s40 offen offset:0 sc1
s_add_u32 s40, s46, 8192
buffer_load_dwordx4 v[60:63], v1, s[8:11], s40 offen offset:1024 sc1
s_waitcnt vmcnt(0)
v_max3_u32 v6, v44, v45, v46
v_max3_u32 v6, v6, v47, v48
v_max3_u32 v6, v6, v49, v50
v_max3_u32 v6, v6, v51, v52
v_max3_u32 v6, v6, v53, v54
v_max3_u32 v6, v6, v55, v56
v_max3_u32 v6, v6, v57, v58
v_max3_u32 v6, v6, v59, v60
v_max3_u32 v6, v6, v61, v62
v_max_u32 v6, v6, v63
v_cmp_eq_u32 vcc, -1, v6
s_sub_u32 s39, s39, 1
s_cbranch_scc1 RB_39
s_cbranch_vccnz RL_40
s_branch RB_39
RT_41:
s_mov_b32 s39, 20000
RL_43:
s_add_u32 s40, s46, 4096
buffer_load_dwordx4 v[48:51], v1, s[8:11], s40 offen offset:2048 sc1
s_add_u32 s40, s46, 4096
buffer_load_dwordx4 v[52:55], v1, s[8:11], s40 offen offset:3072 sc1
s_add_u32 s40, s46, 8192
buffer_load_dwordx4 v[56:59], v1, s[8:11], s40 offen offset:0 sc1
s_add_u32 s40, s46, 8192
buffer_load_dwordx4 v[60:63], v1, s[8:11], s40 offen offset:1024 sc1
s_add_u32 s40, s46, 8192
buffer_load_dwordx4 v[64:67], v1, s[8:11], s40 offen offset:2048 sc1
s_waitcnt vmcnt(0)
v_max3_u32 v6, v48, v49, v50
v_max3_u32 v6, v6, v51, v52
v_max3_u32 v6, v6, v53, v54
v_max3_u32 v6, v6, v55, v56
v_max3_u32 v6, v6, v57, v58
v_max3_u32 v6, v6, v59, v60
v_max3_u32 v6, v6, v61, v62
v_max3_u32 v6, v6, v63, v64
v_max3_u32 v6, v6, v65, v66
v_max_u32 v6, v6, v67
v_cmp_eq_u32 vcc, -1, v6
s_sub_u32 s39, s39, 1
s_cbranch_scc1 RB_42
s_cbranch_vccnz RL_43
s_branch RB_42
RT_44:
s_mov_b32 s39, 20000
RL_46:
s_add_u32 s40, s46, 4096
buffer_load_dwordx4 v[52:55], v1, s[8:11], s40 offen offset:3072 sc1
s_add_u32 s40, s46, 8192
buffer_load_dwordx4 v[56:59], v1, s[8:11], s40 offen offset:0 sc1
s_add_u32 s40, s46, 8192
buffer_load_dwordx4 v[60:63], v1, s[8:11], s40 offen offset:1024 sc1
s_add_u32 s40, s46, 8192
buffer_load_dwordx4 v[64:67], v1, s[8:11], s40 offen offset:2048 sc1
s_add_u32 s40, s46, 8192
buffer_load_dwordx4 v[68:71], v1, s[8:11], s40 offen offset:3072 sc1
s_waitcnt vmcnt(0)
v_max3_u32 v6, v52, v53, v54
v_max3_u32 v6, v6, v55, v56
v_max3_u32 v6, v6, v57, v58
v_max3_u32 v6, v6, v59, v60
v_max3_u32 v6, v6, v61, v62
v_max3_u32 v6, v6, v63, v64
v_max3_u32 v6, v6, v65, v66
v_max3_u32 v6, v6, v67, v68
v_max3_u32 v6, v6, v69, v70
v_max_u32 v6, v6, v71
v_cmp_eq_u32 vcc, -1, v6
s_sub_u32 s39, s39, 1
s_cbranch_scc1 RB_45
s_cbranch_vccnz RL_46
s_branch RB_45
RT_47:
s_mov_b32 s39, 20000
RL_49:
s_add_u32 s40, s46, 8192
buffer_load_dwordx4 v[56:59], v1, s[8:11], s40 offen offset:0 sc1
s_add_u32 s40, s46, 8192
buffer_load_dwordx4 v[60:63], v1, s[8:11], s40 offen offset:1024 sc1
s_add_u32 s40, s46, 8192
buffer_load_dwordx4 v[64:67], v1, s[8:11], s40 offen offset:2048 sc1
s_add_u32 s40, s46, 8192
buffer_load_dwordx4 v[68:71], v1, s[8:11], s40 offen offset:3072 sc1
s_add_u32 s40, s46, 12288
buffer_load_dwordx4 v[72:75], v1, s[8:11], s40 offen offset:0 sc1
s_waitcnt vmcnt(0)
v_max3_u32 v6, v56, v57, v58
v_max3_u32 v6, v6, v59, v60
v_max3_u32 v6, v6, v61, v62
v_max3_u32 v6, v6, v63, v64
v_max3_u32 v6, v6, v65, v66
v_max3_u32 v6, v6, v67, v68
v_max3_u32 v6, v6, v69, v70
v_max3_u32 v6, v6, v71, v72
v_max3_u32 v6, v6, v73, v74
v_max_u32 v6, v6, v75
v_cmp_eq_u32 vcc, -1, v6
s_sub_u32 s39, s39, 1
s_cbranch_scc1 RB_48
s_cbranch_vccnz RL_49
s_branch RB_48
RT_50:
s_mov_b32 s39, 20000
RL_52:
s_add_u32 s40, s46, 8192
buffer_load_dwordx4 v[60:63], v1, s[8:11], s40 offen offset:1024 sc1
s_add_u32 s40, s46, 8192
buffer_load_dwordx4 v[64:67], v1, s[8:11], s40 offen offset:2048 sc1
s_add_u32 s40, s46, 8192
buffer_load_dwordx4 v[68:71], v1, s[8:11], s40 offen offset:3072 sc1
s_add_u32 s40, s46, 12288
buffer_load_dwordx4 v[72:75], v1, s[8:11], s40 offen offset:0 sc1
s_add_u32 s40, s46, 12288
buffer_load_dwordx4 v[76:79], v1, s[8:11], s40 offen offset:1024 sc1
s_waitcnt vmcnt(0)
v_max3_u32 v6, v60, v61, v62
v_max3_u32 v6, v6, v63, v64
v_max3_u32 v6, v6, v65, v66
v_max3_u32 v6, v6, v67, v68
v_max3_u32 v6, v6, v69, v70
v_max3_u32 v6, v6, v71, v72
v_max3_u32 v6, v6, v73, v74
v_max3_u32 v6, v6, v75, v76
v_max3_u32 v6, v6, v77, v78
v_max_u32 v6, v6, v79
v_cmp_eq_u32 vcc, -1, v6
s_sub_u32 s39, s39, 1
s_cbranch_scc1 RB_51
s_cbranch_vccnz RL_52
s_branch RB_51
RT_53:
s_mov_b32 s39, 20000
RL_55:
s_add_u32 s40, s46, 8192
buffer_load_dwordx4 v[64:67], v1, s[8:11], s40 offen offset:2048 sc1
s_add_u32 s40, s46, 8192
buffer_load_dwordx4 v[68:71], v1, s[8:11], s40 offen offset:3072 sc1
s_add_u32 s40, s46, 12288
buffer_load_dwordx4 v[72:75], v1, s[8:11], s40 offen offset:0 sc1
s_add_u32 s40, s46, 12288
buffer_load_dwordx4 v[76:79], v1, s[8:11], s40 offen offset:1024 sc1
s_add_u32 s40, s46, 12288
buffer_load_dwordx4 v[80:83], v1, s[8:11], s40 offen offset:2048 sc1
s_waitcnt vmcnt(0)
v_max3_u32 v6, v64, v65, v66
v_max3_u32 v6, v6, v67, v68
v_max3_u32 v6, v6, v69, v70
v_max3_u32 v6, v6, v71, v72
v_max3_u32 v6, v6, v73, v74
v_max3_u32 v6, v6, v75, v76
v_max3_u32 v6, v6, v77, v78
v_max3_u32 v6, v6, v79, v80
v_max3_u32 v6, v6, v81, v82
v_max_u32 v6, v6, v83
v_cmp_eq_u32 vcc, -1, v6
s_sub_u32 s39, s39, 1
s_cbranch_scc1 RB_54
s_cbranch_vccnz RL_55
s_branch RB_54
RT_56:
s_mov_b32 s39, 20000
RL_58:
s_add_u32 s40, s46, 8192
buffer_load_dwordx4 v[68:71], v1, s[8:11], s40 offen offset:3072 sc1
s_add_u32 s40, s46, 12288
buffer_load_dwordx4 v[72:75], v1, s[8:11], s40 offen offset:0 sc1
s_add_u32 s40, s46, 12288
buffer_load_dwordx4 v[76:79], v1, s[8:11], s40 offen offset:1024 sc1
s_add_u32 s40, s46, 12288
buffer_load_dwordx4 v[80:83], v1, s[8:11], s40 offen offset:2048 sc1
s_add_u32 s40, s46, 12288
buffer_load_dwordx4 v[84:87], v1, s[8:11], s40 offen offset:3072 sc1
s_waitcnt vmcnt(0)
v_max3_u32 v6, v68, v69, v70
v_max3_u32 v6, v6, v71, v72
v_max3_u32 v6, v6, v73, v74
v_max3_u32 v6, v6, v75, v76
v_max3_u32 v6, v6, v77, v78
v_max3_u32 v6, v6, v79, v80
v_max3_u32 v6, v6, v81, v82
v_max3_u32 v6, v6, v83, v84
v_max3_u32 v6, v6, v85, v86
v_max_u32 v6, v6, v87
v_cmp_eq_u32 vcc, -1, v6
s_sub_u32 s39, s39, 1
s_cbranch_scc1 RB_57
s_cbranch_vccnz RL_58
s_branch RB_57
RT_61:
s_mov_b32 s39, 20000
RL_63:
s_add_u32 s40, s46, 12288
buffer_load_dwordx4 v[72:75], v1, s[8:11], s40 offen offset:0 sc1
s_add_u32 s40, s46, 12288
buffer_load_dwordx4 v[76:79], v1, s[8:11], s40 offen offset:1024 sc1
s_add_u32 s40, s46, 12288
buffer_load_dwordx4 v[80:83], v1, s[8:11], s40 offen offset:2048 sc1
s_add_u32 s40, s46, 12288
buffer_load_dwordx4 v[84:87], v1, s[8:11], s40 offen offset:3072 sc1
s_waitcnt vmcnt(0)
v_max3_u32 v6, v72, v73, v74
v_max3_u32 v6, v6, v75, v76
v_max3_u32 v6, v6, v77, v78
v_max3_u32 v6, v6, v79, v80
v_max3_u32 v6, v6, v81, v82
v_max3_u32 v6, v6, v83, v84
v_max3_u32 v6, v6, v85, v86
v_max_u32 v6, v6, v87
v_cmp_eq_u32 vcc, -1, v6
s_sub_u32 s39, s39, 1
s_cbranch_scc1 RB_62
s_cbranch_vccnz RL_63
s_branch RB_62
HS_64:
buffer_store_dwordx4 v[220:223], v1, s[8:11], s41 offen sc1
s_mov_b64 exec, 0xffff
buffer_store_dwordx2 v[220:221], v202, s[8:11], s42 offen sc1
s_mov_b64 exec, -1
s_branch HJ_65
RT_66:
s_mov_b32 s39, 20000
RL_68:
s_add_u32 s40, s46, 12288
buffer_load_dwordx4 v[76:79], v1, s[8:11], s40 offen offset:1024 sc1
s_add_u32 s40, s46, 12288
buffer_load_dwordx4 v[80:83], v1, s[8:11], s40 offen offset:2048 sc1
s_add_u32 s40, s46, 12288
buffer_load_dwordx4 v[84:87], v1, s[8:11], s40 offen offset:3072 sc1
s_waitcnt vmcnt(0)
v_max3_u32 v6, v76, v77, v78
v_max3_u32 v6, v6, v79, v80
v_max3_u32 v6, v6, v81, v82
v_max3_u32 v6, v6, v83, v84
v_max3_u32 v6, v6, v85, v86
v_max_u32 v6, v6, v87
v_cmp_eq_u32 vcc, -1, v6
s_sub_u32 s39, s39, 1
s_cbranch_scc1 RB_67
s_cbranch_vccnz RL_68
s_branch RB_67
RT_69:
s_mov_b32 s39, 20000
RL_71:
s_add_u32 s40, s46, 12288
buffer_load_dwordx4 v[80:83], v1, s[8:11], s40 offen offset:2048 sc1
s_add_u32 s40, s46, 12288
buffer_load_dwordx4 v[84:87], v1, s[8:11], s40 offen offset:3072 sc1
s_waitcnt vmcnt(0)
v_max3_u32 v6, v80, v81, v82
v_max3_u32 v6, v6, v83, v84
v_max3_u32 v6, v6, v85, v86
v_max_u32 v6, v6, v87
v_cmp_eq_u32 vcc, -1, v6
s_sub_u32 s39, s39, 1
s_cbranch_scc1 RB_70
s_cbranch_vccnz RL_71
s_branch RB_70
RT_72:
s_mov_b32 s39, 20000
RL_74:
s_add_u32 s40, s46, 12288
buffer_load_dwordx4 v[84:87], v1, s[8:11], s40 offen offset:3072 sc1
s_waitcnt vmcnt(0)
v_max3_u32 v6, v84, v85, v86
v_max_u32 v6, v6, v87
v_cmp_eq_u32 vcc, -1, v6
s_sub_u32 s39, s39, 1
s_cbranch_scc1 RB_73
s_cbranch_vccnz RL_74
s_branch RB_73
RT_78:
s_mov_b32 s39, 20000
RL_80:
s_add_u32 s40, s46, 16384
buffer_load_dwordx4 v[88:91], v1, s[8:11], s40 offen offset:2048 sc1
s_add_u32 s40, s46, 16384
buffer_load_dwordx4 v[92:95], v1, s[8:11], s40 offen offset:3072 sc1
s_waitcnt vmcnt(0)
v_max3_u32 v6, v88, v89, v90
v_max3_u32 v6, v6, v91, v92
v_max3_u32 v6, v6, v93, v94
v_max_u32 v6, v6, v95
v_cmp_eq_u32 vcc, -1, v6
s_sub_u32 s39, s39, 1
s_cbranch_scc1 RB_79
s_cbranch_vccnz RL_80
s_branch RB_79
ST_76:
s_branch RT_78
RB_79:
v_add_f32 v250, v88, v90
v_add_f32 v251, v89, v91
v_add_f32 v250, v250, v92
v_add_f32 v251, v251, v93
v_add_f32 v250, v250, v94
v_add_f32 v251, v251, v95
v_mov_b32 v5, v250
s_nop 1
v_permlane16_swap_b32 v250, v5
s_nop 0
v_add_f32 v250, v250, v5
v_mov_b32 v5, v250
s_nop 1
v_permlane32_swap_b32 v250, v5
s_nop 0
v_add_f32 v250, v250, v5
v_mov_b32 v5, v251
s_nop 1
v_permlane16_swap_b32 v251, v5
s_nop 0
v_add_f32 v251, v251, v5
v_mov_b32 v5, v251
s_nop 1
v_permlane32_swap_b32 v251, v5
s_nop 0
v_add_f32 v251, v251, v5
v_mul_f32 v250, 0x3ae38e39, v250
v_mul_f32 v251, 0x3ae38e39, v251
v_fma_f32 v251, -v250, v250, v251
v_max_f32 v251, 0, v251
v_add_f32 v251, 0x3727c5ac, v251
v_rsq_f32 v251, v251
s_branch SB_77
RT_84:
s_mov_b32 s39, 20000
RL_86:
buffer_load_dwordx4 v[96:99], v1, s[8:11], s48 offen offset:0 sc1
buffer_load_dwordx4 v[100:103], v1, s[8:11], s48 offen offset:1024 sc1
buffer_load_dwordx4 v[104:107], v1, s[8:11], s48 offen offset:2048 sc1
buffer_load_dwordx4 v[108:111], v1, s[8:11], s48 offen offset:3072 sc1
buffer_load_dwordx4 v[112:115], v1, s[8:11], s49 offen offset:0 sc1
s_waitcnt vmcnt(0)
v_max3_u32 v6, v96, v97, v98
v_max3_u32 v6, v6, v99, v100
v_max3_u32 v6, v6, v101, v102
v_max3_u32 v6, v6, v103, v104
v_max3_u32 v6, v6, v105, v106
v_max3_u32 v6, v6, v107, v108
v_max3_u32 v6, v6, v109, v110
v_max3_u32 v6, v6, v111, v112
v_max3_u32 v6, v6, v113, v114
v_max_u32 v6, v6, v115
v_cmp_eq_u32 vcc, -1, v6
s_sub_u32 s39, s39, 1
s_cbranch_scc1 RB_85
s_cbranch_vccnz RL_86
s_branch RB_85
RT_93:
s_mov_b32 s39, 20000
RL_95:
s_add_u32 s41, s47, 16384
buffer_load_dwordx4 v[96:99], v1, s[8:11], s41 offen offset:2048 sc1
s_add_u32 s41, s47, 16384
buffer_load_dwordx4 v[100:103], v1, s[8:11], s41 offen offset:3072 sc1
s_waitcnt vmcnt(0)
v_max3_u32 v6, v96, v97, v98
v_max3_u32 v6, v6, v99, v100
v_max3_u32 v6, v6, v101, v102
v_max_u32 v6, v6, v103
v_cmp_eq_u32 vcc, -1, v6
s_sub_u32 s39, s39, 1
s_cbranch_scc1 RB_94
s_cbranch_vccnz RL_95
s_branch RB_94
HS_101:
buffer_store_dwordx4 v[152:155], v218, s[8:11], s53 offen sc1
buffer_store_dwordx4 v[156:159], v218, s[8:11], s53 offen offset:256 sc1
buffer_store_dword v160, v219, s[8:11], s54 offen sc1
s_branch HJ_102
RT_110:
s_mov_b32 s39, 20000
RL_112:
buffer_load_dwordx4 v[16:19], v1, s[8:11], s43 offen offset:0 sc1
buffer_load_dwordx4 v[20:23], v1, s[8:11], s44 offen offset:0 sc1
buffer_load_dwordx4 v[24:27], v1, s[8:11], s44 offen offset:1024 sc1
buffer_load_dwordx4 v[28:31], v1, s[8:11], s44 offen offset:2048 sc1
buffer_load_dwordx4 v[32:35], v1, s[8:11], s44 offen offset:3072 sc1
s_waitcnt vmcnt(0)
v_max3_u32 v6, v16, v17, v18
v_max3_u32 v6, v6, v19, v20
v_max3_u32 v6, v6, v21, v22
v_max3_u32 v6, v6, v23, v24
v_max3_u32 v6, v6, v25, v26
v_max3_u32 v6, v6, v27, v28
v_max3_u32 v6, v6, v29, v30
v_max3_u32 v6, v6, v31, v32
v_max3_u32 v6, v6, v33, v34
v_max_u32 v6, v6, v35
v_cmp_eq_u32 vcc, -1, v6
s_sub_u32 s39, s39, 1
s_cbranch_scc1 RB_111
s_cbranch_vccnz RL_112
s_branch RB_111
RT_113:
s_mov_b32 s39, 20000
RL_115:
buffer_load_dwordx4 v[20:23], v1, s[8:11], s44 offen offset:0 sc1
buffer_load_dwordx4 v[24:27], v1, s[8:11], s44 offen offset:1024 sc1
buffer_load_dwordx4 v[28:31], v1, s[8:11], s44 offen offset:2048 sc1
buffer_load_dwordx4 v[32:35], v1, s[8:11], s44 offen offset:3072 sc1
s_add_u32 s40, s44, 4096
buffer_load_dwordx4 v[36:39], v1, s[8:11], s40 offen offset:0 sc1
s_waitcnt vmcnt(0)
v_max3_u32 v6, v20, v21, v22
v_max3_u32 v6, v6, v23, v24
v_max3_u32 v6, v6, v25, v26
v_max3_u32 v6, v6, v27, v28
v_max3_u32 v6, v6, v29, v30
v_max3_u32 v6, v6, v31, v32
v_max3_u32 v6, v6, v33, v34
v_max3_u32 v6, v6, v35, v36
v_max3_u32 v6, v6, v37, v38
v_max_u32 v6, v6, v39
v_cmp_eq_u32 vcc, -1, v6
s_sub_u32 s39, s39, 1
s_cbranch_scc1 RB_114
s_cbranch_vccnz RL_115
s_branch RB_114
RT_116:
s_mov_b32 s39, 20000
RL_118:
buffer_load_dwordx4 v[24:27], v1, s[8:11], s44 offen offset:1024 sc1
buffer_load_dwordx4 v[28:31], v1, s[8:11], s44 offen offset:2048 sc1
buffer_load_dwordx4 v[32:35], v1, s[8:11], s44 offen offset:3072 sc1
s_add_u32 s40, s44, 4096
buffer_load_dwordx4 v[36:39], v1, s[8:11], s40 offen offset:0 sc1
s_add_u32 s40, s44, 4096
buffer_load_dwordx4 v[40:43], v1, s[8:11], s40 offen offset:1024 sc1
s_waitcnt vmcnt(0)
v_max3_u32 v6, v24, v25, v26
v_max3_u32 v6, v6, v27, v28
v_max3_u32 v6, v6, v29, v30
v_max3_u32 v6, v6, v31, v32
v_max3_u32 v6, v6, v33, v34
v_max3_u32 v6, v6, v35, v36
v_max3_u32 v6, v6, v37, v38
v_max3_u32 v6, v6, v39, v40
v_max3_u32 v6, v6, v41, v42
v_max_u32 v6, v6, v43
v_cmp_eq_u32 vcc, -1, v6
s_sub_u32 s39, s39, 1
s_cbranch_scc1 RB_117
s_cbranch_vccnz RL_118
s_branch RB_117
RT_119:
s_mov_b32 s39, 20000
RL_121:
buffer_load_dwordx4 v[28:31], v1, s[8:11], s44 offen offset:2048 sc1
buffer_load_dwordx4 v[32:35], v1, s[8:11], s44 offen offset:3072 sc1
s_add_u32 s40, s44, 4096
buffer_load_dwordx4 v[36:39], v1, s[8:11], s40 offen offset:0 sc1
s_add_u32 s40, s44, 4096
buffer_load_dwordx4 v[40:43], v1, s[8:11], s40 offen offset:1024 sc1
s_add_u32 s40, s44, 4096
buffer_load_dwordx4 v[44:47], v1, s[8:11], s40 offen offset:2048 sc1
s_waitcnt vmcnt(0)
v_max3_u32 v6, v28, v29, v30
v_max3_u32 v6, v6, v31, v32
v_max3_u32 v6, v6, v33, v34
v_max3_u32 v6, v6, v35, v36
v_max3_u32 v6, v6, v37, v38
v_max3_u32 v6, v6, v39, v40
v_max3_u32 v6, v6, v41, v42
v_max3_u32 v6, v6, v43, v44
v_max3_u32 v6, v6, v45, v46
v_max_u32 v6, v6, v47
v_cmp_eq_u32 vcc, -1, v6
s_sub_u32 s39, s39, 1
s_cbranch_scc1 RB_120
s_cbranch_vccnz RL_121
s_branch RB_120
HS_123:
buffer_store_dwordx4 v[228:231], v1, s[8:11], s46 offen sc1
s_mov_b64 exec, s[72:73]
buffer_store_dwordx2 v[228:229], v7, s[8:11], s47 offen sc1
s_mov_b64 exec, -1
s_mov_b64 exec, s[82:83]
buffer_store_dwordx2 v[228:229], v202, s[8:11], s48 offen sc1
s_mov_b64 exec, -1
s_branch HJ_124
RT_125:
s_mov_b32 s39, 20000
RL_127:
buffer_load_dwordx4 v[32:35], v1, s[8:11], s44 offen offset:3072 sc1
s_add_u32 s40, s44, 4096
buffer_load_dwordx4 v[36:39], v1, s[8:11], s40 offen offset:0 sc1
s_add_u32 s40, s44, 4096
buffer_load_dwordx4 v[40:43], v1, s[8:11], s40 offen offset:1024 sc1
s_add_u32 s40, s44, 4096
buffer_load_dwordx4 v[44:47], v1, s[8:11], s40 offen offset:2048 sc1
s_add_u32 s40, s44, 4096
buffer_load_dwordx4 v[48:51], v1, s[8:11], s40 offen offset:3072 sc1
s_waitcnt vmcnt(0)
v_max3_u32 v6, v32, v33, v34
v_max3_u32 v6, v6, v35, v36
v_max3_u32 v6, v6, v37, v38
v_max3_u32 v6, v6, v39, v40
v_max3_u32 v6, v6, v41, v42
v_max3_u32 v6, v6, v43, v44
v_max3_u32 v6, v6, v45, v46
v_max3_u32 v6, v6, v47, v48
v_max3_u32 v6, v6, v49, v50
v_max_u32 v6, v6, v51
v_cmp_eq_u32 vcc, -1, v6
s_sub_u32 s39, s39, 1
s_cbranch_scc1 RB_126
s_cbranch_vccnz RL_127
s_branch RB_126
RT_129:
s_mov_b32 s39, 20000
RL_131:
s_add_u32 s40, s44, 4096
buffer_load_dwordx4 v[36:39], v1, s[8:11], s40 offen offset:0 sc1
s_add_u32 s40, s44, 4096
buffer_load_dwordx4 v[40:43], v1, s[8:11], s40 offen offset:1024 sc1
s_add_u32 s40, s44, 4096
buffer_load_dwordx4 v[44:47], v1, s[8:11], s40 offen offset:2048 sc1
s_add_u32 s40, s44, 4096
buffer_load_dwordx4 v[48:51], v1, s[8:11], s40 offen offset:3072 sc1
s_waitcnt vmcnt(0)
v_max3_u32 v6, v36, v37, v38
v_max3_u32 v6, v6, v39, v40
v_max3_u32 v6, v6, v41, v42
v_max3_u32 v6, v6, v43, v44
v_max3_u32 v6, v6, v45, v46
v_max3_u32 v6, v6, v47, v48
v_max3_u32 v6, v6, v49, v50
v_max_u32 v6, v6, v51
v_cmp_eq_u32 vcc, -1, v6
s_sub_u32 s39, s39, 1
s_cbranch_scc1 RB_130
s_cbranch_vccnz RL_131
s_branch RB_130
RT_133:
s_mov_b32 s39, 20000
RL_135:
s_add_u32 s40, s44, 4096
buffer_load_dwordx4 v[40:43], v1, s[8:11], s40 offen offset:1024 sc1
s_add_u32 s40, s44, 4096
buffer_load_dwordx4 v[44:47], v1, s[8:11], s40 offen offset:2048 sc1
s_add_u32 s40, s44, 4096
buffer_load_dwordx4 v[48:51], v1, s[8:11], s40 offen offset:3072 sc1
s_waitcnt vmcnt(0)
v_max3_u32 v6, v40, v41, v42
v_max3_u32 v6, v6, v43, v44
v_max3_u32 v6, v6, v45, v46
v_max3_u32 v6, v6, v47, v48
v_max3_u32 v6, v6, v49, v50
v_max_u32 v6, v6, v51
v_cmp_eq_u32 vcc, -1, v6
s_sub_u32 s39, s39, 1
s_cbranch_scc1 RB_134
s_cbranch_vccnz RL_135
s_branch RB_134
RT_136:
s_mov_b32 s39, 20000
RL_138:
s_add_u32 s40, s44, 4096
buffer_load_dwordx4 v[44:47], v1, s[8:11], s40 offen offset:2048 sc1
s_add_u32 s40, s44, 4096
buffer_load_dwordx4 v[48:51], v1, s[8:11], s40 offen offset:3072 sc1
s_waitcnt vmcnt(0)
v_max3_u32 v6, v44, v45, v46
v_max3_u32 v6, v6, v47, v48
v_max3_u32 v6, v6, v49, v50
v_max_u32 v6, v6, v51
v_cmp_eq_u32 vcc, -1, v6
s_sub_u32 s39, s39, 1
s_cbranch_scc1 RB_137
s_cbranch_vccnz RL_138
s_branch RB_137
RT_140:
s_mov_b32 s39, 20000
RL_142:
s_add_u32 s40, s44, 4096
buffer_load_dwordx4 v[48:51], v1, s[8:11], s40 offen offset:3072 sc1
s_waitcnt vmcnt(0)
v_max3_u32 v6, v48, v49, v50
v_max_u32 v6, v6, v51
v_cmp_eq_u32 vcc, -1, v6
s_sub_u32 s39, s39, 1
s_cbranch_scc1 RB_141
s_cbranch_vccnz RL_142
s_branch RB_141
HS_148:
buffer_store_dwordx4 v[8:11], v1, s[8:11], s46 offen sc1
v_cndmask_b32_e64 v50, 0, v12, s[72:73]
v_cndmask_b32_e64 v51, 0, v13, s[72:73]
v_mov_b32 v52, 0
v_mov_b32 v53, 0
v_mfma_f32_16x16x32_bf16 v[56:59], v[236:239], v[8:11], 0
v_mfma_f32_16x16x32_bf16 v[60:63], v[8:11], v[8:11], 0
s_mov_b64 exec, s[72:73]
buffer_store_dwordx2 v[12:13], v7, s[8:11], s47 offen sc1
s_mov_b64 exec, -1
v_mfma_f32_16x16x32_bf16 v[56:59], v[236:239], v[50:53], v[56:59]
v_mfma_f32_16x16x32_bf16 v[60:63], v[50:53], v[50:53], v[60:63]
s_nop 7
v_cndmask_b32_e64 v60, v60, v61, s[76:77]
v_cndmask_b32_e64 v60, v60, v62, s[78:79]
v_cndmask_b32_e64 v57, v60, v63, s[80:81]
s_mov_b64 exec, s[82:83]
buffer_store_dwordx2 v[56:57], v202, s[8:11], s48 offen sc1
s_mov_b64 exec, -1
s_branch HJ_149
RT_152:
s_mov_b32 s39, 20000
RL_154:
s_add_u32 s40, s46, 16384
buffer_load_dwordx4 v[16:19], v1, s[8:11], s40 offen offset:0 sc1
s_add_u32 s40, s46, 16384
buffer_load_dwordx4 v[20:23], v1, s[8:11], s40 offen offset:1024 sc1
buffer_load_dwordx4 v[24:27], v1, s[8:11], s46 offen offset:0 sc1
buffer_load_dwordx4 v[28:31], v1, s[8:11], s46 offen offset:1024 sc1
buffer_load_dwordx4 v[32:35], v1, s[8:11], s46 offen offset:2048 sc1
s_waitcnt vmcnt(0)
v_max3_u32 v6, v16, v17, v18
v_max3_u32 v6, v6, v19, v20
v_max3_u32 v6, v6, v21, v22
v_max3_u32 v6, v6, v23, v24
v_max3_u32 v6, v6, v25, v26
v_max3_u32 v6, v6, v27, v28
v_max3_u32 v6, v6, v29, v30
v_max3_u32 v6, v6, v31, v32
v_max3_u32 v6, v6, v33, v34
v_max_u32 v6, v6, v35
v_cmp_eq_u32 vcc, -1, v6
s_sub_u32 s39, s39, 1
s_cbranch_scc1 RB_153
s_cbranch_vccnz RL_154
s_branch RB_153
RT_155:
s_mov_b32 s39, 20000
RL_157:
s_add_u32 s40, s46, 16384
buffer_load_dwordx4 v[20:23], v1, s[8:11], s40 offen offset:1024 sc1
buffer_load_dwordx4 v[24:27], v1, s[8:11], s46 offen offset:0 sc1
buffer_load_dwordx4 v[28:31], v1, s[8:11], s46 offen offset:1024 sc1
buffer_load_dwordx4 v[32:35], v1, s[8:11], s46 offen offset:2048 sc1
buffer_load_dwordx4 v[36:39], v1, s[8:11], s46 offen offset:3072 sc1
s_waitcnt vmcnt(0)
v_max3_u32 v6, v20, v21, v22
v_max3_u32 v6, v6, v23, v24
v_max3_u32 v6, v6, v25, v26
v_max3_u32 v6, v6, v27, v28
v_max3_u32 v6, v6, v29, v30
v_max3_u32 v6, v6, v31, v32
v_max3_u32 v6, v6, v33, v34
v_max3_u32 v6, v6, v35, v36
v_max3_u32 v6, v6, v37, v38
v_max_u32 v6, v6, v39
v_cmp_eq_u32 vcc, -1, v6
s_sub_u32 s39, s39, 1
s_cbranch_scc1 RB_156
s_cbranch_vccnz RL_157
s_branch RB_156
RT_158:
s_mov_b32 s39, 20000
RL_160:
buffer_load_dwordx4 v[24:27], v1, s[8:11], s46 offen offset:0 sc1
buffer_load_dwordx4 v[28:31], v1, s[8:11], s46 offen offset:1024 sc1
buffer_load_dwordx4 v[32:35], v1, s[8:11], s46 offen offset:2048 sc1
buffer_load_dwordx4 v[36:39], v1, s[8:11], s46 offen offset:3072 sc1
s_add_u32 s40, s46, 4096
buffer_load_dwordx4 v[40:43], v1, s[8:11], s40 offen offset:0 sc1
s_waitcnt vmcnt(0)
v_max3_u32 v6, v24, v25, v26
v_max3_u32 v6, v6, v27, v28
v_max3_u32 v6, v6, v29, v30
v_max3_u32 v6, v6, v31, v32
v_max3_u32 v6, v6, v33, v34
v_max3_u32 v6, v6, v35, v36
v_max3_u32 v6, v6, v37, v38
v_max3_u32 v6, v6, v39, v40
v_max3_u32 v6, v6, v41, v42
v_max_u32 v6, v6, v43
v_cmp_eq_u32 vcc, -1, v6
s_sub_u32 s39, s39, 1
s_cbranch_scc1 RB_159
s_cbranch_vccnz RL_160
s_branch RB_159
RT_161:
s_mov_b32 s39, 20000
RL_163:
buffer_load_dwordx4 v[28:31], v1, s[8:11], s46 offen offset:1024 sc1
buffer_load_dwordx4 v[32:35], v1, s[8:11], s46 offen offset:2048 sc1
buffer_load_dwordx4 v[36:39], v1, s[8:11], s46 offen offset:3072 sc1
s_add_u32 s40, s46, 4096
buffer_load_dwordx4 v[40:43], v1, s[8:11], s40 offen offset:0 sc1
s_add_u32 s40, s46, 4096
buffer_load_dwordx4 v[44:47], v1, s[8:11], s40 offen offset:1024 sc1
s_waitcnt vmcnt(0)
v_max3_u32 v6, v28, v29, v30
v_max3_u32 v6, v6, v31, v32
v_max3_u32 v6, v6, v33, v34
v_max3_u32 v6, v6, v35, v36
v_max3_u32 v6, v6, v37, v38
v_max3_u32 v6, v6, v39, v40
v_max3_u32 v6, v6, v41, v42
v_max3_u32 v6, v6, v43, v44
v_max3_u32 v6, v6, v45, v46
v_max_u32 v6, v6, v47
v_cmp_eq_u32 vcc, -1, v6
s_sub_u32 s39, s39, 1
s_cbranch_scc1 RB_162
s_cbranch_vccnz RL_163
s_branch RB_162
RT_164:
s_mov_b32 s39, 20000
RL_166:
buffer_load_dwordx4 v[32:35], v1, s[8:11], s46 offen offset:2048 sc1
buffer_load_dwordx4 v[36:39], v1, s[8:11], s46 offen offset:3072 sc1
s_add_u32 s40, s46, 4096
buffer_load_dwordx4 v[40:43], v1, s[8:11], s40 offen offset:0 sc1
s_add_u32 s40, s46, 4096
buffer_load_dwordx4 v[44:47], v1, s[8:11], s40 offen offset:1024 sc1
s_add_u32 s40, s46, 4096
buffer_load_dwordx4 v[48:51], v1, s[8:11], s40 offen offset:2048 sc1
s_waitcnt vmcnt(0)
v_max3_u32 v6, v32, v33, v34
v_max3_u32 v6, v6, v35, v36
v_max3_u32 v6, v6, v37, v38
v_max3_u32 v6, v6, v39, v40
v_max3_u32 v6, v6, v41, v42
v_max3_u32 v6, v6, v43, v44
v_max3_u32 v6, v6, v45, v46
v_max3_u32 v6, v6, v47, v48
v_max3_u32 v6, v6, v49, v50
v_max_u32 v6, v6, v51
v_cmp_eq_u32 vcc, -1, v6
s_sub_u32 s39, s39, 1
s_cbranch_scc1 RB_165
s_cbranch_vccnz RL_166
s_branch RB_165
RT_167:
s_mov_b32 s39, 20000
RL_169:
buffer_load_dwordx4 v[36:39], v1, s[8:11], s46 offen offset:3072 sc1
s_add_u32 s40, s46, 4096
buffer_load_dwordx4 v[40:43], v1, s[8:11], s40 offen offset:0 sc1
s_add_u32 s40, s46, 4096
buffer_load_dwordx4 v[44:47], v1, s[8:11], s40 offen offset:1024 sc1
s_add_u32 s40, s46, 4096
buffer_load_dwordx4 v[48:51], v1, s[8:11], s40 offen offset:2048 sc1
s_add_u32 s40, s46, 4096
buffer_load_dwordx4 v[52:55], v1, s[8:11], s40 offen offset:3072 sc1
s_waitcnt vmcnt(0)
v_max3_u32 v6, v36, v37, v38
v_max3_u32 v6, v6, v39, v40
v_max3_u32 v6, v6, v41, v42
v_max3_u32 v6, v6, v43, v44
v_max3_u32 v6, v6, v45, v46
v_max3_u32 v6, v6, v47, v48
v_max3_u32 v6, v6, v49, v50
v_max3_u32 v6, v6, v51, v52
v_max3_u32 v6, v6, v53, v54
v_max_u32 v6, v6, v55
v_cmp_eq_u32 vcc, -1, v6
s_sub_u32 s39, s39, 1
s_cbranch_scc1 RB_168
s_cbranch_vccnz RL_169
s_branch RB_168
RT_170:
s_mov_b32 s39, 20000
RL_172:
s_add_u32 s40, s46, 4096
buffer_load_dwordx4 v[40:43], v1, s[8:11], s40 offen offset:0 sc1
s_add_u32 s40, s46, 4096
buffer_load_dwordx4 v[44:47], v1, s[8:11], s40 offen offset:1024 sc1
s_add_u32 s40, s46, 4096
buffer_load_dwordx4 v[48:51], v1, s[8:11], s40 offen offset:2048 sc1
s_add_u32 s40, s46, 4096
buffer_load_dwordx4 v[52:55], v1, s[8:11], s40 offen offset:3072 sc1
s_add_u32 s40, s46, 8192
buffer_load_dwordx4 v[56:59], v1, s[8:11], s40 offen offset:0 sc1
s_waitcnt vmcnt(0)
v_max3_u32 v6, v40, v41, v42
v_max3_u32 v6, v6, v43, v44
v_max3_u32 v6, v6, v45, v46
v_max3_u32 v6, v6, v47, v48
v_max3_u32 v6, v6, v49, v50
v_max3_u32 v6, v6, v51, v52
v_max3_u32 v6, v6, v53, v54
v_max3_u32 v6, v6, v55, v56
v_max3_u32 v6, v6, v57, v58
v_max_u32 v6, v6, v59
v_cmp_eq_u32 vcc, -1, v6
s_sub_u32 s39, s39, 1
s_cbranch_scc1 RB_171
s_cbranch_vccnz RL_172
s_branch RB_171
RT_173:
s_mov_b32 s39, 20000
RL_175:
s_add_u32 s40, s46, 4096
buffer_load_dwordx4 v[44:47], v1, s[8:11], s40 offen offset:1024 sc1
s_add_u32 s40, s46, 4096
buffer_load_dwordx4 v[48:51], v1, s[8:11], s40 offen offset:2048 sc1
s_add_u32 s40, s46, 4096
buffer_load_dwordx4 v[52:55], v1, s[8:11], s40 offen offset:3072 sc1
s_add_u32 s40, s46, 8192
buffer_load_dwordx4 v[56:59], v1, s[8:11], s40 offen offset:0 sc1
s_add_u32 s40, s46, 8192
buffer_load_dwordx4 v[60:63], v1, s[8:11], s40 offen offset:1024 sc1
s_waitcnt vmcnt(0)
v_max3_u32 v6, v44, v45, v46
v_max3_u32 v6, v6, v47, v48
v_max3_u32 v6, v6, v49, v50
v_max3_u32 v6, v6, v51, v52
v_max3_u32 v6, v6, v53, v54
v_max3_u32 v6, v6, v55, v56
v_max3_u32 v6, v6, v57, v58
v_max3_u32 v6, v6, v59, v60
v_max3_u32 v6, v6, v61, v62
v_max_u32 v6, v6, v63
v_cmp_eq_u32 vcc, -1, v6
s_sub_u32 s39, s39, 1
s_cbranch_scc1 RB_174
s_cbranch_vccnz RL_175
s_branch RB_174
RT_176:
s_mov_b32 s39, 20000
RL_178:
s_add_u32 s40, s46, 4096
buffer_load_dwordx4 v[48:51], v1, s[8:11], s40 offen offset:2048 sc1
s_add_u32 s40, s46, 4096
buffer_load_dwordx4 v[52:55], v1, s[8:11], s40 offen offset:3072 sc1
s_add_u32 s40, s46, 8192
buffer_load_dwordx4 v[56:59], v1, s[8:11], s40 offen offset:0 sc1
s_add_u32 s40, s46, 8192
buffer_load_dwordx4 v[60:63], v1, s[8:11], s40 offen offset:1024 sc1
s_add_u32 s40, s46, 8192
buffer_load_dwordx4 v[64:67], v1, s[8:11], s40 offen offset:2048 sc1
s_waitcnt vmcnt(0)
v_max3_u32 v6, v48, v49, v50
v_max3_u32 v6, v6, v51, v52
v_max3_u32 v6, v6, v53, v54
v_max3_u32 v6, v6, v55, v56
v_max3_u32 v6, v6, v57, v58
v_max3_u32 v6, v6, v59, v60
v_max3_u32 v6, v6, v61, v62
v_max3_u32 v6, v6, v63, v64
v_max3_u32 v6, v6, v65, v66
v_max_u32 v6, v6, v67
v_cmp_eq_u32 vcc, -1, v6
s_sub_u32 s39, s39, 1
s_cbranch_scc1 RB_177
s_cbranch_vccnz RL_178
s_branch RB_177
RT_179:
s_mov_b32 s39, 20000
RL_181:
s_add_u32 s40, s46, 4096
buffer_load_dwordx4 v[52:55], v1, s[8:11], s40 offen offset:3072 sc1
s_add_u32 s40, s46, 8192
buffer_load_dwordx4 v[56:59], v1, s[8:11], s40 offen offset:0 sc1
s_add_u32 s40, s46, 8192
buffer_load_dwordx4 v[60:63], v1, s[8:11], s40 offen offset:1024 sc1
s_add_u32 s40, s46, 8192
buffer_load_dwordx4 v[64:67], v1, s[8:11], s40 offen offset:2048 sc1
s_add_u32 s40, s46, 8192
buffer_load_dwordx4 v[68:71], v1, s[8:11], s40 offen offset:3072 sc1
s_waitcnt vmcnt(0)
v_max3_u32 v6, v52, v53, v54
v_max3_u32 v6, v6, v55, v56
v_max3_u32 v6, v6, v57, v58
v_max3_u32 v6, v6, v59, v60
v_max3_u32 v6, v6, v61, v62
v_max3_u32 v6, v6, v63, v64
v_max3_u32 v6, v6, v65, v66
v_max3_u32 v6, v6, v67, v68
v_max3_u32 v6, v6, v69, v70
v_max_u32 v6, v6, v71
v_cmp_eq_u32 vcc, -1, v6
s_sub_u32 s39, s39, 1
s_cbranch_scc1 RB_180
s_cbranch_vccnz RL_181
s_branch RB_180
RT_182:
s_mov_b32 s39, 20000
RL_184:
s_add_u32 s40, s46, 8192
buffer_load_dwordx4 v[56:59], v1, s[8:11], s40 offen offset:0 sc1
s_add_u32 s40, s46, 8192
buffer_load_dwordx4 v[60:63], v1, s[8:11], s40 offen offset:1024 sc1
s_add_u32 s40, s46, 8192
buffer_load_dwordx4 v[64:67], v1, s[8:11], s40 offen offset:2048 sc1
s_add_u32 s40, s46, 8192
buffer_load_dwordx4 v[68:71], v1, s[8:11], s40 offen offset:3072 sc1
s_add_u32 s40, s46, 12288
buffer_load_dwordx4 v[72:75], v1, s[8:11], s40 offen offset:0 sc1
s_waitcnt vmcnt(0)
v_max3_u32 v6, v56, v57, v58
v_max3_u32 v6, v6, v59, v60
v_max3_u32 v6, v6, v61, v62
v_max3_u32 v6, v6, v63, v64
v_max3_u32 v6, v6, v65, v66
v_max3_u32 v6, v6, v67, v68
v_max3_u32 v6, v6, v69, v70
v_max3_u32 v6, v6, v71, v72
v_max3_u32 v6, v6, v73, v74
v_max_u32 v6, v6, v75
v_cmp_eq_u32 vcc, -1, v6
s_sub_u32 s39, s39, 1
s_cbranch_scc1 RB_183
s_cbranch_vccnz RL_184
s_branch RB_183
RT_185:
s_mov_b32 s39, 20000
RL_187:
s_add_u32 s40, s46, 8192
buffer_load_dwordx4 v[60:63], v1, s[8:11], s40 offen offset:1024 sc1
s_add_u32 s40, s46, 8192
buffer_load_dwordx4 v[64:67], v1, s[8:11], s40 offen offset:2048 sc1
s_add_u32 s40, s46, 8192
buffer_load_dwordx4 v[68:71], v1, s[8:11], s40 offen offset:3072 sc1
s_add_u32 s40, s46, 12288
buffer_load_dwordx4 v[72:75], v1, s[8:11], s40 offen offset:0 sc1
s_add_u32 s40, s46, 12288
buffer_load_dwordx4 v[76:79], v1, s[8:11], s40 offen offset:1024 sc1
s_waitcnt vmcnt(0)
v_max3_u32 v6, v60, v61, v62
v_max3_u32 v6, v6, v63, v64
v_max3_u32 v6, v6, v65, v66
v_max3_u32 v6, v6, v67, v68
v_max3_u32 v6, v6, v69, v70
v_max3_u32 v6, v6, v71, v72
v_max3_u32 v6, v6, v73, v74
v_max3_u32 v6, v6, v75, v76
v_max3_u32 v6, v6, v77, v78
v_max_u32 v6, v6, v79
v_cmp_eq_u32 vcc, -1, v6
s_sub_u32 s39, s39, 1
s_cbranch_scc1 RB_186
s_cbranch_vccnz RL_187
s_branch RB_186
RT_188:
s_mov_b32 s39, 20000
RL_190:
s_add_u32 s40, s46, 8192
buffer_load_dwordx4 v[64:67], v1, s[8:11], s40 offen offset:2048 sc1
s_add_u32 s40, s46, 8192
buffer_load_dwordx4 v[68:71], v1, s[8:11], s40 offen offset:3072 sc1
s_add_u32 s40, s46, 12288
buffer_load_dwordx4 v[72:75], v1, s[8:11], s40 offen offset:0 sc1
s_add_u32 s40, s46, 12288
buffer_load_dwordx4 v[76:79], v1, s[8:11], s40 offen offset:1024 sc1
s_add_u32 s40, s46, 12288
buffer_load_dwordx4 v[80:83], v1, s[8:11], s40 offen offset:2048 sc1
s_waitcnt vmcnt(0)
v_max3_u32 v6, v64, v65, v66
v_max3_u32 v6, v6, v67, v68
v_max3_u32 v6, v6, v69, v70
v_max3_u32 v6, v6, v71, v72
v_max3_u32 v6, v6, v73, v74
v_max3_u32 v6, v6, v75, v76
v_max3_u32 v6, v6, v77, v78
v_max3_u32 v6, v6, v79, v80
v_max3_u32 v6, v6, v81, v82
v_max_u32 v6, v6, v83
v_cmp_eq_u32 vcc, -1, v6
s_sub_u32 s39, s39, 1
s_cbranch_scc1 RB_189
s_cbranch_vccnz RL_190
s_branch RB_189
RT_191:
s_mov_b32 s39, 20000
RL_193:
s_add_u32 s40, s46, 8192
buffer_load_dwordx4 v[68:71], v1, s[8:11], s40 offen offset:3072 sc1
s_add_u32 s40, s46, 12288
buffer_load_dwordx4 v[72:75], v1, s[8:11], s40 offen offset:0 sc1
s_add_u32 s40, s46, 12288
buffer_load_dwordx4 v[76:79], v1, s[8:11], s40 offen offset:1024 sc1
s_add_u32 s40, s46, 12288
buffer_load_dwordx4 v[80:83], v1, s[8:11], s40 offen offset:2048 sc1
s_add_u32 s40, s46, 12288
buffer_load_dwordx4 v[84:87], v1, s[8:11], s40 offen offset:3072 sc1
s_waitcnt vmcnt(0)
v_max3_u32 v6, v68, v69, v70
v_max3_u32 v6, v6, v71, v72
v_max3_u32 v6, v6, v73, v74
v_max3_u32 v6, v6, v75, v76
v_max3_u32 v6, v6, v77, v78
v_max3_u32 v6, v6, v79, v80
v_max3_u32 v6, v6, v81, v82
v_max3_u32 v6, v6, v83, v84
v_max3_u32 v6, v6, v85, v86
v_max_u32 v6, v6, v87
v_cmp_eq_u32 vcc, -1, v6
s_sub_u32 s39, s39, 1
s_cbranch_scc1 RB_192
s_cbranch_vccnz RL_193
s_branch RB_192
HS_195:
buffer_store_dwordx4 v[220:223], v1, s[8:11], s41 offen sc1
s_mov_b64 exec, 0xffff
buffer_store_dwordx2 v[220:221], v202, s[8:11], s42 offen sc1
s_mov_b64 exec, -1
s_branch HJ_196
RT_197:
s_mov_b32 s39, 20000
RL_199:
s_add_u32 s40, s46, 12288
buffer_load_dwordx4 v[72:75], v1, s[8:11], s40 offen offset:0 sc1
s_add_u32 s40, s46, 12288
buffer_load_dwordx4 v[76:79], v1, s[8:11], s40 offen offset:1024 sc1
s_add_u32 s40, s46, 12288
buffer_load_dwordx4 v[80:83], v1, s[8:11], s40 offen offset:2048 sc1
s_add_u32 s40, s46, 12288
buffer_load_dwordx4 v[84:87], v1, s[8:11], s40 offen offset:3072 sc1
s_waitcnt vmcnt(0)
v_max3_u32 v6, v72, v73, v74
v_max3_u32 v6, v6, v75, v76
v_max3_u32 v6, v6, v77, v78
v_max3_u32 v6, v6, v79, v80
v_max3_u32 v6, v6, v81, v82
v_max3_u32 v6, v6, v83, v84
v_max3_u32 v6, v6, v85, v86
v_max_u32 v6, v6, v87
v_cmp_eq_u32 vcc, -1, v6
s_sub_u32 s39, s39, 1
s_cbranch_scc1 RB_198
s_cbranch_vccnz RL_199
s_branch RB_198
RT_200:
s_mov_b32 s39, 20000
RL_202:
s_add_u32 s40, s46, 12288
buffer_load_dwordx4 v[76:79], v1, s[8:11], s40 offen offset:1024 sc1
s_add_u32 s40, s46, 12288
buffer_load_dwordx4 v[80:83], v1, s[8:11], s40 offen offset:2048 sc1
s_add_u32 s40, s46, 12288
buffer_load_dwordx4 v[84:87], v1, s[8:11], s40 offen offset:3072 sc1
s_waitcnt vmcnt(0)
v_max3_u32 v6, v76, v77, v78
v_max3_u32 v6, v6, v79, v80
v_max3_u32 v6, v6, v81, v82
v_max3_u32 v6, v6, v83, v84
v_max3_u32 v6, v6, v85, v86
v_max_u32 v6, v6, v87
v_cmp_eq_u32 vcc, -1, v6
s_sub_u32 s39, s39, 1
s_cbranch_scc1 RB_201
s_cbranch_vccnz RL_202
s_branch RB_201
RT_203:
s_mov_b32 s39, 20000
RL_205:
s_add_u32 s40, s46, 12288
buffer_load_dwordx4 v[80:83], v1, s[8:11], s40 offen offset:2048 sc1
s_add_u32 s40, s46, 12288
buffer_load_dwordx4 v[84:87], v1, s[8:11], s40 offen offset:3072 sc1
s_waitcnt vmcnt(0)
v_max3_u32 v6, v80, v81, v82
v_max3_u32 v6, v6, v83, v84
v_max3_u32 v6, v6, v85, v86
v_max_u32 v6, v6, v87
v_cmp_eq_u32 vcc, -1, v6
s_sub_u32 s39, s39, 1
s_cbranch_scc1 RB_204
s_cbranch_vccnz RL_205
s_branch RB_204
RT_207:
s_mov_b32 s39, 20000
RL_209:
s_add_u32 s40, s46, 12288
buffer_load_dwordx4 v[84:87], v1, s[8:11], s40 offen offset:3072 sc1
s_waitcnt vmcnt(0)
v_max3_u32 v6, v84, v85, v86
v_max_u32 v6, v6, v87
v_cmp_eq_u32 vcc, -1, v6
s_sub_u32 s39, s39, 1
s_cbranch_scc1 RB_208
s_cbranch_vccnz RL_209
s_branch RB_208
RT_212:
s_mov_b32 s39, 20000
RL_214:
s_add_u32 s40, s46, 16384
buffer_load_dwordx4 v[88:91], v1, s[8:11], s40 offen offset:2048 sc1
s_add_u32 s40, s46, 16384
buffer_load_dwordx4 v[92:95], v1, s[8:11], s40 offen offset:3072 sc1
s_waitcnt vmcnt(0)
v_max3_u32 v6, v88, v89, v90
v_max3_u32 v6, v6, v91, v92
v_max3_u32 v6, v6, v93, v94
v_max_u32 v6, v6, v95
v_cmp_eq_u32 vcc, -1, v6
s_sub_u32 s39, s39, 1
s_cbranch_scc1 RB_213
s_cbranch_vccnz RL_214
s_branch RB_213
ST_210:
s_branch RT_212
RB_213:
v_add_f32 v250, v88, v90
v_add_f32 v251, v89, v91
v_add_f32 v250, v250, v92
v_add_f32 v251, v251, v93
v_add_f32 v250, v250, v94
v_add_f32 v251, v251, v95
v_mov_b32 v5, v250
s_nop 1
v_permlane16_swap_b32 v250, v5
s_nop 0
v_add_f32 v250, v250, v5
v_mov_b32 v5, v250
s_nop 1
v_permlane32_swap_b32 v250, v5
s_nop 0
v_add_f32 v250, v250, v5
v_mov_b32 v5, v251
s_nop 1
v_permlane16_swap_b32 v251, v5
s_nop 0
v_add_f32 v251, v251, v5
v_mov_b32 v5, v251
s_nop 1
v_permlane32_swap_b32 v251, v5
s_nop 0
v_add_f32 v251, v251, v5
v_mul_f32 v250, 0x3ae38e39, v250
v_mul_f32 v251, 0x3ae38e39, v251
v_fma_f32 v251, -v250, v250, v251
v_max_f32 v251, 0, v251
v_add_f32 v251, 0x3727c5ac, v251
v_rsq_f32 v251, v251
s_branch SB_211
HS_246:
buffer_store_dwordx4 v[128:131], v1, s[8:11], s53 offen sc1
buffer_store_dword v132, v5, s[8:11], s54 offen sc1
s_branch HJ_247
RT_250:
s_mov_b32 s39, 20000
RL_252:
buffer_load_dwordx4 v[16:19], v1, s[8:11], s43 offen offset:0 sc1
buffer_load_dwordx4 v[20:23], v1, s[8:11], s44 offen offset:0 sc1
buffer_load_dwordx4 v[24:27], v1, s[8:11], s44 offen offset:1024 sc1
buffer_load_dwordx4 v[28:31], v1, s[8:11], s44 offen offset:2048 sc1
buffer_load_dwordx4 v[32:35], v1, s[8:11], s44 offen offset:3072 sc1
s_waitcnt vmcnt(0)
v_max3_u32 v6, v16, v17, v18
v_max3_u32 v6, v6, v19, v20
v_max3_u32 v6, v6, v21, v22
v_max3_u32 v6, v6, v23, v24
v_max3_u32 v6, v6, v25, v26
v_max3_u32 v6, v6, v27, v28
v_max3_u32 v6, v6, v29, v30
v_max3_u32 v6, v6, v31, v32
v_max3_u32 v6, v6, v33, v34
v_max_u32 v6, v6, v35
v_cmp_eq_u32 vcc, -1, v6
s_sub_u32 s39, s39, 1
s_cbranch_scc1 RB_251
s_cbranch_vccnz RL_252
s_branch RB_251
RT_253:
s_mov_b32 s39, 20000
RL_255:
buffer_load_dwordx4 v[20:23], v1, s[8:11], s44 offen offset:0 sc1
buffer_load_dwordx4 v[24:27], v1, s[8:11], s44 offen offset:1024 sc1
buffer_load_dwordx4 v[28:31], v1, s[8:11], s44 offen offset:2048 sc1
buffer_load_dwordx4 v[32:35], v1, s[8:11], s44 offen offset:3072 sc1
s_add_u32 s40, s44, 4096
buffer_load_dwordx4 v[36:39], v1, s[8:11], s40 offen offset:0 sc1
s_waitcnt vmcnt(0)
v_max3_u32 v6, v20, v21, v22
v_max3_u32 v6, v6, v23, v24
v_max3_u32 v6, v6, v25, v26
v_max3_u32 v6, v6, v27, v28
v_max3_u32 v6, v6, v29, v30
v_max3_u32 v6, v6, v31, v32
v_max3_u32 v6, v6, v33, v34
v_max3_u32 v6, v6, v35, v36
v_max3_u32 v6, v6, v37, v38
v_max_u32 v6, v6, v39
v_cmp_eq_u32 vcc, -1, v6
s_sub_u32 s39, s39, 1
s_cbranch_scc1 RB_254
s_cbranch_vccnz RL_255
s_branch RB_254
RT_256:
s_mov_b32 s39, 20000
RL_258:
buffer_load_dwordx4 v[24:27], v1, s[8:11], s44 offen offset:1024 sc1
buffer_load_dwordx4 v[28:31], v1, s[8:11], s44 offen offset:2048 sc1
buffer_load_dwordx4 v[32:35], v1, s[8:11], s44 offen offset:3072 sc1
s_add_u32 s40, s44, 4096
buffer_load_dwordx4 v[36:39], v1, s[8:11], s40 offen offset:0 sc1
s_add_u32 s40, s44, 4096
buffer_load_dwordx4 v[40:43], v1, s[8:11], s40 offen offset:1024 sc1
s_waitcnt vmcnt(0)
v_max3_u32 v6, v24, v25, v26
v_max3_u32 v6, v6, v27, v28
v_max3_u32 v6, v6, v29, v30
v_max3_u32 v6, v6, v31, v32
v_max3_u32 v6, v6, v33, v34
v_max3_u32 v6, v6, v35, v36
v_max3_u32 v6, v6, v37, v38
v_max3_u32 v6, v6, v39, v40
v_max3_u32 v6, v6, v41, v42
v_max_u32 v6, v6, v43
v_cmp_eq_u32 vcc, -1, v6
s_sub_u32 s39, s39, 1
s_cbranch_scc1 RB_257
s_cbranch_vccnz RL_258
s_branch RB_257
RT_259:
s_mov_b32 s39, 20000
RL_261:
buffer_load_dwordx4 v[28:31], v1, s[8:11], s44 offen offset:2048 sc1
buffer_load_dwordx4 v[32:35], v1, s[8:11], s44 offen offset:3072 sc1
s_add_u32 s40, s44, 4096
buffer_load_dwordx4 v[36:39], v1, s[8:11], s40 offen offset:0 sc1
s_add_u32 s40, s44, 4096
buffer_load_dwordx4 v[40:43], v1, s[8:11], s40 offen offset:1024 sc1
s_add_u32 s40, s44, 4096
buffer_load_dwordx4 v[44:47], v1, s[8:11], s40 offen offset:2048 sc1
s_waitcnt vmcnt(0)
v_max3_u32 v6, v28, v29, v30
v_max3_u32 v6, v6, v31, v32
v_max3_u32 v6, v6, v33, v34
v_max3_u32 v6, v6, v35, v36
v_max3_u32 v6, v6, v37, v38
v_max3_u32 v6, v6, v39, v40
v_max3_u32 v6, v6, v41, v42
v_max3_u32 v6, v6, v43, v44
v_max3_u32 v6, v6, v45, v46
v_max_u32 v6, v6, v47
v_cmp_eq_u32 vcc, -1, v6
s_sub_u32 s39, s39, 1
s_cbranch_scc1 RB_260
s_cbranch_vccnz RL_261
s_branch RB_260
HS_263:
buffer_store_dwordx4 v[228:231], v1, s[8:11], s46 offen sc1
s_mov_b64 exec, s[72:73]
buffer_store_dwordx2 v[228:229], v7, s[8:11], s47 offen sc1
s_mov_b64 exec, -1
s_mov_b64 exec, s[82:83]
buffer_store_dwordx2 v[228:229], v202, s[8:11], s48 offen sc1
s_mov_b64 exec, -1
s_branch HJ_264
RT_265:
s_mov_b32 s39, 20000
RL_267:
buffer_load_dwordx4 v[32:35], v1, s[8:11], s44 offen offset:3072 sc1
s_add_u32 s40, s44, 4096
buffer_load_dwordx4 v[36:39], v1, s[8:11], s40 offen offset:0 sc1
s_add_u32 s40, s44, 4096
buffer_load_dwordx4 v[40:43], v1, s[8:11], s40 offen offset:1024 sc1
s_add_u32 s40, s44, 4096
buffer_load_dwordx4 v[44:47], v1, s[8:11], s40 offen offset:2048 sc1
s_add_u32 s40, s44, 4096
buffer_load_dwordx4 v[48:51], v1, s[8:11], s40 offen offset:3072 sc1
s_waitcnt vmcnt(0)
v_max3_u32 v6, v32, v33, v34
v_max3_u32 v6, v6, v35, v36
v_max3_u32 v6, v6, v37, v38
v_max3_u32 v6, v6, v39, v40
v_max3_u32 v6, v6, v41, v42
v_max3_u32 v6, v6, v43, v44
v_max3_u32 v6, v6, v45, v46
v_max3_u32 v6, v6, v47, v48
v_max3_u32 v6, v6, v49, v50
v_max_u32 v6, v6, v51
v_cmp_eq_u32 vcc, -1, v6
s_sub_u32 s39, s39, 1
s_cbranch_scc1 RB_266
s_cbranch_vccnz RL_267
s_branch RB_266
RT_270:
s_mov_b32 s39, 20000
RL_272:
s_add_u32 s40, s44, 4096
buffer_load_dwordx4 v[36:39], v1, s[8:11], s40 offen offset:0 sc1
s_add_u32 s40, s44, 4096
buffer_load_dwordx4 v[40:43], v1, s[8:11], s40 offen offset:1024 sc1
s_add_u32 s40, s44, 4096
buffer_load_dwordx4 v[44:47], v1, s[8:11], s40 offen offset:2048 sc1
s_add_u32 s40, s44, 4096
buffer_load_dwordx4 v[48:51], v1, s[8:11], s40 offen offset:3072 sc1
s_waitcnt vmcnt(0)
v_max3_u32 v6, v36, v37, v38
v_max3_u32 v6, v6, v39, v40
v_max3_u32 v6, v6, v41, v42
v_max3_u32 v6, v6, v43, v44
v_max3_u32 v6, v6, v45, v46
v_max3_u32 v6, v6, v47, v48
v_max3_u32 v6, v6, v49, v50
v_max_u32 v6, v6, v51
v_cmp_eq_u32 vcc, -1, v6
s_sub_u32 s39, s39, 1
s_cbranch_scc1 RB_271
s_cbranch_vccnz RL_272
s_branch RB_271
RT_273:
s_mov_b32 s39, 20000
RL_275:
s_add_u32 s40, s44, 4096
buffer_load_dwordx4 v[40:43], v1, s[8:11], s40 offen offset:1024 sc1
s_add_u32 s40, s44, 4096
buffer_load_dwordx4 v[44:47], v1, s[8:11], s40 offen offset:2048 sc1
s_add_u32 s40, s44, 4096
buffer_load_dwordx4 v[48:51], v1, s[8:11], s40 offen offset:3072 sc1
s_waitcnt vmcnt(0)
v_max3_u32 v6, v40, v41, v42
v_max3_u32 v6, v6, v43, v44
v_max3_u32 v6, v6, v45, v46
v_max3_u32 v6, v6, v47, v48
v_max3_u32 v6, v6, v49, v50
v_max_u32 v6, v6, v51
v_cmp_eq_u32 vcc, -1, v6
s_sub_u32 s39, s39, 1
s_cbranch_scc1 RB_274
s_cbranch_vccnz RL_275
s_branch RB_274
RT_276:
s_mov_b32 s39, 20000
RL_278:
s_add_u32 s40, s44, 4096
buffer_load_dwordx4 v[44:47], v1, s[8:11], s40 offen offset:2048 sc1
s_add_u32 s40, s44, 4096
buffer_load_dwordx4 v[48:51], v1, s[8:11], s40 offen offset:3072 sc1
s_waitcnt vmcnt(0)
v_max3_u32 v6, v44, v45, v46
v_max3_u32 v6, v6, v47, v48
v_max3_u32 v6, v6, v49, v50
v_max_u32 v6, v6, v51
v_cmp_eq_u32 vcc, -1, v6
s_sub_u32 s39, s39, 1
s_cbranch_scc1 RB_277
s_cbranch_vccnz RL_278
s_branch RB_277
RT_279:
s_mov_b32 s39, 20000
RL_281:
s_add_u32 s40, s44, 4096
buffer_load_dwordx4 v[48:51], v1, s[8:11], s40 offen offset:3072 sc1
s_waitcnt vmcnt(0)
v_max3_u32 v6, v48, v49, v50
v_max_u32 v6, v6, v51
v_cmp_eq_u32 vcc, -1, v6
s_sub_u32 s39, s39, 1
s_cbranch_scc1 RB_280
s_cbranch_vccnz RL_281
s_branch RB_280
HS_290:
buffer_store_dwordx4 v[8:11], v1, s[8:11], s46 offen sc1
v_cndmask_b32_e64 v50, 0, v12, s[72:73]
v_cndmask_b32_e64 v51, 0, v13, s[72:73]
v_mov_b32 v52, 0
v_mov_b32 v53, 0
v_mfma_f32_16x16x32_bf16 v[56:59], v[236:239], v[8:11], 0
v_mfma_f32_16x16x32_bf16 v[60:63], v[8:11], v[8:11], 0
s_mov_b64 exec, s[72:73]
buffer_store_dwordx2 v[12:13], v7, s[8:11], s47 offen sc1
s_mov_b64 exec, -1
v_mfma_f32_16x16x32_bf16 v[56:59], v[236:239], v[50:53], v[56:59]
v_mfma_f32_16x16x32_bf16 v[60:63], v[50:53], v[50:53], v[60:63]
s_nop 7
v_cndmask_b32_e64 v60, v60, v61, s[76:77]
v_cndmask_b32_e64 v60, v60, v62, s[78:79]
v_cndmask_b32_e64 v57, v60, v63, s[80:81]
s_mov_b64 exec, s[82:83]
buffer_store_dwordx2 v[56:57], v202, s[8:11], s48 offen sc1
s_mov_b64 exec, -1
s_branch HJ_291
.section .rodata,"a"
.p2align 6
.amdhsa_kernel main_kernel
  .amdhsa_next_free_vgpr 256
  .amdhsa_next_free_sgpr 102
  .amdhsa_accum_offset 256
  .amdhsa_group_segment_fixed_size 0
  .amdhsa_kernarg_size 80
  .amdhsa_user_sgpr_count 2
  .amdhsa_user_sgpr_kernarg_segment_ptr 1
  .amdhsa_system_sgpr_workgroup_id_x 1
  .amdhsa_float_denorm_mode_32 3
.end_amdhsa_kernel
```
